```python
import torch

def _softmax(x, axis=-1):
    return torch.softmax(x, dim=axis)
def _gelu(x):
    return torch.nn.functional.gelu(x, approximate="tanh")
def _silu(x):
    return torch.nn.functional.silu(x)
def _sigmoid(x):
    return torch.sigmoid(x)
def _layernorm(x, axis=-1, eps=1e-5):
    m = x.mean(dim=axis, keepdim=True)
    v = x.var(dim=axis, keepdim=True, unbiased=False)
    return (x - m) / torch.sqrt(v + eps)
def _scatter_add(tgt, idx, src, axis=0):
    return tgt.clone().index_add_(axis, idx, src)
def _segment_sum(src, seg, n):
    out = torch.zeros((n,) + src.shape[1:], dtype=src.dtype)
    return out.index_add_(0, seg, src)
def _pad(x, pw):
    flat = tuple(v for pair in reversed(pw) for v in pair)
    return torch.nn.functional.pad(x, flat)

kernel_name = 'sequential_preLN__mha_block_cached__glu_gated_bilinear__decode'

def setup_inputs():

    _w = (lambda a: (lambda t: t.to(torch.bfloat16) if t.is_floating_point() else t)(torch.as_tensor(a)))
    def _A_setup():
        B, Sq, D = 4, 1, 448
        H, Sk, Dh = 16, 8192, 256
        return {
            "x": _w((lambda *s: torch.randn(*s, dtype=torch.bfloat16) * 0.05)(B, Sq, D)),
            "k_cache": _w((lambda *s: torch.randn(*s, dtype=torch.bfloat16) * 1.6)(B, H, Sk, Dh)),
            "v_cache": _w((lambda *s: torch.randn(*s, dtype=torch.bfloat16) * 0.8)(B, H, Sk, Dh)),
            "wq": _w((lambda *s: torch.randn(*s, dtype=torch.bfloat16) * 1.6)(D, H * Dh) * (D ** -0.5)),
            "wo": _w((lambda *s: torch.randn(*s, dtype=torch.bfloat16) * 0.8)(H * Dh, D) * ((H * Dh) ** -0.5)),
        }
    _A_in = _A_setup()

    def _B_setup():
        B, S, D, F = 4, 1, 448, 1792
        return {
            "x": _w((lambda *s: torch.randn(*s, dtype=torch.bfloat16) * 0.05)(B, S, D)),
            "w_gate": _w((lambda *s: torch.randn(*s, dtype=torch.bfloat16) * 0.4)(D, F) * (D ** -0.5)),
            "w_up": _w((lambda *s: torch.randn(*s, dtype=torch.bfloat16) * 0.4)(D, F) * (D ** -0.5)),
            "w_down": _w((lambda *s: torch.randn(*s, dtype=torch.bfloat16) * 0.4)(F, D) * (F ** -0.5)),
        }
    _B_in = _B_setup()

    return {
        "A_x": _A_in["x"],
        "A_k_cache": _A_in["k_cache"],
        "A_v_cache": _A_in["v_cache"],
        "A_wq": _A_in["wq"],
        "A_wo": _A_in["wo"],
        "B_x": _B_in["x"],
        "B_w_gate": _B_in["w_gate"],
        "B_w_up": _B_in["w_up"],
        "B_w_down": _B_in["w_down"],
    }

def reference(A_x, A_k_cache, A_v_cache, A_wq, A_wo, B_x, B_w_gate, B_w_up, B_w_down):
    def _A_ref(x, k_cache, v_cache, wq, wo):
        B, Sq, D = x.shape
        H, Dh = 16, 256
        q = (lambda x, *d: x.permute(*d))((x @ wq).reshape(B, Sq, H, Dh), 0, 2, 1, 3)
        scores = torch.einsum("bhqd,bhkd->bhqk", q, k_cache) * (Dh ** -0.5)
        p = _softmax(scores, axis=-1)
        o = torch.einsum("bhqk,bhkd->bhqd", p, v_cache)
        return (lambda x, *d: x.permute(*d))(o, 0, 2, 1, 3).reshape(B, Sq, H * Dh) @ wo

    def _B_ref(x, w_gate, w_up, w_down):
        g = torch.einsum("bsd,df->bsf", x, w_gate)
        u = torch.einsum("bsd,df->bsf", x, w_up)
        h = g * u
        return torch.einsum("bsf,fd->bsd", h, w_down)

    x = A_x
    h = x + _A_ref(_layernorm(x, axis=-1), A_k_cache, A_v_cache, A_wq, A_wo)
    h2 = h + _B_ref(_layernorm(h, axis=-1), B_w_gate, B_w_up, B_w_down)
    return h2
```

```asm
; @launch grid=(256,1,1) block=(512,1,1) lds=154624
.amdgcn_target "amdgcn-amd-amdhsa--gfx950"
.text
.globl sequential_preLN__mha_block_cached__glu_gated_bilinear__decode_kernel
.p2align 8
.type sequential_preLN__mha_block_cached__glu_gated_bilinear__decode_kernel,@function
sequential_preLN__mha_block_cached__glu_gated_bilinear__decode_kernel:
    s_cmp_ge_u32 s2, 0x100
    s_cbranch_scc1 L_exit
    s_load_dwordx16 s[4:19], s[0:1], 0
    s_load_dwordx8 s[20:27], s[0:1], 64
    v_lshrrev_b32 v1, 6, v0
    v_and_b32 v2, 63, v0
    v_readfirstlane_b32 s3, v1
    v_mov_b32 v15, 0
    s_cmp_ge_u32 s3, 4
    s_cbranch_scc1 L_early
    v_mul_u32_u24 v1, 4096, v1
    v_lshl_add_u32 v1, v2, 4, v1
    s_lshr_b32 s40, s2, 1
    s_lshl_b32 s40, s40, 7
    s_and_b32 s41, s2, 1
    s_add_u32 s40, s40, s41
    s_lshl_b32 s40, s40, 14
    s_mov_b32 s42, 0x8000
    s_mov_b32 s41, s40
    s_mov_b32 s30, 0x10000000
    s_mov_b32 s31, 0x20000
    s_setprio 2
    s_waitcnt lgkmcnt(0)
    s_mov_b32 s28, s6
    s_and_b32 s29, s7, 0xffff
    buffer_load_dwordx4 v[48:51], v1, s[28:31], s41 offen offset:0 nt
    buffer_load_dwordx4 v[52:55], v1, s[28:31], s41 offen offset:1024 nt
    buffer_load_dwordx4 v[56:59], v1, s[28:31], s41 offen offset:2048 nt
    buffer_load_dwordx4 v[60:63], v1, s[28:31], s41 offen offset:3072 nt
    s_add_u32 s41, s41, s42
    buffer_load_dwordx4 v[64:67], v1, s[28:31], s41 offen offset:0 nt
    buffer_load_dwordx4 v[68:71], v1, s[28:31], s41 offen offset:1024 nt
    buffer_load_dwordx4 v[72:75], v1, s[28:31], s41 offen offset:2048 nt
    buffer_load_dwordx4 v[76:79], v1, s[28:31], s41 offen offset:3072 nt
    s_barrier
    s_branch L_stream
L_early:
    v_lshlrev_b32 v11, 2, v2
    s_mov_b32 vcc_lo, 0x10000f00
    s_mov_b32 vcc_hi, 0
    v_lshlrev_b32 v6, 4, v2
    v_mov_b32 v7, 0x7ffffff0
    v_cndmask_b32 v10, 0, -1, vcc
    ds_write_b32 v11, v10
    ds_write_b32 v11, v15 offset:19200
    v_cmp_gt_u32 vcc, 56, v2
    v_lshrrev_b32 v9, 3, v2
    v_lshlrev_b32 v9, 13, v9
    v_cndmask_b32 v5, 0, 1.0, vcc
    v_cndmask_b32 v6, v7, v6, vcc
    v_and_b32 v10, 7, v2
    v_lshl_add_u32 v9, v10, 4, v9
    s_and_b32 s52, s2, 7
    s_lshr_b32 s53, s2, 5
    s_lshl_b32 s53, s53, 3
    s_add_u32 s52, s52, s53
    s_sub_u32 s48, s3, 4
    s_mul_i32 s55, s48, 896
    s_lshl_b32 s53, s52, 7
    s_lshl_b32 s56, s48, 16
    s_add_u32 s53, s53, s56
    s_lshl_b32 s56, s48, 10
    s_add_u32 s56, s56, 19456
    s_waitcnt lgkmcnt(0)
    s_barrier
    s_setprio 3
    s_mov_b32 s36, s26
    s_and_b32 s37, s27, 0xffff
    s_mov_b32 s38, 3145728
    s_mov_b32 s39, 0x20000
    s_mov_b32 s28, s4
    s_and_b32 s29, s5, 0xffff
    s_mov_b32 s30, 3584
    s_mov_b32 s31, 0x20000
    s_mov_b32 s32, s10
    s_and_b32 s33, s11, 0xffff
    s_mov_b32 s34, 3670016
    s_mov_b32 s35, 0x20000
    s_cmp_lg_u32 s48, 1
    s_cbranch_scc1 L_noclear
    s_bfe_u32 s45, s2, 0x40002
    s_lshl_b32 s45, s45, 14
    s_and_b32 s46, s2, 3
    s_lshl_b32 s46, s46, 8
    s_lshr_b32 s47, s2, 6
    s_lshl_b32 s47, s47, 6
    s_add_u32 s45, s45, s46
    s_add_u32 s45, s45, s47
    s_add_u32 s45, s45, 262144
    v_lshrrev_b32 v22, 3, v2
    v_and_b32 v23, 7, v2
    v_lshlrev_b32 v23, 3, v23
    v_lshl_add_u32 v22, v22, 10, v23
    v_mov_b32 v20, -1
    v_mov_b32 v21, -1
    buffer_store_dwordx2 v[20:21], v22, s[36:39], s45 offen sc1
    s_add_u32 s45, s45, 0x2000
    buffer_store_dwordx2 v[20:21], v22, s[36:39], s45 offen sc1
L_noclear:
    buffer_load_dword v8, v15, s[36:39], 0 offen offset:0 sc1
    s_bfe_u32 s62, s2, 0x20003
    s_cmp_lg_u32 s62, 0
    s_cbranch_scc1 L_gather
    buffer_load_dwordx4 v[16:19], v6, s[28:31], s55 offen
    s_mov_b32 s57, 14
L_wq:
    s_mov_b32 m0, s56
    s_nop 0
    buffer_load_dwordx4 v9, s[32:35], s53 offen nt lds
    s_add_u32 s53, s53, 262144
    s_add_u32 s56, s56, 4096
    s_sub_u32 s57, s57, 1
    s_cmp_lg_u32 s57, 0
    s_cbranch_scc1 L_wq
L_helper:
    s_waitcnt vmcnt(14)
    v_lshlrev_b32 v32, 16, v16
    v_and_b32 v33, 0xffff0000, v16
    v_lshlrev_b32 v34, 16, v17
    v_and_b32 v35, 0xffff0000, v17
    v_lshlrev_b32 v36, 16, v18
    v_and_b32 v37, 0xffff0000, v18
    v_lshlrev_b32 v38, 16, v19
    v_and_b32 v39, 0xffff0000, v19
    v_add_f32 v80, v32, v33
    v_add_f32 v81, v34, v35
    v_add_f32 v88, v36, v37
    v_add_f32 v89, v38, v39
    v_add_f32 v80, v80, v81
    v_add_f32 v88, v88, v89
    v_add_f32 v80, v80, v88
    s_nop 1
    v_add_f32_dpp v80, v80, v80 quad_perm:[1,0,3,2] row_mask:0xf bank_mask:0xf
    s_nop 1
    v_add_f32_dpp v80, v80, v80 quad_perm:[2,3,0,1] row_mask:0xf bank_mask:0xf
    s_nop 1
    v_add_f32_dpp v80, v80, v80 row_half_mirror row_mask:0xf bank_mask:0xf
    s_nop 1
    v_add_f32_dpp v80, v80, v80 row_mirror row_mask:0xf bank_mask:0xf
    s_nop 1
    v_mov_b32 v88, v80
    s_nop 1
    v_permlane16_swap_b32 v80, v88
    v_add_f32 v80, v80, v88
    v_mov_b32 v88, v80
    s_nop 1
    v_permlane32_swap_b32 v80, v88
    v_add_f32 v80, v80, v88
    v_mul_f32 v80, 0x3b124925, v80
    v_sub_f32 v88, v32, v80
    v_sub_f32 v89, v33, v80
    v_sub_f32 v90, v34, v80
    v_sub_f32 v91, v35, v80
    v_sub_f32 v92, v36, v80
    v_sub_f32 v93, v37, v80
    v_sub_f32 v94, v38, v80
    v_sub_f32 v95, v39, v80
    v_mul_f32 v81, v88, v88
    v_mul_f32 v89, v89, v89
    v_fmac_f32 v81, v90, v90
    v_fmac_f32 v89, v91, v91
    v_fmac_f32 v81, v92, v92
    v_fmac_f32 v89, v93, v93
    v_fmac_f32 v81, v94, v94
    v_fmac_f32 v89, v95, v95
    v_add_f32 v81, v81, v89
    v_mul_f32 v81, v81, v5
    s_nop 1
    v_add_f32_dpp v81, v81, v81 quad_perm:[1,0,3,2] row_mask:0xf bank_mask:0xf
    s_nop 1
    v_add_f32_dpp v81, v81, v81 quad_perm:[2,3,0,1] row_mask:0xf bank_mask:0xf
    s_nop 1
    v_add_f32_dpp v81, v81, v81 row_half_mirror row_mask:0xf bank_mask:0xf
    s_nop 1
    v_add_f32_dpp v81, v81, v81 row_mirror row_mask:0xf bank_mask:0xf
    s_nop 1
    v_mov_b32 v88, v81
    s_nop 1
    v_permlane16_swap_b32 v81, v88
    v_add_f32 v81, v81, v88
    v_mov_b32 v88, v81
    s_nop 1
    v_permlane32_swap_b32 v81, v88
    v_add_f32 v81, v81, v88
    v_mul_f32 v81, 0x3b124925, v81
    v_cvt_pk_bf16_f32 v81, v80, v81
    v_lshlrev_b32 v80, 16, v81
    v_and_b32 v81, 0xffff0000, v81
    v_add_f32 v81, 0x3727c5ac, v81
    v_cvt_pk_bf16_f32 v81, v81, v81
    v_and_b32 v81, 0xffff0000, v81
    v_sqrt_f32 v81, v81
    v_sub_f32 v88, v32, v80
    v_cvt_pk_bf16_f32 v81, v81, v81
    v_and_b32 v81, 0xffff0000, v81
    v_rcp_f32 v81, v81
    v_sub_f32 v89, v33, v80
    v_sub_f32 v90, v34, v80
    v_sub_f32 v91, v35, v80
    v_sub_f32 v92, v36, v80
    v_sub_f32 v93, v37, v80
    v_sub_f32 v94, v38, v80
    v_sub_f32 v95, v39, v80
    v_cvt_pk_bf16_f32 v64, v88, v89
    v_cvt_pk_bf16_f32 v65, v90, v91
    v_cvt_pk_bf16_f32 v66, v92, v93
    v_cvt_pk_bf16_f32 v67, v94, v95
    v_lshlrev_b32 v88, 16, v64
    v_and_b32 v89, 0xffff0000, v64
    v_lshlrev_b32 v90, 16, v65
    v_and_b32 v91, 0xffff0000, v65
    v_lshlrev_b32 v92, 16, v66
    v_and_b32 v93, 0xffff0000, v66
    v_lshlrev_b32 v94, 16, v67
    v_and_b32 v95, 0xffff0000, v67
    v_mul_f32 v88, v88, v81
    v_mul_f32 v89, v89, v81
    v_mul_f32 v90, v90, v81
    v_mul_f32 v91, v91, v81
    v_mul_f32 v92, v92, v81
    v_mul_f32 v93, v93, v81
    v_mul_f32 v94, v94, v81
    v_mul_f32 v95, v95, v81
    v_cvt_pk_bf16_f32 v64, v88, v89
    v_cvt_pk_bf16_f32 v65, v90, v91
    v_cvt_pk_bf16_f32 v66, v92, v93
    v_cvt_pk_bf16_f32 v67, v94, v95
    v_lshlrev_b32 v9, 4, v2
    v_add_u32 v9, s55, v9
    s_mov_b32 exec_lo, 0xffffffff
    s_mov_b32 exec_hi, 0xffffff
    ds_write_b128 v9, v[64:67] offset:13312
    s_mov_b64 exec, 1
    v_mov_b32 v10, 1
    s_waitcnt vmcnt(0) lgkmcnt(0)
    ds_add_u32 v15, v10 offset:16
    s_mov_b64 exec, -1
    v_and_b32 v3, 15, v2
    v_lshrrev_b32 v4, 4, v2
    v_and_b32 v12, 3, v2
    v_lshrrev_b32 v11, 2, v3
    v_lshl_add_u32 v11, v4, 3, v11
    v_mul_u32_u24 v10, 896, v12
    v_lshl_add_u32 v10, v4, 4, v10
    v_lshlrev_b32 v13, 7, v11
    v_lshl_add_u32 v13, v12, 3, v13
    s_lshl_b32 s55, s48, 5
    s_add_u32 s55, s55, 19456
    v_add_u32 v13, s55, v13
    s_lshr_b32 s53, s52, 2
    s_lshl_b32 s53, s53, 12
    s_and_b32 s55, s52, 3
    s_lshl_b32 s55, s55, 8
    s_add_u32 s53, s53, s55
    s_lshl_b32 s55, s48, 6
    s_add_u32 s53, s53, s55
    s_add_u32 s53, s53, 4096
    v_lshlrev_b32 v9, 10, v3
    v_lshl_add_u32 v9, v4, 4, v9
    v_add_u32 v21, 1, v8
    v_add_u32 v23, 1, v8
L_spin_1:
    ds_read_b32 v16, v15 offset:16
    s_waitcnt lgkmcnt(0)
    v_readfirstlane_b32 s58, v16
    s_cmp_ge_u32 s58, 4
    s_cbranch_scc1 L_spun_2
    s_branch L_spin_1
L_spun_2:
    ds_read_b128 v[96:99], v10 offset:13312
    ds_read_b64_tr_b16 v[160:161], v13 offset:0
    ds_read_b64_tr_b16 v[162:163], v13 offset:512
    ds_read_b128 v[100:103], v10 offset:13376
    ds_read_b64_tr_b16 v[164:165], v13 offset:4096
    ds_read_b64_tr_b16 v[166:167], v13 offset:4608
    ds_read_b128 v[104:107], v10 offset:13440
    ds_read_b64_tr_b16 v[168:169], v13 offset:8192
    ds_read_b64_tr_b16 v[170:171], v13 offset:8704
    ds_read_b128 v[108:111], v10 offset:13504
    ds_read_b64_tr_b16 v[172:173], v13 offset:12288
    ds_read_b64_tr_b16 v[174:175], v13 offset:12800
    ds_read_b128 v[112:115], v10 offset:13568
    ds_read_b64_tr_b16 v[176:177], v13 offset:16384
    ds_read_b64_tr_b16 v[178:179], v13 offset:16896
    s_waitcnt lgkmcnt(12)
    v_mfma_f32_16x16x32_bf16 v[16:19], v[160:163], v[96:99], 0
    ds_read_b128 v[116:119], v10 offset:13632
    ds_read_b64_tr_b16 v[180:181], v13 offset:20480
    ds_read_b64_tr_b16 v[182:183], v13 offset:20992
    s_waitcnt lgkmcnt(12)
    v_mfma_f32_16x16x32_bf16 v[16:19], v[164:167], v[100:103], v[16:19]
    ds_read_b128 v[120:123], v10 offset:13696
    ds_read_b64_tr_b16 v[184:185], v13 offset:24576
    ds_read_b64_tr_b16 v[186:187], v13 offset:25088
    s_waitcnt lgkmcnt(12)
    v_mfma_f32_16x16x32_bf16 v[16:19], v[168:171], v[104:107], v[16:19]
    ds_read_b128 v[124:127], v10 offset:13760
    ds_read_b64_tr_b16 v[188:189], v13 offset:28672
    ds_read_b64_tr_b16 v[190:191], v13 offset:29184
    s_waitcnt lgkmcnt(12)
    v_mfma_f32_16x16x32_bf16 v[16:19], v[172:175], v[108:111], v[16:19]
    ds_read_b128 v[128:131], v10 offset:13824
    ds_read_b64_tr_b16 v[192:193], v13 offset:32768
    ds_read_b64_tr_b16 v[194:195], v13 offset:33280
    s_waitcnt lgkmcnt(12)
    v_mfma_f32_16x16x32_bf16 v[16:19], v[176:179], v[112:115], v[16:19]
    ds_read_b128 v[132:135], v10 offset:13888
    ds_read_b64_tr_b16 v[196:197], v13 offset:36864
    ds_read_b64_tr_b16 v[198:199], v13 offset:37376
    s_waitcnt lgkmcnt(12)
    v_mfma_f32_16x16x32_bf16 v[16:19], v[180:183], v[116:119], v[16:19]
    ds_read_b128 v[136:139], v10 offset:13952
    ds_read_b64_tr_b16 v[200:201], v13 offset:40960
    ds_read_b64_tr_b16 v[202:203], v13 offset:41472
    s_waitcnt lgkmcnt(12)
    v_mfma_f32_16x16x32_bf16 v[16:19], v[184:187], v[120:123], v[16:19]
    ds_read_b128 v[140:143], v10 offset:14016
    ds_read_b64_tr_b16 v[204:205], v13 offset:45056
    ds_read_b64_tr_b16 v[206:207], v13 offset:45568
    s_waitcnt lgkmcnt(12)
    v_mfma_f32_16x16x32_bf16 v[16:19], v[188:191], v[124:127], v[16:19]
    ds_read_b128 v[144:147], v10 offset:14080
    ds_read_b64_tr_b16 v[208:209], v13 offset:49152
    ds_read_b64_tr_b16 v[210:211], v13 offset:49664
    s_waitcnt lgkmcnt(12)
    v_mfma_f32_16x16x32_bf16 v[16:19], v[192:195], v[128:131], v[16:19]
    ds_read_b128 v[148:151], v10 offset:14144
    ds_read_b64_tr_b16 v[212:213], v13 offset:53248
    ds_read_b64_tr_b16 v[214:215], v13 offset:53760
    s_waitcnt lgkmcnt(12)
    v_mfma_f32_16x16x32_bf16 v[16:19], v[196:199], v[132:135], v[16:19]
    s_waitcnt lgkmcnt(9)
    v_mfma_f32_16x16x32_bf16 v[16:19], v[200:203], v[136:139], v[16:19]
    s_waitcnt lgkmcnt(6)
    v_mfma_f32_16x16x32_bf16 v[16:19], v[204:207], v[140:143], v[16:19]
    s_waitcnt lgkmcnt(3)
    v_mfma_f32_16x16x32_bf16 v[16:19], v[208:211], v[144:147], v[16:19]
    s_waitcnt lgkmcnt(0)
    v_mfma_f32_16x16x32_bf16 v[16:19], v[212:215], v[148:151], v[16:19]
    s_nop 7
    v_cvt_pk_bf16_f32 v20, v16, v17
    v_cvt_pk_bf16_f32 v22, v18, v19
    s_mov_b32 exec_lo, 0xf000f
    s_mov_b32 exec_hi, 0xf000f
    buffer_store_dwordx4 v[20:23], v9, s[36:39], s53 offen sc1
    s_mov_b64 exec, -1
L_gather:
    v_and_b32 v3, 15, v2
    v_lshrrev_b32 v4, 4, v2
    v_and_b32 v12, 3, v2
    v_lshrrev_b32 v11, 2, v3
    v_lshl_add_u32 v11, v4, 3, v11
    s_waitcnt vmcnt(0)
    v_add_u32 v60, 1, v8
    s_movk_i32 s61, 0xff
    v_bfe_u32 v61, v60, 8, 8
    v_readfirstlane_b32 s54, v60
    v_bfe_u32 v62, v60, 16, 8
    v_lshrrev_b32 v63, 24, v60
    v_and_b32 v60, 0xff, v60
    s_cmp_lg_u32 s48, 0
    s_cbranch_scc1 L_role
    s_bfe_u32 s55, s2, 0x40002
    s_lshl_b32 s55, s55, 2
    s_lshr_b32 s56, s2, 6
    s_add_u32 s55, s55, s56
    s_lshl_b32 s55, s55, 10
    s_add_u32 s55, s55, 4096
    v_lshlrev_b32 v10, 4, v2
    s_mov_b32 s59, 262144
L_qpoll_3:
    buffer_load_dwordx4 v[24:27], v10, s[36:39], s55 offen sc1
    s_waitcnt vmcnt(0)
    v_cmp_ne_u32 vcc, s54, v25
    v_cmp_ne_u32 s[56:57], s54, v27
    s_or_b64 vcc, vcc, s[56:57]
    s_cbranch_vccz L_ok_4
    s_sleep 24
    s_sub_u32 s59, s59, 1
    s_cmp_lg_u32 s59, 0
    s_cbranch_scc1 L_qpoll_3
    v_mov_b32 v248, 1
    v_mov_b32 v249, 4
    global_store_dword v249, v248, s[24:25]
L_ok_4:
    v_mov_b32 v25, v26
    v_lshlrev_b32 v9, 3, v2
    ds_write_b64 v9, v[24:25] offset:256
    v_mov_b32 v10, 1
    s_waitcnt lgkmcnt(0)
    ds_write_b32 v15, v10 offset:0
L_role:
    s_setprio 0
    v_mov_b32 v16, 1
    s_mov_b64 exec, 1
    ds_add_u32 v15, v16 offset:120
    s_mov_b64 exec, -1
    s_mov_b32 s49, 0
    s_mov_b32 s50, 0
    s_mov_b32 s51, 0
    s_and_b32 s52, s2, 3
    s_lshr_b32 s53, s2, 3
    s_cmp_ge_u32 s53, 14
    s_cbranch_scc1 L_role_hi
    s_mul_i32 s55, s52, 7
    s_lshr_b32 s56, s53, 1
    s_and_b32 s53, s53, 1
    s_bitcmp1_b32 s2, 2
    s_cbranch_scc1 L_role_ffn
    s_mov_b32 s49, 1
    s_mov_b32 s50, s52
    s_lshl_b32 s51, s56, 1
    s_add_u32 s51, s51, s53
    s_branch L_role_done
L_role_ffn:
    s_mov_b32 s49, 2
    s_add_u32 s50, s55, s56
    s_lshl_b32 s50, s50, 1
    s_add_u32 s50, s50, s53
    s_branch L_role_done
L_role_hi:
    s_bitcmp1_b32 s2, 2
    s_cbranch_scc0 L_role_a
    s_sub_u32 s53, s53, 14
    s_cmp_lt_u32 s53, 14
    s_cbranch_scc1 L_role_pf
    s_sub_u32 s53, s53, 14
    s_lshl_b32 s53, s53, 2
    s_add_u32 s53, s53, s52
    s_cmp_ge_u32 s53, 14
    s_cbranch_scc1 L_role_done
    s_mov_b32 s49, 3
    s_mov_b32 s50, s53
    s_branch L_role_done
L_role_pf:
    s_mov_b32 s49, 4
    s_mov_b32 s50, s53
    s_mov_b32 s51, s52
L_role_a:
L_role_done:
    s_mov_b32 s80, 0
    s_mov_b32 s81, 384
    s_mov_b32 s82, 0
    s_mov_b32 s92, 0
    s_lshl_b32 s63, s2, 7
    s_add_u32 s63, s63, 786432
    s_add_u32 s84, s2, 33
    s_and_b32 s84, s84, 0xff
    s_lshl_b32 s84, s84, 7
    s_add_u32 s84, s84, 786432
    s_add_u32 s85, s2, 66
    s_and_b32 s85, s85, 0xff
    s_lshl_b32 s85, s85, 7
    s_add_u32 s85, s85, 786432
    s_add_u32 s86, s2, 99
    s_and_b32 s86, s86, 0xff
    s_lshl_b32 s86, s86, 7
    s_add_u32 s86, s86, 786432
    s_add_u32 s87, s2, 132
    s_and_b32 s87, s87, 0xff
    s_lshl_b32 s87, s87, 7
    s_add_u32 s87, s87, 786432
    s_add_u32 s88, s2, 165
    s_and_b32 s88, s88, 0xff
    s_lshl_b32 s88, s88, 7
    s_add_u32 s88, s88, 786432
    s_add_u32 s89, s2, 198
    s_and_b32 s89, s89, 0xff
    s_lshl_b32 s89, s89, 7
    s_add_u32 s89, s89, 786432
    s_add_u32 s90, s2, 231
    s_and_b32 s90, s90, 0xff
    s_lshl_b32 s90, s90, 7
    s_add_u32 s90, s90, 786432
    s_add_u32 s91, s2, 264
    s_and_b32 s91, s91, 0xff
    s_lshl_b32 s91, s91, 7
    s_add_u32 s91, s91, 786432
L_spin_5:
    ds_read_b32 v16, v15 offset:120
    s_waitcnt lgkmcnt(0)
    v_readfirstlane_b32 s58, v16
    s_cmp_ge_u32 s58, 4
    s_cbranch_scc1 L_spun_6
    s_sleep 8
    s_branch L_spin_5
L_spun_6:
L_spin_7:
    ds_read_b32 v16, v15 offset:24
    s_waitcnt lgkmcnt(0)
    v_readfirstlane_b32 s58, v16
    s_cmp_ge_u32 s58, 1
    s_cbranch_scc1 L_spun_8
    s_sleep 8
    s_branch L_spin_7
L_spun_8:
    s_cmp_lg_u32 s2, 0
    s_cbranch_scc1 L_noprobe
    s_cmp_lg_u32 s48, 2
    s_cbranch_scc1 L_noprobe
    s_add_u32 s64, s26, 531456
    s_addc_u32 s65, s27, 0
    s_mov_b32 s66, -1
    s_mov_b32 s67, -1
    s_mov_b32 s57, 16
L_probe:
    s_memtime s[68:69]
    s_waitcnt lgkmcnt(0)
    s_load_dword s72, s[64:65], 0 glc
    s_waitcnt lgkmcnt(0)
    s_memtime s[70:71]
    s_waitcnt lgkmcnt(0)
    s_sub_u32 s70, s70, s68
    s_min_u32 s66, s66, s70
    s_memtime s[68:69]
    s_waitcnt lgkmcnt(0)
    s_load_dword s72, s[64:65], 8192 glc
    s_waitcnt lgkmcnt(0)
    s_memtime s[70:71]
    s_waitcnt lgkmcnt(0)
    s_sub_u32 s70, s70, s68
    s_min_u32 s67, s67, s70
    s_sub_u32 s57, s57, 1
    s_cmp_lg_u32 s57, 0
    s_cbranch_scc1 L_probe
    s_cmp_le_u32 s66, s67
    s_cselect_b32 s58, 0, 0x2000
    v_mov_b32 v16, s58
    v_mov_b32 v17, s54
    s_mov_b64 exec, 1
    buffer_store_dwordx2 v[16:17], v15, s[36:39], 0 offen offset:2048 sc1
    s_mov_b64 exec, -1
L_noprobe:
    s_cmp_eq_u32 s49, 1
    s_cbranch_scc1 L_w_wo
    s_cmp_eq_u32 s49, 2
    s_cbranch_scc1 L_w_ffn
    s_branch L_w_done
L_w_wo:
    s_mov_b32 s32, s12
    s_and_b32 s33, s13, 0xffff
    s_mov_b32 s34, 3670016
    s_mov_b32 s35, 0x20000
    v_lshrrev_b32 v84, 2, v2
    v_mul_u32_u24 v84, 896, v84
    v_lshl_add_u32 v84, v12, 4, v84
    s_lshl_b32 s94, s50, 2
    s_add_u32 s94, s94, s48
    s_mul_i32 s53, s94, 229376
    s_lshl_b32 s55, s51, 6
    s_add_u32 s53, s53, s55
    s_lshl_b32 s55, s48, 14
    s_add_u32 s55, s55, 19456
    s_mov_b32 s56, s55
    s_mov_b32 s57, 16
L_paced_9:
    s_mov_b32 m0, s56
    s_nop 0
    buffer_load_dwordx4 v84, s[32:35], s53 offen  lds
    s_add_u32 s53, s53, 14336
    s_add_u32 s56, s56, 0x400
    s_waitcnt vmcnt(0)
    s_cmp_lg_u32 s48, 3
    s_cbranch_scc1 L_noctl_10
    ds_read_b128 v[16:19], v15 offset:96
    s_cmp_ge_u32 s80, 6
    s_waitcnt lgkmcnt(0)
    s_cbranch_scc1 L_ctl_out_11
    v_add_u32 v16, v16, v17
    v_add3_u32 v16, v16, v18, v19
    v_mov_b32 v19, s54
    v_readfirstlane_b32 s83, v16
    s_mov_b32 s15, s83
    s_add_u32 s58, s15, 32
    s_cmp_lt_u32 s58, s81
    s_cbranch_scc1 L_ctl_poll_12
    s_cmp_gt_u32 s92, s80
    s_cbranch_scc1 L_ctl_ann_13
    s_add_u32 s92, s80, 1
    v_mov_b32 v18, s92
    s_mov_b64 exec, 1
    buffer_store_dwordx2 v[18:19], v15, s[36:39], s63 offen sc1
    s_mov_b64 exec, -1
L_ctl_ann_13:
    s_cmp_lt_u32 s15, s81
    s_cbranch_scc1 L_ctl_poll_12
    s_add_u32 s80, s80, 1
    s_add_u32 s81, s81, 304
    s_mov_b32 s82, 0
    s_branch L_ctl_out_11
L_ctl_poll_12:
    s_cmp_lg_u32 s82, 0
    s_cbranch_scc1 L_ctl_out_11
    s_add_u32 s58, s15, 80
    s_cmp_lt_u32 s58, s81
    s_cbranch_scc1 L_ctl_out_11
    s_load_dwordx2 s[64:65], s[26:27], s84 glc
    s_load_dwordx2 s[66:67], s[26:27], s85 glc
    s_load_dwordx2 s[68:69], s[26:27], s86 glc
    s_load_dwordx2 s[70:71], s[26:27], s87 glc
    s_load_dwordx2 s[72:73], s[26:27], s88 glc
    s_load_dwordx2 s[74:75], s[26:27], s89 glc
    s_load_dwordx2 s[76:77], s[26:27], s90 glc
    s_load_dwordx2 s[78:79], s[26:27], s91 glc
    s_mov_b32 s58, 0
    s_waitcnt lgkmcnt(0)
    s_cmp_eq_u32 s65, s54
    s_cselect_b32 s64, s64, 0
    s_cmp_gt_u32 s64, s80
    s_addc_u32 s58, s58, 0
    s_cmp_eq_u32 s67, s54
    s_cselect_b32 s66, s66, 0
    s_cmp_gt_u32 s66, s80
    s_addc_u32 s58, s58, 0
    s_cmp_eq_u32 s69, s54
    s_cselect_b32 s68, s68, 0
    s_cmp_gt_u32 s68, s80
    s_addc_u32 s58, s58, 0
    s_cmp_eq_u32 s71, s54
    s_cselect_b32 s70, s70, 0
    s_cmp_gt_u32 s70, s80
    s_addc_u32 s58, s58, 0
    s_cmp_eq_u32 s73, s54
    s_cselect_b32 s72, s72, 0
    s_cmp_gt_u32 s72, s80
    s_addc_u32 s58, s58, 0
    s_cmp_eq_u32 s75, s54
    s_cselect_b32 s74, s74, 0
    s_cmp_gt_u32 s74, s80
    s_addc_u32 s58, s58, 0
    s_cmp_eq_u32 s77, s54
    s_cselect_b32 s76, s76, 0
    s_cmp_gt_u32 s76, s80
    s_addc_u32 s58, s58, 0
    s_cmp_eq_u32 s79, s54
    s_cselect_b32 s78, s78, 0
    s_cmp_gt_u32 s78, s80
    s_addc_u32 s58, s58, 0
    s_cmp_lt_u32 s58, 4
    s_cbranch_scc1 L_ctl_out_11
    s_sub_u32 s58, s81, s15
    s_mul_i32 s58, s58, 4
    s_add_u32 s58, s58, s83
    s_lshr_b32 s58, s58, 2
    v_mov_b32 v16, s58
    s_mov_b32 s82, 1
    ds_write_b32 v15, v16 offset:28
L_ctl_out_11:
L_noctl_10:
    s_sub_u32 s57, s57, 1
    s_cmp_lg_u32 s57, 0
    s_cbranch_scc1 L_paced_9
    s_waitcnt vmcnt(0)
    v_lshlrev_b32 v85, 6, v11
    v_lshl_add_u32 v85, v12, 3, v85
    v_add_u32 v85, s55, v85
    ds_read_b64_tr_b16 v[96:97], v85 offset:0
    ds_read_b64_tr_b16 v[98:99], v85 offset:256
    ds_read_b64_tr_b16 v[100:101], v85 offset:32
    ds_read_b64_tr_b16 v[102:103], v85 offset:288
    s_waitcnt lgkmcnt(8)
    ds_read_b64_tr_b16 v[104:105], v85 offset:2048
    ds_read_b64_tr_b16 v[106:107], v85 offset:2304
    ds_read_b64_tr_b16 v[108:109], v85 offset:2080
    ds_read_b64_tr_b16 v[110:111], v85 offset:2336
    s_waitcnt lgkmcnt(8)
    ds_read_b64_tr_b16 v[112:113], v85 offset:4096
    ds_read_b64_tr_b16 v[114:115], v85 offset:4352
    ds_read_b64_tr_b16 v[116:117], v85 offset:4128
    ds_read_b64_tr_b16 v[118:119], v85 offset:4384
    s_waitcnt lgkmcnt(8)
    ds_read_b64_tr_b16 v[120:121], v85 offset:6144
    ds_read_b64_tr_b16 v[122:123], v85 offset:6400
    ds_read_b64_tr_b16 v[124:125], v85 offset:6176
    ds_read_b64_tr_b16 v[126:127], v85 offset:6432
    s_waitcnt lgkmcnt(8)
    ds_read_b64_tr_b16 v[128:129], v85 offset:8192
    ds_read_b64_tr_b16 v[130:131], v85 offset:8448
    ds_read_b64_tr_b16 v[132:133], v85 offset:8224
    ds_read_b64_tr_b16 v[134:135], v85 offset:8480
    s_waitcnt lgkmcnt(8)
    ds_read_b64_tr_b16 v[136:137], v85 offset:10240
    ds_read_b64_tr_b16 v[138:139], v85 offset:10496
    ds_read_b64_tr_b16 v[140:141], v85 offset:10272
    ds_read_b64_tr_b16 v[142:143], v85 offset:10528
    s_waitcnt lgkmcnt(8)
    ds_read_b64_tr_b16 v[144:145], v85 offset:12288
    ds_read_b64_tr_b16 v[146:147], v85 offset:12544
    ds_read_b64_tr_b16 v[148:149], v85 offset:12320
    ds_read_b64_tr_b16 v[150:151], v85 offset:12576
    s_waitcnt lgkmcnt(8)
    ds_read_b64_tr_b16 v[152:153], v85 offset:14336
    ds_read_b64_tr_b16 v[154:155], v85 offset:14592
    ds_read_b64_tr_b16 v[156:157], v85 offset:14368
    ds_read_b64_tr_b16 v[158:159], v85 offset:14624
    s_waitcnt lgkmcnt(8)
    s_waitcnt lgkmcnt(0)
    s_branch L_w_done
L_w_ffn:
    s_mov_b32 s32, s16
    s_and_b32 s33, s17, 0xffff
    s_mov_b32 s34, 1605632
    s_mov_b32 s35, 0x20000
    v_lshrrev_b32 v84, 2, v2
    v_mul_u32_u24 v84, 3584, v84
    v_lshl_add_u32 v84, v12, 4, v84
    s_mul_i32 s53, s48, 401408
    s_lshl_b32 s55, s50, 6
    s_add_u32 s53, s53, s55
    s_mul_i32 s56, s48, 7168
    s_add_u32 s56, s56, 19456
    s_mov_b32 s57, 7
L_paced_14:
    s_mov_b32 m0, s56
    s_nop 0
    buffer_load_dwordx4 v84, s[32:35], s53 offen  lds
    s_add_u32 s53, s53, 57344
    s_add_u32 s56, s56, 0x400
    s_waitcnt vmcnt(0)
    s_cmp_lg_u32 s48, 3
    s_cbranch_scc1 L_noctl_15
    ds_read_b128 v[16:19], v15 offset:96
    s_cmp_ge_u32 s80, 6
    s_waitcnt lgkmcnt(0)
    s_cbranch_scc1 L_ctl_out_16
    v_add_u32 v16, v16, v17
    v_add3_u32 v16, v16, v18, v19
    v_mov_b32 v19, s54
    v_readfirstlane_b32 s83, v16
    s_mov_b32 s15, s83
    s_add_u32 s58, s15, 32
    s_cmp_lt_u32 s58, s81
    s_cbranch_scc1 L_ctl_poll_17
    s_cmp_gt_u32 s92, s80
    s_cbranch_scc1 L_ctl_ann_18
    s_add_u32 s92, s80, 1
    v_mov_b32 v18, s92
    s_mov_b64 exec, 1
    buffer_store_dwordx2 v[18:19], v15, s[36:39], s63 offen sc1
    s_mov_b64 exec, -1
L_ctl_ann_18:
    s_cmp_lt_u32 s15, s81
    s_cbranch_scc1 L_ctl_poll_17
    s_add_u32 s80, s80, 1
    s_add_u32 s81, s81, 304
    s_mov_b32 s82, 0
    s_branch L_ctl_out_16
L_ctl_poll_17:
    s_cmp_lg_u32 s82, 0
    s_cbranch_scc1 L_ctl_out_16
    s_add_u32 s58, s15, 80
    s_cmp_lt_u32 s58, s81
    s_cbranch_scc1 L_ctl_out_16
    s_load_dwordx2 s[64:65], s[26:27], s84 glc
    s_load_dwordx2 s[66:67], s[26:27], s85 glc
    s_load_dwordx2 s[68:69], s[26:27], s86 glc
    s_load_dwordx2 s[70:71], s[26:27], s87 glc
    s_load_dwordx2 s[72:73], s[26:27], s88 glc
    s_load_dwordx2 s[74:75], s[26:27], s89 glc
    s_load_dwordx2 s[76:77], s[26:27], s90 glc
    s_load_dwordx2 s[78:79], s[26:27], s91 glc
    s_mov_b32 s58, 0
    s_waitcnt lgkmcnt(0)
    s_cmp_eq_u32 s65, s54
    s_cselect_b32 s64, s64, 0
    s_cmp_gt_u32 s64, s80
    s_addc_u32 s58, s58, 0
    s_cmp_eq_u32 s67, s54
    s_cselect_b32 s66, s66, 0
    s_cmp_gt_u32 s66, s80
    s_addc_u32 s58, s58, 0
    s_cmp_eq_u32 s69, s54
    s_cselect_b32 s68, s68, 0
    s_cmp_gt_u32 s68, s80
    s_addc_u32 s58, s58, 0
    s_cmp_eq_u32 s71, s54
    s_cselect_b32 s70, s70, 0
    s_cmp_gt_u32 s70, s80
    s_addc_u32 s58, s58, 0
    s_cmp_eq_u32 s73, s54
    s_cselect_b32 s72, s72, 0
    s_cmp_gt_u32 s72, s80
    s_addc_u32 s58, s58, 0
    s_cmp_eq_u32 s75, s54
    s_cselect_b32 s74, s74, 0
    s_cmp_gt_u32 s74, s80
    s_addc_u32 s58, s58, 0
    s_cmp_eq_u32 s77, s54
    s_cselect_b32 s76, s76, 0
    s_cmp_gt_u32 s76, s80
    s_addc_u32 s58, s58, 0
    s_cmp_eq_u32 s79, s54
    s_cselect_b32 s78, s78, 0
    s_cmp_gt_u32 s78, s80
    s_addc_u32 s58, s58, 0
    s_cmp_lt_u32 s58, 4
    s_cbranch_scc1 L_ctl_out_16
    s_sub_u32 s58, s81, s15
    s_mul_i32 s58, s58, 4
    s_add_u32 s58, s58, s83
    s_lshr_b32 s58, s58, 2
    v_mov_b32 v16, s58
    s_mov_b32 s82, 1
    ds_write_b32 v15, v16 offset:28
L_ctl_out_16:
L_noctl_15:
    s_sub_u32 s57, s57, 1
    s_cmp_lg_u32 s57, 0
    s_cbranch_scc1 L_paced_14
L_w_done:
    s_cmp_lg_u32 s48, 1
    s_cbranch_scc1 L_noml
    v_lshlrev_b32 v9, 4, v2
L_spin_19:
    ds_read_b32 v20, v15 offset:20
    s_waitcnt lgkmcnt(0)
    v_readfirstlane_b32 s58, v20
    s_cmp_ge_u32 s58, 4
    s_cbranch_scc1 L_spun_20
    s_sleep 16
    s_branch L_spin_19
L_spun_20:
    v_lshlrev_b32 v10, 3, v3
    ds_read_b64 v[20:21], v10 offset:64
    s_lshl_b32 s53, s2, 6
    s_add_u32 s53, s53, 73728
    v_mov_b32 v23, s54
    s_waitcnt lgkmcnt(0)
    v_mov_b32 v22, v21
    v_mov_b32 v21, s54
    s_waitcnt vmcnt(0)
    s_mov_b64 exec, 15
    buffer_store_dwordx4 v[20:23], v9, s[36:39], s53 offen sc1
    s_mov_b64 exec, -1
    s_mov_b32 s59, 262144
L_par_21:
    buffer_load_dwordx2 v[16:17], v15, s[36:39], 0 offen offset:2048 sc1
    s_waitcnt vmcnt(0)
    v_cmp_ne_u32 vcc, s54, v17
    s_cbranch_vccz L_ok_22
    s_sleep 32
    s_sub_u32 s59, s59, 1
    s_cmp_lg_u32 s59, 0
    s_cbranch_scc1 L_par_21
    v_mov_b32 v248, 9
    v_mov_b32 v249, 36
    global_store_dword v249, v248, s[24:25]
L_ok_22:
    v_and_b32 v16, 0x2000, v16
    ds_write_b32 v15, v16 offset:112
    v_lshlrev_b32 v9, 4, v3
    s_lshr_b32 s53, s2, 2
    s_lshl_b32 s53, s53, 8
    s_add_u32 s53, s53, 73728
    s_mov_b32 s59, 262144
L_spin_23:
    ds_read_b32 v16, v15 offset:48
    s_waitcnt lgkmcnt(0)
    v_readfirstlane_b32 s58, v16
    s_cmp_ge_u32 s58, 1
    s_cbranch_scc1 L_spun_24
    s_sleep 16
    s_branch L_spin_23
L_spun_24:
L_ml_25:
    buffer_load_dwordx4 v[16:19], v9, s[36:39], s53 offen sc1
    s_waitcnt vmcnt(0)
    v_cmp_ne_u32 vcc, s54, v17
    v_cmp_ne_u32 s[56:57], s54, v19
    s_or_b64 vcc, vcc, s[56:57]
    s_cbranch_vccz L_ok_26
    s_sleep 16
    s_sub_u32 s59, s59, 1
    s_cmp_lg_u32 s59, 0
    s_cbranch_scc1 L_ml_25
    v_mov_b32 v248, 3
    v_mov_b32 v249, 12
    global_store_dword v249, v248, s[24:25]
L_ok_26:
    v_mov_b32 v17, v16
    s_nop 1
    v_max_f32_dpp v17, v17, v17 quad_perm:[1,0,3,2] row_mask:0xf bank_mask:0xf
    s_nop 1
    v_max_f32_dpp v17, v17, v17 quad_perm:[2,3,0,1] row_mask:0xf bank_mask:0xf
    s_nop 1
    v_max_f32_dpp v17, v17, v17 row_half_mirror row_mask:0xf bank_mask:0xf
    s_nop 1
    v_max_f32_dpp v17, v17, v17 row_mirror row_mask:0xf bank_mask:0xf
    s_nop 1
    v_sub_f32 v17, v16, v17
    v_mul_f32 v17, 0x3db8aa3b, v17
    v_exp_f32 v17, v17
    s_nop 0
    v_mul_f32 v19, v17, v18
    s_nop 1
    v_add_f32_dpp v19, v19, v19 quad_perm:[1,0,3,2] row_mask:0xf bank_mask:0xf
    s_nop 1
    v_add_f32_dpp v19, v19, v19 quad_perm:[2,3,0,1] row_mask:0xf bank_mask:0xf
    s_nop 1
    v_add_f32_dpp v19, v19, v19 row_half_mirror row_mask:0xf bank_mask:0xf
    s_nop 1
    v_add_f32_dpp v19, v19, v19 row_mirror row_mask:0xf bank_mask:0xf
    s_nop 1
    v_rcp_f32 v19, v19
    s_nop 0
    v_mul_f32 v17, v17, v19
    v_min_u32 v17, 0xfffffffe, v17
    v_lshlrev_b32 v10, 2, v12
    s_and_b32 s53, s2, 3
    s_lshl_b32 s53, s53, 2
    s_lshl_b64 exec, 15, s53
    ds_write_b32 v10, v17 offset:32
    s_mov_b64 exec, -1
    s_cmp_lg_u32 s49, 1
    s_cbranch_scc1 L_noml
    v_lshlrev_b32 v10, 6, v4
    v_add_u32 v10, v10, v3
    v_lshlrev_b32 v10, 6, v10
    s_lshl_b32 s53, s50, 10
    s_add_u32 s53, s53, 73728
    s_mov_b32 s59, 262144
L_clr_27:
    buffer_load_dword v16, v10, s[36:39], s53 offen offset:4 sc1
    s_waitcnt vmcnt(0)
    v_cmp_ne_u32 vcc, s54, v16
    s_cbranch_vccz L_ok_28
    s_sleep 16
    s_sub_u32 s59, s59, 1
    s_cmp_lg_u32 s59, 0
    s_cbranch_scc1 L_clr_27
    v_mov_b32 v248, 2
    v_mov_b32 v249, 8
    global_store_dword v249, v248, s[24:25]
L_ok_28:
    v_mov_b32 v10, 1
    ds_write_b32 v15, v10 offset:8
L_noml:
    s_cmp_lg_u32 s48, 3
    s_cbranch_scc1 L_noctl
L_ctl:
    ds_read_b128 v[16:19], v15 offset:96
    s_cmp_ge_u32 s80, 6
    s_waitcnt lgkmcnt(0)
    s_cbranch_scc1 L_ctl_out_29
    v_add_u32 v16, v16, v17
    v_add3_u32 v16, v16, v18, v19
    v_mov_b32 v19, s54
    v_readfirstlane_b32 s83, v16
    s_mov_b32 s15, s83
    s_add_u32 s58, s15, 32
    s_cmp_lt_u32 s58, s81
    s_cbranch_scc1 L_ctl_poll_30
    s_cmp_gt_u32 s92, s80
    s_cbranch_scc1 L_ctl_ann_31
    s_add_u32 s92, s80, 1
    v_mov_b32 v18, s92
    s_mov_b64 exec, 1
    buffer_store_dwordx2 v[18:19], v15, s[36:39], s63 offen sc1
    s_mov_b64 exec, -1
L_ctl_ann_31:
    s_cmp_lt_u32 s15, s81
    s_cbranch_scc1 L_ctl_poll_30
    s_add_u32 s80, s80, 1
    s_add_u32 s81, s81, 304
    s_mov_b32 s82, 0
    s_branch L_ctl_out_29
L_ctl_poll_30:
    s_cmp_lg_u32 s82, 0
    s_cbranch_scc1 L_ctl_out_29
    s_add_u32 s58, s15, 80
    s_cmp_lt_u32 s58, s81
    s_cbranch_scc1 L_ctl_out_29
    s_load_dwordx2 s[64:65], s[26:27], s84 glc
    s_load_dwordx2 s[66:67], s[26:27], s85 glc
    s_load_dwordx2 s[68:69], s[26:27], s86 glc
    s_load_dwordx2 s[70:71], s[26:27], s87 glc
    s_load_dwordx2 s[72:73], s[26:27], s88 glc
    s_load_dwordx2 s[74:75], s[26:27], s89 glc
    s_load_dwordx2 s[76:77], s[26:27], s90 glc
    s_load_dwordx2 s[78:79], s[26:27], s91 glc
    s_mov_b32 s58, 0
    s_waitcnt lgkmcnt(0)
    s_cmp_eq_u32 s65, s54
    s_cselect_b32 s64, s64, 0
    s_cmp_gt_u32 s64, s80
    s_addc_u32 s58, s58, 0
    s_cmp_eq_u32 s67, s54
    s_cselect_b32 s66, s66, 0
    s_cmp_gt_u32 s66, s80
    s_addc_u32 s58, s58, 0
    s_cmp_eq_u32 s69, s54
    s_cselect_b32 s68, s68, 0
    s_cmp_gt_u32 s68, s80
    s_addc_u32 s58, s58, 0
    s_cmp_eq_u32 s71, s54
    s_cselect_b32 s70, s70, 0
    s_cmp_gt_u32 s70, s80
    s_addc_u32 s58, s58, 0
    s_cmp_eq_u32 s73, s54
    s_cselect_b32 s72, s72, 0
    s_cmp_gt_u32 s72, s80
    s_addc_u32 s58, s58, 0
    s_cmp_eq_u32 s75, s54
    s_cselect_b32 s74, s74, 0
    s_cmp_gt_u32 s74, s80
    s_addc_u32 s58, s58, 0
    s_cmp_eq_u32 s77, s54
    s_cselect_b32 s76, s76, 0
    s_cmp_gt_u32 s76, s80
    s_addc_u32 s58, s58, 0
    s_cmp_eq_u32 s79, s54
    s_cselect_b32 s78, s78, 0
    s_cmp_gt_u32 s78, s80
    s_addc_u32 s58, s58, 0
    s_cmp_lt_u32 s58, 4
    s_cbranch_scc1 L_ctl_out_29
    s_sub_u32 s58, s81, s15
    s_mul_i32 s58, s58, 4
    s_add_u32 s58, s58, s83
    s_lshr_b32 s58, s58, 2
    v_mov_b32 v16, s58
    s_mov_b32 s82, 1
    ds_write_b32 v15, v16 offset:28
L_ctl_out_29:
    s_sleep 8
    s_cmp_lt_u32 s80, 6
    s_cbranch_scc1 L_ctl
L_noctl:
    s_cmp_lg_u32 s49, 4
    s_cbranch_scc1 L_nopf
    s_lshl_b32 s53, s50, 2
    s_add_u32 s53, s53, s48
    s_mov_b32 s32, s18
    s_and_b32 s33, s19, 0xffff
    s_mov_b32 s34, 1605632
    s_mov_b32 s35, 0x20000
    s_mul_i32 s53, s53, 28672
    s_mul_i32 s55, s51, 896
    s_add_u32 s53, s53, s55
    v_mul_u32_u24 v9, 37, v2
    v_lshrrev_b32 v9, 8, v9
    v_mul_u32_u24 v10, 7, v9
    v_sub_u32 v10, v2, v10
    v_cmp_gt_u32 vcc, 56, v2
    v_mul_u32_u24 v9, 3584, v9
    v_lshl_add_u32 v9, v10, 7, v9
    v_cndmask_b32 v9, v7, v9, vcc
L_spin_32:
    ds_read_b32 v16, v15 offset:116
    s_waitcnt lgkmcnt(0)
    v_readfirstlane_b32 s58, v16
    s_cmp_ge_u32 s58, 1
    s_cbranch_scc1 L_spun_33
    s_sleep 2
    s_branch L_spin_32
L_spun_33:
    buffer_load_dword v16, v9, s[32:35], s53 offen
    s_waitcnt vmcnt(0)
    s_branch L_helper_end
L_nopf:
    s_cmp_eq_u32 s49, 0
    s_cbranch_scc1 L_helper_end
L_spin_34:
    ds_read_b32 v16, v15 offset:112
    s_waitcnt lgkmcnt(0)
    v_readfirstlane_b32 s58, v16
    s_cmp_lg_u32 s58, -1
    s_cbranch_scc1 L_spun_35
    s_sleep 16
    s_branch L_spin_34
L_spun_35:
    s_mov_b32 s60, s58
    s_xor_b32 s62, s58, 0x2000
    s_cmp_eq_u32 s49, 2
    s_cbranch_scc1 L_ffn
    s_cmp_eq_u32 s49, 3
    s_cbranch_scc1 L_final
    s_lshl_b32 s52, s50, 2
    s_add_u32 s52, s52, s48
    s_lshl_b32 s53, s52, 14
    s_add_u32 s53, s53, 262144
    s_add_u32 s53, s53, s60
    v_lshlrev_b32 v9, 6, v3
    v_lshl_add_u32 v9, v4, 4, v9
    v_add_u32 v51, 0x1000, v9
    v_lshlrev_b32 v10, 7, v12
    v_lshl_add_u32 v10, v4, 4, v10
    s_lshl_b32 s55, s48, 9
    v_add_u32 v10, s55, v10
    s_lshl_b32 s45, s50, 14
    s_lshl_b32 s46, s51, 7
    s_add_u32 s45, s45, s46
    s_add_u32 s45, s45, 524288
    s_add_u32 s45, s45, s62
    v_lshrrev_b32 v13, 3, v2
    v_mul_u32_u24 v13, 1792, v13
    v_and_b32 v14, 7, v2
    v_lshl_add_u32 v13, v14, 4, v13
    v_lshlrev_b32 v14, 4, v2
    s_mov_b32 s95, s53
L_spin_36:
    ds_read_b32 v48, v15 offset:8
    s_waitcnt lgkmcnt(0)
    v_readfirstlane_b32 s58, v48
    s_cmp_ge_u32 s58, 1
    s_cbranch_scc1 L_spun_37
    s_sleep 16
    s_branch L_spin_36
L_spun_37:
L_spin_38:
    ds_read_b32 v48, v15 offset:116
    s_waitcnt lgkmcnt(0)
    v_readfirstlane_b32 s58, v48
    s_cmp_ge_u32 s58, 1
    s_cbranch_scc1 L_spun_39
    s_sleep 2
    s_branch L_spin_38
L_spun_39:
    s_setprio 3
L_wo_go:
    s_mov_b32 s59, 262144
L_poll_40:
    buffer_load_dwordx4 v[16:19], v9, s[36:39], s95 offen offset:0 sc1
    buffer_load_dwordx4 v[20:23], v9, s[36:39], s95 offen offset:1024 sc1
    buffer_load_dwordx4 v[24:27], v9, s[36:39], s95 offen offset:2048 sc1
    buffer_load_dwordx4 v[28:31], v9, s[36:39], s95 offen offset:3072 sc1
    buffer_load_dwordx4 v[32:35], v51, s[36:39], s95 offen offset:0 sc1
    buffer_load_dwordx4 v[36:39], v51, s[36:39], s95 offen offset:1024 sc1
    buffer_load_dwordx4 v[40:43], v51, s[36:39], s95 offen offset:2048 sc1
    buffer_load_dwordx4 v[44:47], v51, s[36:39], s95 offen offset:3072 sc1
L_poll_40_check:
    s_waitcnt vmcnt(7)
    v_max3_u32 v48, v16, v17, v18
    v_max_u32 v48, v48, v19
    s_waitcnt vmcnt(6)
    v_max3_u32 v48, v48, v20, v21
    v_max3_u32 v48, v48, v22, v23
    s_waitcnt vmcnt(5)
    v_max3_u32 v48, v48, v24, v25
    v_max3_u32 v48, v48, v26, v27
    s_waitcnt vmcnt(4)
    v_max3_u32 v48, v48, v28, v29
    v_max3_u32 v48, v48, v30, v31
    s_waitcnt vmcnt(3)
    v_max3_u32 v48, v48, v32, v33
    v_max3_u32 v48, v48, v34, v35
    s_waitcnt vmcnt(2)
    v_max3_u32 v48, v48, v36, v37
    v_max3_u32 v48, v48, v38, v39
    s_waitcnt vmcnt(1)
    v_max3_u32 v48, v48, v40, v41
    v_max3_u32 v48, v48, v42, v43
    s_waitcnt vmcnt(0)
    v_max3_u32 v48, v48, v44, v45
    v_max3_u32 v48, v48, v46, v47
    v_cmp_eq_u32 vcc, -1, v48
    s_and_b64 exec, vcc, exec
    s_cbranch_scc0 L_got_41
    s_bcnt1_i32_b64 s58, exec
    s_cmp_le_u32 s58, 4
    s_cbranch_scc1 L_fast_42
    s_sleep 8
L_fast_42:
    s_sleep 1
    s_sub_u32 s59, s59, 1
    s_cmp_lg_u32 s59, 0
    s_cbranch_scc1 L_poll_40
    v_mov_b32 v248, 4
    v_mov_b32 v249, 16
    global_store_dword v249, v248, s[24:25]
L_got_41:
    s_mov_b64 exec, -1
    v_mfma_f32_16x16x32_bf16 v[52:55], v[96:99], v[16:19], 0
    v_mfma_f32_16x16x32_bf16 v[56:59], v[100:103], v[16:19], 0
    v_mfma_f32_16x16x32_bf16 v[52:55], v[104:107], v[20:23], v[52:55]
    v_mfma_f32_16x16x32_bf16 v[56:59], v[108:111], v[20:23], v[56:59]
    v_mfma_f32_16x16x32_bf16 v[52:55], v[112:115], v[24:27], v[52:55]
    v_mfma_f32_16x16x32_bf16 v[56:59], v[116:119], v[24:27], v[56:59]
    v_mfma_f32_16x16x32_bf16 v[52:55], v[120:123], v[28:31], v[52:55]
    v_mfma_f32_16x16x32_bf16 v[56:59], v[124:127], v[28:31], v[56:59]
    v_mfma_f32_16x16x32_bf16 v[52:55], v[128:131], v[32:35], v[52:55]
    v_mfma_f32_16x16x32_bf16 v[56:59], v[132:135], v[32:35], v[56:59]
    v_mfma_f32_16x16x32_bf16 v[52:55], v[136:139], v[36:39], v[52:55]
    v_mfma_f32_16x16x32_bf16 v[56:59], v[140:143], v[36:39], v[56:59]
    v_mfma_f32_16x16x32_bf16 v[52:55], v[144:147], v[40:43], v[52:55]
    v_mfma_f32_16x16x32_bf16 v[56:59], v[148:151], v[40:43], v[56:59]
    v_mfma_f32_16x16x32_bf16 v[52:55], v[152:155], v[44:47], v[52:55]
    v_mfma_f32_16x16x32_bf16 v[56:59], v[156:159], v[44:47], v[56:59]
    s_nop 6
    v_add_f32_dpp v52, v52, v52 row_ror:4 row_mask:0xf bank_mask:0xf
    v_add_f32_dpp v53, v53, v53 row_ror:4 row_mask:0xf bank_mask:0xf
    v_add_f32_dpp v54, v54, v54 row_ror:4 row_mask:0xf bank_mask:0xf
    v_add_f32_dpp v55, v55, v55 row_ror:4 row_mask:0xf bank_mask:0xf
    v_add_f32_dpp v56, v56, v56 row_ror:4 row_mask:0xf bank_mask:0xf
    v_add_f32_dpp v57, v57, v57 row_ror:4 row_mask:0xf bank_mask:0xf
    v_add_f32_dpp v58, v58, v58 row_ror:4 row_mask:0xf bank_mask:0xf
    v_add_f32_dpp v59, v59, v59 row_ror:4 row_mask:0xf bank_mask:0xf
    v_add_f32_dpp v52, v52, v52 row_ror:8 row_mask:0xf bank_mask:0xf
    v_add_f32_dpp v53, v53, v53 row_ror:8 row_mask:0xf bank_mask:0xf
    v_add_f32_dpp v54, v54, v54 row_ror:8 row_mask:0xf bank_mask:0xf
    v_add_f32_dpp v55, v55, v55 row_ror:8 row_mask:0xf bank_mask:0xf
    v_add_f32_dpp v56, v56, v56 row_ror:8 row_mask:0xf bank_mask:0xf
    v_add_f32_dpp v57, v57, v57 row_ror:8 row_mask:0xf bank_mask:0xf
    v_add_f32_dpp v58, v58, v58 row_ror:8 row_mask:0xf bank_mask:0xf
    v_add_f32_dpp v59, v59, v59 row_ror:8 row_mask:0xf bank_mask:0xf
    ds_write_b128 v10, v[52:55] offset:16896
    ds_write_b128 v10, v[56:59] offset:16960
    s_waitcnt vmcnt(0) lgkmcnt(0)
    s_barrier
    s_cmp_lg_u32 s48, 0
    s_cbranch_scc1 L_helper_end
    ds_read_b128 v[16:19], v14 offset:16896
    ds_read_b128 v[20:23], v14 offset:17408
    ds_read_b128 v[24:27], v14 offset:17920
    ds_read_b128 v[28:31], v14 offset:18432
    s_waitcnt lgkmcnt(2)
    v_pk_add_f32 v[16:17], v[16:17], v[20:21]
    v_pk_add_f32 v[18:19], v[18:19], v[22:23]
    s_waitcnt lgkmcnt(0)
    v_pk_add_f32 v[24:25], v[24:25], v[28:29]
    v_pk_add_f32 v[26:27], v[26:27], v[30:31]
    v_pk_add_f32 v[16:17], v[16:17], v[24:25]
    v_pk_add_f32 v[18:19], v[18:19], v[26:27]
    v_bfi_b32 v16, s61, v60, v16
    v_bfi_b32 v17, s61, v61, v17
    v_bfi_b32 v18, s61, v62, v18
    v_bfi_b32 v19, s61, v63, v19
    s_mov_b32 exec_lo, 0xffffffff
    s_mov_b32 exec_hi, 0x0
    buffer_store_dwordx4 v[16:19], v13, s[36:39], s45 offen sc1
    s_mov_b64 exec, -1
    s_branch L_helper_end
L_ffn:
    s_mul_i32 s53, s48, 896
    v_lshrrev_b32 v8, 1, v6
    buffer_load_dwordx2 v[64:65], v8, s[28:31], s53 offen
    buffer_load_dwordx2 v[66:67], v8, s[28:31], s53 offen offset:448
    s_mul_i32 s44, s48, 1792
    s_add_u32 s44, s44, 524288
    s_add_u32 s44, s44, s62
    s_add_u32 s45, s44, 16384
    s_add_u32 s46, s44, 32768
    s_add_u32 s47, s44, 49152
    v_lshlrev_b32 v9, 4, v2
    v_lshlrev_b32 v8, 3, v2
    v_add_u32 v8, s53, v8
    v_mul_u32_u24 v10, 896, v12
    v_lshl_add_u32 v10, v4, 4, v10
    v_and_b32 v13, 1, v4
    v_lshlrev_b32 v13, 3, v13
    v_lshrrev_b32 v14, 1, v4
    v_lshl_add_u32 v13, v14, 2, v13
    v_lshl_add_u32 v13, v12, 6, v13
    s_lshl_b32 s55, s48, 4
    v_add_u32 v13, s55, v13
    v_lshlrev_b32 v14, 6, v12
    v_lshl_add_u32 v14, v4, 4, v14
    v_add_u32 v14, 18944, v14
    v_lshlrev_b32 v68, 4, v4
    v_add_u32 v68, 19200, v68
    v_lshrrev_b32 v69, 2, v3
    v_cmp_eq_u32 vcc, 0, v69
    s_nop 1
    v_cndmask_b32 v72, v68, v14, vcc
    v_cmp_eq_u32 vcc, 1, v69
    s_nop 1
    v_cndmask_b32 v73, v68, v14, vcc
    v_cmp_eq_u32 vcc, 2, v69
    s_nop 1
    v_cndmask_b32 v74, v68, v14, vcc
    v_cmp_eq_u32 vcc, 3, v69
    s_nop 1
    v_cndmask_b32 v75, v68, v14, vcc
    v_mul_u32_u24 v14, 1792, v12
    v_lshl_add_u32 v14, v69, 6, v14
    v_lshl_add_u32 v14, v4, 4, v14
    s_lshl_b32 s52, s50, 14
    s_lshl_b32 s55, s48, 9
    s_add_u32 s52, s52, s55
    s_add_u32 s52, s52, 1048576
    s_add_u32 s52, s52, s62
    s_waitcnt vmcnt(0)
    v_lshlrev_b32 v76, 16, v64
    v_and_b32 v77, 0xffff0000, v64
    v_lshlrev_b32 v78, 16, v65
    v_and_b32 v79, 0xffff0000, v65
    v_lshlrev_b32 v80, 16, v66
    v_and_b32 v81, 0xffff0000, v66
    v_lshlrev_b32 v82, 16, v67
    v_and_b32 v83, 0xffff0000, v67
    v_mov_b32 v16, 0
    v_mov_b32 v17, 0
    v_mov_b32 v18, 0
    v_mov_b32 v19, 0
    v_mov_b32 v20, 0
    v_mov_b32 v21, 0
    v_mov_b32 v22, 0
    v_mov_b32 v23, 0
    v_mov_b32 v24, 0
    v_mov_b32 v25, 0
    v_mov_b32 v26, 0
    v_mov_b32 v27, 0
    v_mov_b32 v28, 0
    v_mov_b32 v29, 0
    v_mov_b32 v30, 0
    v_mov_b32 v31, 0
    v_mov_b32 v32, 0
    v_mov_b32 v33, 0
    v_mov_b32 v34, 0
    v_mov_b32 v35, 0
    v_mov_b32 v36, 0
    v_mov_b32 v37, 0
    v_mov_b32 v38, 0
    v_mov_b32 v39, 0
    v_mov_b32 v40, 0
    v_mov_b32 v41, 0
    v_mov_b32 v42, 0
    v_mov_b32 v43, 0
    v_mov_b32 v44, 0
    v_mov_b32 v45, 0
    v_mov_b32 v46, 0
    v_mov_b32 v47, 0
L_spin_43:
    ds_read_b32 v87, v15 offset:116
    s_waitcnt lgkmcnt(0)
    v_readfirstlane_b32 s58, v87
    s_cmp_ge_u32 s58, 1
    s_cbranch_scc1 L_spun_44
    s_sleep 1
    s_branch L_spin_43
L_spun_44:
    s_setprio 3
    s_mov_b32 s40, s20
    s_and_b32 s41, s21, 0xffff
    s_mov_b32 s42, 1605632
    s_mov_b32 s43, 0x20000
    v_lshlrev_b32 v84, 4, v2
    s_mul_i32 s53, s50, 28672
    s_mul_i32 s55, s48, 7168
    s_add_u32 s53, s53, s55
    s_add_u32 s56, s55, 76800
    s_mov_b32 s57, 7
L_paced_45:
    s_mov_b32 m0, s56
    s_nop 0
    buffer_load_dwordx4 v84, s[40:43], s53 offen nt lds
    s_add_u32 s53, s53, 1024
    s_add_u32 s56, s56, 0x400
    s_waitcnt vmcnt(7)
    s_sub_u32 s57, s57, 1
    s_cmp_lg_u32 s57, 0
    s_cbranch_scc1 L_paced_45
    s_mov_b32 s32, s18
    s_and_b32 s33, s19, 0xffff
    s_mov_b32 s34, 1605632
    s_mov_b32 s35, 0x20000
    v_lshrrev_b32 v84, 2, v2
    v_mul_u32_u24 v84, 3584, v84
    v_lshl_add_u32 v84, v12, 4, v84
    s_mul_i32 s53, s48, 401408
    s_lshl_b32 s55, s50, 6
    s_add_u32 s53, s53, s55
    s_mul_i32 s56, s48, 7168
    s_add_u32 s56, s56, 48128
    s_mov_b32 s57, 7
L_paced_47:
    s_mov_b32 m0, s56
    s_nop 0
    buffer_load_dwordx4 v84, s[32:35], s53 offen  lds
    s_add_u32 s53, s53, 57344
    s_add_u32 s56, s56, 0x400
    s_waitcnt vmcnt(7)
    s_sub_u32 s57, s57, 1
    s_cmp_lg_u32 s57, 0
    s_cbranch_scc1 L_paced_47
    s_waitcnt vmcnt(0)
    v_mov_b32 v85, 1
    s_mov_b64 exec, 1
    ds_add_u32 v15, v85 offset:12
    s_mov_b64 exec, -1
L_spin_49:
    ds_read_b32 v87, v15 offset:12
    s_waitcnt lgkmcnt(0)
    v_readfirstlane_b32 s58, v87
    s_cmp_ge_u32 s58, 4
    s_cbranch_scc1 L_spun_50
    s_branch L_spin_49
L_spun_50:
    s_mov_b32 exec_lo, 0xffffffff
    s_mov_b32 exec_hi, 0xffffff
    s_mov_b32 s59, 262144
    buffer_load_dwordx4 v[16:19], v9, s[36:39], s44 offen offset:0 sc1
    buffer_load_dwordx4 v[20:23], v9, s[36:39], s44 offen offset:896 sc1
    buffer_load_dwordx4 v[24:27], v9, s[36:39], s45 offen offset:0 sc1
    buffer_load_dwordx4 v[28:31], v9, s[36:39], s45 offen offset:896 sc1
    buffer_load_dwordx4 v[32:35], v9, s[36:39], s46 offen offset:0 sc1
    buffer_load_dwordx4 v[36:39], v9, s[36:39], s46 offen offset:896 sc1
    buffer_load_dwordx4 v[40:43], v9, s[36:39], s47 offen offset:0 sc1
    buffer_load_dwordx4 v[44:47], v9, s[36:39], s47 offen offset:896 sc1
    s_mov_b64 exec, -1
    v_lshlrev_b32 v85, 6, v11
    v_and_b32 v86, 1, v12
    v_lshl_add_u32 v85, v86, 3, v85
    v_lshrrev_b32 v86, 1, v12
    v_mul_u32_u24 v86, 28672, v86
    v_add_u32 v85, v85, v86
    s_lshl_b32 s55, s48, 4
    s_add_u32 s55, s55, 19456
    v_add_u32 v85, s55, v85
    ds_read_b64_tr_b16 v[96:97], v85 offset:0
    ds_read_b64_tr_b16 v[98:99], v85 offset:256
    ds_read_b64_tr_b16 v[100:101], v85 offset:2048
    ds_read_b64_tr_b16 v[102:103], v85 offset:2304
    s_waitcnt lgkmcnt(8)
    ds_read_b64_tr_b16 v[104:105], v85 offset:4096
    ds_read_b64_tr_b16 v[106:107], v85 offset:4352
    ds_read_b64_tr_b16 v[108:109], v85 offset:6144
    ds_read_b64_tr_b16 v[110:111], v85 offset:6400
    s_waitcnt lgkmcnt(8)
    ds_read_b64_tr_b16 v[112:113], v85 offset:8192
    ds_read_b64_tr_b16 v[114:115], v85 offset:8448
    ds_read_b64_tr_b16 v[116:117], v85 offset:10240
    ds_read_b64_tr_b16 v[118:119], v85 offset:10496
    s_waitcnt lgkmcnt(8)
    ds_read_b64_tr_b16 v[120:121], v85 offset:12288
    ds_read_b64_tr_b16 v[122:123], v85 offset:12544
    ds_read_b64_tr_b16 v[124:125], v85 offset:14336
    ds_read_b64_tr_b16 v[126:127], v85 offset:14592
    s_waitcnt lgkmcnt(8)
    ds_read_b64_tr_b16 v[128:129], v85 offset:16384
    ds_read_b64_tr_b16 v[130:131], v85 offset:16640
    ds_read_b64_tr_b16 v[132:133], v85 offset:18432
    ds_read_b64_tr_b16 v[134:135], v85 offset:18688
    s_waitcnt lgkmcnt(8)
    ds_read_b64_tr_b16 v[136:137], v85 offset:20480
    ds_read_b64_tr_b16 v[138:139], v85 offset:20736
    ds_read_b64_tr_b16 v[140:141], v85 offset:22528
    ds_read_b64_tr_b16 v[142:143], v85 offset:22784
    s_waitcnt lgkmcnt(8)
    ds_read_b64_tr_b16 v[144:145], v85 offset:24576
    ds_read_b64_tr_b16 v[146:147], v85 offset:24832
    ds_read_b64_tr_b16 v[148:149], v85 offset:26624
    ds_read_b64_tr_b16 v[150:151], v85 offset:26880
    s_waitcnt lgkmcnt(8)
    v_mul_u32_u24 v85, 896, v11
    v_lshl_add_u32 v85, v12, 3, v85
    s_lshl_b32 s55, s48, 8
    s_add_u32 s55, s55, 76800
    v_add_u32 v85, s55, v85
    ds_read_b64_tr_b16 v[152:153], v85 offset:0
    ds_read_b64_tr_b16 v[154:155], v85 offset:3584
    ds_read_b64_tr_b16 v[156:157], v85 offset:32
    ds_read_b64_tr_b16 v[158:159], v85 offset:3616
    s_waitcnt lgkmcnt(8)
    ds_read_b64_tr_b16 v[160:161], v85 offset:64
    ds_read_b64_tr_b16 v[162:163], v85 offset:3648
    ds_read_b64_tr_b16 v[164:165], v85 offset:96
    ds_read_b64_tr_b16 v[166:167], v85 offset:3680
    s_waitcnt lgkmcnt(8)
    ds_read_b64_tr_b16 v[168:169], v85 offset:128
    ds_read_b64_tr_b16 v[170:171], v85 offset:3712
    ds_read_b64_tr_b16 v[172:173], v85 offset:160
    ds_read_b64_tr_b16 v[174:175], v85 offset:3744
    s_waitcnt lgkmcnt(8)
    ds_read_b64_tr_b16 v[176:177], v85 offset:192
    ds_read_b64_tr_b16 v[178:179], v85 offset:3776
    ds_read_b64_tr_b16 v[180:181], v85 offset:224
    ds_read_b64_tr_b16 v[182:183], v85 offset:3808
    s_waitcnt lgkmcnt(8)
    s_waitcnt lgkmcnt(0)
    s_mov_b32 exec_lo, 0xffffffff
    s_mov_b32 exec_hi, 0xffffff
    s_branch L_poll_51_check
L_poll_51:
    buffer_load_dwordx4 v[16:19], v9, s[36:39], s44 offen offset:0 sc1
    buffer_load_dwordx4 v[20:23], v9, s[36:39], s44 offen offset:896 sc1
    buffer_load_dwordx4 v[24:27], v9, s[36:39], s45 offen offset:0 sc1
    buffer_load_dwordx4 v[28:31], v9, s[36:39], s45 offen offset:896 sc1
    buffer_load_dwordx4 v[32:35], v9, s[36:39], s46 offen offset:0 sc1
    buffer_load_dwordx4 v[36:39], v9, s[36:39], s46 offen offset:896 sc1
    buffer_load_dwordx4 v[40:43], v9, s[36:39], s47 offen offset:0 sc1
    buffer_load_dwordx4 v[44:47], v9, s[36:39], s47 offen offset:896 sc1
L_poll_51_check:
    s_waitcnt vmcnt(7)
    v_xor_b32 v16, v16, v60
    v_xor_b32 v17, v17, v61
    v_xor_b32 v18, v18, v62
    v_xor_b32 v19, v19, v63
    v_or_b32 v48, v16, v17
    v_or_b32 v49, v18, v19
    s_waitcnt vmcnt(6)
    v_xor_b32 v20, v20, v60
    v_xor_b32 v21, v21, v61
    v_xor_b32 v22, v22, v62
    v_xor_b32 v23, v23, v63
    v_or3_b32 v48, v48, v20, v21
    v_or3_b32 v49, v49, v22, v23
    s_waitcnt vmcnt(5)
    v_xor_b32 v24, v24, v60
    v_xor_b32 v25, v25, v61
    v_xor_b32 v26, v26, v62
    v_xor_b32 v27, v27, v63
    v_or3_b32 v48, v48, v24, v25
    v_or3_b32 v49, v49, v26, v27
    s_waitcnt vmcnt(4)
    v_xor_b32 v28, v28, v60
    v_xor_b32 v29, v29, v61
    v_xor_b32 v30, v30, v62
    v_xor_b32 v31, v31, v63
    v_or3_b32 v48, v48, v28, v29
    v_or3_b32 v49, v49, v30, v31
    s_waitcnt vmcnt(3)
    v_xor_b32 v32, v32, v60
    v_xor_b32 v33, v33, v61
    v_xor_b32 v34, v34, v62
    v_xor_b32 v35, v35, v63
    v_or3_b32 v48, v48, v32, v33
    v_or3_b32 v49, v49, v34, v35
    s_waitcnt vmcnt(2)
    v_xor_b32 v36, v36, v60
    v_xor_b32 v37, v37, v61
    v_xor_b32 v38, v38, v62
    v_xor_b32 v39, v39, v63
    v_or3_b32 v48, v48, v36, v37
    v_or3_b32 v49, v49, v38, v39
    s_waitcnt vmcnt(1)
    v_xor_b32 v40, v40, v60
    v_xor_b32 v41, v41, v61
    v_xor_b32 v42, v42, v62
    v_xor_b32 v43, v43, v63
    v_or3_b32 v48, v48, v40, v41
    v_or3_b32 v49, v49, v42, v43
    s_waitcnt vmcnt(0)
    v_xor_b32 v44, v44, v60
    v_xor_b32 v45, v45, v61
    v_xor_b32 v46, v46, v62
    v_xor_b32 v47, v47, v63
    v_or3_b32 v48, v48, v44, v45
    v_or3_b32 v49, v49, v46, v47
    v_bitop3_b32 v48, v48, v49, s61 bitop3:0xa8
    v_cmp_ne_u32 vcc, 0, v48
    s_and_b64 exec, vcc, exec
    s_cbranch_scc0 L_got_52
    s_sleep 1
    s_sub_u32 s59, s59, 1
    s_cmp_lg_u32 s59, 0
    s_cbranch_scc1 L_poll_51
    v_mov_b32 v248, 5
    v_mov_b32 v249, 20
    global_store_dword v249, v248, s[24:25]
L_got_52:
    s_mov_b64 exec, -1
    v_pk_add_f32 v[184:185], v[16:17], v[24:25]
    v_pk_add_f32 v[186:187], v[18:19], v[26:27]
    v_pk_add_f32 v[188:189], v[20:21], v[28:29]
    v_pk_add_f32 v[190:191], v[22:23], v[30:31]
    v_pk_add_f32 v[192:193], v[32:33], v[40:41]
    v_pk_add_f32 v[194:195], v[34:35], v[42:43]
    v_pk_add_f32 v[196:197], v[36:37], v[44:45]
    v_pk_add_f32 v[198:199], v[38:39], v[46:47]
    v_pk_add_f32 v[184:185], v[184:185], v[192:193]
    v_pk_add_f32 v[186:187], v[186:187], v[194:195]
    v_pk_add_f32 v[188:189], v[188:189], v[196:197]
    v_pk_add_f32 v[190:191], v[190:191], v[198:199]
    v_cvt_pk_bf16_f32 v192, v184, v185
    v_cvt_pk_bf16_f32 v193, v186, v187
    v_cvt_pk_bf16_f32 v194, v188, v189
    v_cvt_pk_bf16_f32 v195, v190, v191
    v_lshlrev_b32 v184, 16, v192
    v_and_b32 v185, 0xffff0000, v192
    v_lshlrev_b32 v186, 16, v193
    v_and_b32 v187, 0xffff0000, v193
    v_lshlrev_b32 v188, 16, v194
    v_and_b32 v189, 0xffff0000, v194
    v_lshlrev_b32 v190, 16, v195
    v_and_b32 v191, 0xffff0000, v195
    v_pk_add_f32 v[184:185], v[184:185], v[76:77]
    v_pk_add_f32 v[186:187], v[186:187], v[78:79]
    v_pk_add_f32 v[188:189], v[188:189], v[80:81]
    v_pk_add_f32 v[190:191], v[190:191], v[82:83]
    v_cvt_pk_bf16_f32 v192, v184, v185
    v_cvt_pk_bf16_f32 v193, v186, v187
    v_cvt_pk_bf16_f32 v194, v188, v189
    v_cvt_pk_bf16_f32 v195, v190, v191
    v_lshlrev_b32 v184, 16, v192
    v_and_b32 v185, 0xffff0000, v192
    v_lshlrev_b32 v186, 16, v193
    v_and_b32 v187, 0xffff0000, v193
    v_lshlrev_b32 v188, 16, v194
    v_and_b32 v189, 0xffff0000, v194
    v_lshlrev_b32 v190, 16, v195
    v_and_b32 v191, 0xffff0000, v195
    s_nop 0
    v_readfirstlane_b32 s58, v184
    s_nop 1
    v_mul_f32 v208, s58, v5
    v_pk_add_f32 v[200:201], v[184:185], v[208:209] op_sel_hi:[1,0] neg_lo:[0,1] neg_hi:[0,1]
    v_pk_add_f32 v[202:203], v[186:187], v[208:209] op_sel_hi:[1,0] neg_lo:[0,1] neg_hi:[0,1]
    v_pk_add_f32 v[204:205], v[188:189], v[208:209] op_sel_hi:[1,0] neg_lo:[0,1] neg_hi:[0,1]
    v_pk_add_f32 v[206:207], v[190:191], v[208:209] op_sel_hi:[1,0] neg_lo:[0,1] neg_hi:[0,1]
    v_pk_mul_f32 v[212:213], v[200:201], v[200:201]
    v_pk_add_f32 v[210:211], v[200:201], v[202:203]
    v_pk_fma_f32 v[212:213], v[202:203], v[202:203], v[212:213]
    v_pk_fma_f32 v[212:213], v[204:205], v[204:205], v[212:213]
    v_pk_add_f32 v[210:211], v[210:211], v[204:205]
    v_pk_fma_f32 v[212:213], v[206:207], v[206:207], v[212:213]
    v_pk_add_f32 v[210:211], v[210:211], v[206:207]
    v_add_f32 v210, v210, v211
    v_add_f32 v212, v212, v213
    s_nop 0
    v_add_f32_dpp v210, v210, v210 quad_perm:[1,0,3,2] row_mask:0xf bank_mask:0xf
    v_add_f32_dpp v212, v212, v212 quad_perm:[1,0,3,2] row_mask:0xf bank_mask:0xf
    s_nop 0
    v_add_f32_dpp v210, v210, v210 quad_perm:[2,3,0,1] row_mask:0xf bank_mask:0xf
    v_add_f32_dpp v212, v212, v212 quad_perm:[2,3,0,1] row_mask:0xf bank_mask:0xf
    s_nop 0
    v_add_f32_dpp v210, v210, v210 row_half_mirror row_mask:0xf bank_mask:0xf
    v_add_f32_dpp v212, v212, v212 row_half_mirror row_mask:0xf bank_mask:0xf
    s_nop 0
    v_add_f32_dpp v210, v210, v210 row_mirror row_mask:0xf bank_mask:0xf
    v_add_f32_dpp v212, v212, v212 row_mirror row_mask:0xf bank_mask:0xf
    s_nop 0
    v_mov_b32 v211, v210
    v_mov_b32 v213, v212
    s_nop 0
    v_permlane16_swap_b32 v210, v211
    v_permlane16_swap_b32 v212, v213
    v_add_f32 v210, v210, v211
    v_add_f32 v212, v212, v213
    v_mov_b32 v211, v210
    v_mov_b32 v213, v212
    s_nop 0
    v_permlane32_swap_b32 v210, v211
    v_permlane32_swap_b32 v212, v213
    v_add_f32 v210, v210, v211
    v_add_f32 v212, v212, v213
    v_mul_f32 v210, 0x3b124925, v210
    v_mul_f32 v212, 0x3b124925, v212
    v_fma_f32 v212, -v210, v210, v212
    v_add_f32 v210, s58, v210
    v_max_f32 v212, 0, v212
    v_cvt_pk_bf16_f32 v212, v210, v212
    v_lshlrev_b32 v210, 16, v212
    v_and_b32 v212, 0xffff0000, v212
    v_add_f32 v212, 0x3727c5ac, v212
    v_pk_add_f32 v[200:201], v[184:185], v[210:211] op_sel_hi:[1,0] neg_lo:[0,1] neg_hi:[0,1]
    v_cvt_pk_bf16_f32 v212, v212, v212
    v_pk_add_f32 v[202:203], v[186:187], v[210:211] op_sel_hi:[1,0] neg_lo:[0,1] neg_hi:[0,1]
    v_and_b32 v212, 0xffff0000, v212
    v_sqrt_f32 v212, v212
    v_pk_add_f32 v[204:205], v[188:189], v[210:211] op_sel_hi:[1,0] neg_lo:[0,1] neg_hi:[0,1]
    v_pk_add_f32 v[206:207], v[190:191], v[210:211] op_sel_hi:[1,0] neg_lo:[0,1] neg_hi:[0,1]
    v_cvt_pk_bf16_f32 v212, v212, v212
    v_and_b32 v212, 0xffff0000, v212
    v_rcp_f32 v212, v212
    v_cvt_pk_bf16_f32 v192, v200, v201
    v_cvt_pk_bf16_f32 v193, v202, v203
    v_cvt_pk_bf16_f32 v194, v204, v205
    v_cvt_pk_bf16_f32 v195, v206, v207
    v_lshlrev_b32 v200, 16, v192
    v_and_b32 v201, 0xffff0000, v192
    v_lshlrev_b32 v202, 16, v193
    v_and_b32 v203, 0xffff0000, v193
    v_lshlrev_b32 v204, 16, v194
    v_and_b32 v205, 0xffff0000, v194
    v_lshlrev_b32 v206, 16, v195
    v_and_b32 v207, 0xffff0000, v195
    v_pk_mul_f32 v[200:201], v[200:201], v[212:213] op_sel_hi:[1,0]
    v_pk_mul_f32 v[202:203], v[202:203], v[212:213] op_sel_hi:[1,0]
    v_pk_mul_f32 v[204:205], v[204:205], v[212:213] op_sel_hi:[1,0]
    v_pk_mul_f32 v[206:207], v[206:207], v[212:213] op_sel_hi:[1,0]
    v_cvt_pk_bf16_f32 v192, v200, v201
    v_cvt_pk_bf16_f32 v193, v202, v203
    v_cvt_pk_bf16_f32 v194, v204, v205
    v_cvt_pk_bf16_f32 v195, v206, v207
    s_mov_b32 exec_lo, 0xffffffff
    s_mov_b32 exec_hi, 0xffffff
    ds_write_b64 v8, v[192:193] offset:13312
    ds_write_b64 v8, v[194:195] offset:13760
    s_mov_b64 exec, -1
    s_waitcnt vmcnt(0) lgkmcnt(0)
    s_barrier
    ds_read_b128 v[184:187], v10 offset:13312
    ds_read_b128 v[188:191], v10 offset:13376
    ds_read_b128 v[192:195], v10 offset:13440
    ds_read_b128 v[196:199], v10 offset:13504
    ds_read_b128 v[200:203], v10 offset:13568
    ds_read_b128 v[204:207], v10 offset:13632
    ds_read_b128 v[208:211], v10 offset:13696
    ds_read_b128 v[212:215], v10 offset:13760
    ds_read_b128 v[216:219], v10 offset:13824
    ds_read_b128 v[220:223], v10 offset:13888
    ds_read_b128 v[224:227], v10 offset:13952
    ds_read_b128 v[228:231], v10 offset:14016
    ds_read_b128 v[232:235], v10 offset:14080
    ds_read_b128 v[236:239], v10 offset:14144
    s_waitcnt lgkmcnt(13)
    v_mfma_f32_16x16x32_bf16 v[16:19], v[96:99], v[184:187], 0
    s_waitcnt lgkmcnt(12)
    v_mfma_f32_16x16x32_bf16 v[16:19], v[100:103], v[188:191], v[16:19]
    s_waitcnt lgkmcnt(11)
    v_mfma_f32_16x16x32_bf16 v[16:19], v[104:107], v[192:195], v[16:19]
    s_waitcnt lgkmcnt(10)
    v_mfma_f32_16x16x32_bf16 v[16:19], v[108:111], v[196:199], v[16:19]
    s_waitcnt lgkmcnt(9)
    v_mfma_f32_16x16x32_bf16 v[16:19], v[112:115], v[200:203], v[16:19]
    s_waitcnt lgkmcnt(8)
    v_mfma_f32_16x16x32_bf16 v[16:19], v[116:119], v[204:207], v[16:19]
    s_waitcnt lgkmcnt(7)
    v_mfma_f32_16x16x32_bf16 v[16:19], v[120:123], v[208:211], v[16:19]
    s_waitcnt lgkmcnt(6)
    v_mfma_f32_16x16x32_bf16 v[16:19], v[124:127], v[212:215], v[16:19]
    s_waitcnt lgkmcnt(5)
    v_mfma_f32_16x16x32_bf16 v[16:19], v[128:131], v[216:219], v[16:19]
    s_waitcnt lgkmcnt(4)
    v_mfma_f32_16x16x32_bf16 v[16:19], v[132:135], v[220:223], v[16:19]
    s_waitcnt lgkmcnt(3)
    v_mfma_f32_16x16x32_bf16 v[16:19], v[136:139], v[224:227], v[16:19]
    s_waitcnt lgkmcnt(2)
    v_mfma_f32_16x16x32_bf16 v[16:19], v[140:143], v[228:231], v[16:19]
    s_waitcnt lgkmcnt(1)
    v_mfma_f32_16x16x32_bf16 v[16:19], v[144:147], v[232:235], v[16:19]
    s_waitcnt lgkmcnt(0)
    v_mfma_f32_16x16x32_bf16 v[16:19], v[148:151], v[236:239], v[16:19]
    s_nop 7
    v_permlane32_swap_b32 v16, v18
    v_permlane32_swap_b32 v17, v19
    v_cvt_pk_bf16_f32 v16, v16, v17
    v_cvt_pk_bf16_f32 v18, v18, v19
    v_and_b32 v17, 0xffff0000, v16
    v_lshlrev_b32 v16, 16, v16
    v_and_b32 v19, 0xffff0000, v18
    v_lshlrev_b32 v18, 16, v18
    v_mul_f32 v16, v16, v18
    v_mul_f32 v17, v17, v19
    v_cvt_pk_bf16_f32 v16, v16, v17
    ds_write_b32 v13, v16 offset:18944
    s_waitcnt lgkmcnt(0)
    s_barrier
    ds_read_b128 v[20:23], v72
    ds_read_b128 v[24:27], v73
    ds_read_b128 v[28:31], v74
    ds_read_b128 v[32:35], v75
    s_waitcnt lgkmcnt(3)
    v_mfma_f32_16x16x32_bf16 v[36:39], v[152:155], v[20:23], 0
    v_mfma_f32_16x16x32_bf16 v[40:43], v[168:171], v[20:23], 0
    s_waitcnt lgkmcnt(2)
    v_mfma_f32_16x16x32_bf16 v[36:39], v[156:159], v[24:27], v[36:39]
    v_mfma_f32_16x16x32_bf16 v[40:43], v[172:175], v[24:27], v[40:43]
    s_waitcnt lgkmcnt(1)
    v_mfma_f32_16x16x32_bf16 v[36:39], v[160:163], v[28:31], v[36:39]
    v_mfma_f32_16x16x32_bf16 v[40:43], v[176:179], v[28:31], v[40:43]
    s_waitcnt lgkmcnt(0)
    v_mfma_f32_16x16x32_bf16 v[36:39], v[164:167], v[32:35], v[36:39]
    v_mfma_f32_16x16x32_bf16 v[40:43], v[180:183], v[32:35], v[40:43]
    s_nop 6
    v_bfi_b32 v36, s61, v60, v36
    v_bfi_b32 v37, s61, v61, v37
    v_bfi_b32 v38, s61, v62, v38
    v_bfi_b32 v39, s61, v63, v39
    buffer_store_dwordx4 v[36:39], v14, s[36:39], s52 offen sc1
    v_bfi_b32 v40, s61, v60, v40
    v_bfi_b32 v41, s61, v61, v41
    v_bfi_b32 v42, s61, v62, v42
    v_bfi_b32 v43, s61, v63, v43
    s_cmp_eq_u32 s48, 3
    s_cbranch_scc1 L_half_53
    buffer_store_dwordx4 v[40:43], v14, s[36:39], s52 offen offset:256 sc1
L_half_53:
    s_branch L_helper_end
L_final:
    s_mov_b32 s32, s22
    s_and_b32 s33, s23, 0xffff
    s_mov_b32 s34, 3584
    s_mov_b32 s35, 0x20000
    v_and_b32 v12, 7, v2
    v_lshrrev_b32 v13, 3, v2
    s_mul_i32 s53, s48, 896
    s_lshl_b32 s55, s50, 6
    s_add_u32 s53, s53, s55
    v_lshlrev_b32 v8, 3, v12
    buffer_load_dwordx2 v[64:65], v8, s[28:31], s53 offen
    v_and_b32 v9, 3, v13
    v_lshlrev_b32 v9, 14, v9
    v_lshl_add_u32 v9, v12, 4, v9
    v_lshlrev_b32 v10, 14, v13
    v_lshl_add_u32 v10, v12, 4, v10
    s_mul_i32 s52, s48, 1792
    s_lshl_b32 s55, s50, 7
    s_add_u32 s52, s52, s55
    s_add_u32 s44, s52, 524288
    s_add_u32 s44, s44, s62
    s_add_u32 s52, s52, s62
    s_add_u32 s6, s52, 1048576
    s_add_u32 s7, s52, 1179648
    s_add_u32 s8, s52, 1310720
    s_add_u32 s9, s52, 1441792
    s_add_u32 s10, s52, 1572864
    s_add_u32 s11, s52, 1703936
    s_add_u32 s12, s52, 1835008
    s_waitcnt vmcnt(0)
L_spin_54:
    ds_read_b32 v48, v15 offset:116
    s_waitcnt lgkmcnt(0)
    v_readfirstlane_b32 s58, v48
    s_cmp_ge_u32 s58, 1
    s_cbranch_scc1 L_spun_55
    s_sleep 2
    s_branch L_spin_54
L_spun_55:
    s_setprio 3
L_fin_go:
    v_lshlrev_b32 v68, 16, v64
    v_and_b32 v69, 0xffff0000, v64
    v_lshlrev_b32 v70, 16, v65
    v_and_b32 v71, 0xffff0000, v65
    s_mov_b32 s59, 262144
L_poll_56:
    buffer_load_dwordx4 v[16:19], v9, s[36:39], s44 offen sc1
L_poll_56_check:
    s_waitcnt vmcnt(0)
    v_xor_b32 v16, v16, v60
    v_xor_b32 v17, v17, v61
    v_xor_b32 v18, v18, v62
    v_xor_b32 v19, v19, v63
    v_or_b32 v48, v16, v17
    v_or_b32 v49, v18, v19
    v_bitop3_b32 v48, v48, v49, s61 bitop3:0xa8
    v_cmp_ne_u32 vcc, 0, v48
    s_and_b64 exec, vcc, exec
    s_cbranch_scc0 L_got_57
    s_sleep 1
    s_sub_u32 s59, s59, 1
    s_cmp_lg_u32 s59, 0
    s_cbranch_scc1 L_poll_56
    v_mov_b32 v248, 6
    v_mov_b32 v249, 24
    global_store_dword v249, v248, s[24:25]
L_got_57:
    s_mov_b64 exec, -1
    s_or_b32 s58, s50, s48
    s_cmp_lg_u32 s58, 0
    s_cbranch_scc1 L_epoch_done
    v_mov_b32 v80, s54
    s_mov_b64 exec, 1
    buffer_store_dword v80, v15, s[36:39], 0 offen offset:0 sc1
L_epoch_done:
    s_mov_b64 exec, -1
    v_add_f32_dpp v16, v16, v16 row_ror:8 row_mask:0xf bank_mask:0xf
    v_add_f32_dpp v17, v17, v17 row_ror:8 row_mask:0xf bank_mask:0xf
    v_add_f32_dpp v18, v18, v18 row_ror:8 row_mask:0xf bank_mask:0xf
    v_add_f32_dpp v19, v19, v19 row_ror:8 row_mask:0xf bank_mask:0xf
    v_mov_b32 v20, v16
    v_mov_b32 v21, v17
    v_mov_b32 v22, v18
    v_mov_b32 v23, v19
    v_permlane16_swap_b32 v16, v20
    v_permlane16_swap_b32 v17, v21
    v_permlane16_swap_b32 v18, v22
    v_permlane16_swap_b32 v19, v23
    v_add_f32 v16, v16, v20
    v_add_f32 v17, v17, v21
    v_add_f32 v18, v18, v22
    v_add_f32 v19, v19, v23
    v_cvt_pk_bf16_f32 v20, v16, v17
    v_cvt_pk_bf16_f32 v21, v18, v19
    v_lshlrev_b32 v16, 16, v20
    v_and_b32 v17, 0xffff0000, v20
    v_lshlrev_b32 v18, 16, v21
    v_and_b32 v19, 0xffff0000, v21
    v_add_f32 v16, v16, v68
    v_add_f32 v17, v17, v69
    v_add_f32 v18, v18, v70
    v_add_f32 v19, v19, v71
    v_cvt_pk_bf16_f32 v20, v16, v17
    v_cvt_pk_bf16_f32 v21, v18, v19
    v_lshlrev_b32 v68, 16, v20
    v_and_b32 v69, 0xffff0000, v20
    v_lshlrev_b32 v70, 16, v21
    v_and_b32 v71, 0xffff0000, v21
    s_mov_b32 s59, 262144
L_poll_58:
    buffer_load_dwordx4 v[16:19], v10, s[36:39], s6 offen sc1
    buffer_load_dwordx4 v[20:23], v10, s[36:39], s7 offen sc1
    buffer_load_dwordx4 v[24:27], v10, s[36:39], s8 offen sc1
    buffer_load_dwordx4 v[28:31], v10, s[36:39], s9 offen sc1
    buffer_load_dwordx4 v[32:35], v10, s[36:39], s10 offen sc1
    buffer_load_dwordx4 v[36:39], v10, s[36:39], s11 offen sc1
    buffer_load_dwordx4 v[40:43], v10, s[36:39], s12 offen sc1
L_poll_58_check:
    s_waitcnt vmcnt(6)
    v_xor_b32 v16, v16, v60
    v_xor_b32 v17, v17, v61
    v_xor_b32 v18, v18, v62
    v_xor_b32 v19, v19, v63
    v_or_b32 v48, v16, v17
    v_or_b32 v49, v18, v19
    s_waitcnt vmcnt(5)
    v_xor_b32 v20, v20, v60
    v_xor_b32 v21, v21, v61
    v_xor_b32 v22, v22, v62
    v_xor_b32 v23, v23, v63
    v_or3_b32 v48, v48, v20, v21
    v_or3_b32 v49, v49, v22, v23
    s_waitcnt vmcnt(4)
    v_xor_b32 v24, v24, v60
    v_xor_b32 v25, v25, v61
    v_xor_b32 v26, v26, v62
    v_xor_b32 v27, v27, v63
    v_or3_b32 v48, v48, v24, v25
    v_or3_b32 v49, v49, v26, v27
    s_waitcnt vmcnt(3)
    v_xor_b32 v28, v28, v60
    v_xor_b32 v29, v29, v61
    v_xor_b32 v30, v30, v62
    v_xor_b32 v31, v31, v63
    v_or3_b32 v48, v48, v28, v29
    v_or3_b32 v49, v49, v30, v31
    s_waitcnt vmcnt(2)
    v_xor_b32 v32, v32, v60
    v_xor_b32 v33, v33, v61
    v_xor_b32 v34, v34, v62
    v_xor_b32 v35, v35, v63
    v_or3_b32 v48, v48, v32, v33
    v_or3_b32 v49, v49, v34, v35
    s_waitcnt vmcnt(1)
    v_xor_b32 v36, v36, v60
    v_xor_b32 v37, v37, v61
    v_xor_b32 v38, v38, v62
    v_xor_b32 v39, v39, v63
    v_or3_b32 v48, v48, v36, v37
    v_or3_b32 v49, v49, v38, v39
    s_waitcnt vmcnt(0)
    v_xor_b32 v40, v40, v60
    v_xor_b32 v41, v41, v61
    v_xor_b32 v42, v42, v62
    v_xor_b32 v43, v43, v63
    v_or3_b32 v48, v48, v40, v41
    v_or3_b32 v49, v49, v42, v43
    v_bitop3_b32 v48, v48, v49, s61 bitop3:0xa8
    v_cmp_ne_u32 vcc, 0, v48
    s_and_b64 exec, vcc, exec
    s_cbranch_scc0 L_got_59
    s_sleep 1
    s_sub_u32 s59, s59, 1
    s_cmp_lg_u32 s59, 0
    s_cbranch_scc1 L_poll_58
    v_mov_b32 v248, 7
    v_mov_b32 v249, 28
    global_store_dword v249, v248, s[24:25]
L_got_59:
    s_mov_b64 exec, -1
    v_pk_add_f32 v[52:53], v[16:17], v[20:21]
    v_pk_add_f32 v[54:55], v[18:19], v[22:23]
    v_pk_add_f32 v[72:73], v[24:25], v[28:29]
    v_pk_add_f32 v[74:75], v[26:27], v[30:31]
    v_pk_add_f32 v[76:77], v[32:33], v[36:37]
    v_pk_add_f32 v[78:79], v[34:35], v[38:39]
    v_pk_add_f32 v[52:53], v[52:53], v[40:41]
    v_pk_add_f32 v[54:55], v[54:55], v[42:43]
    v_pk_add_f32 v[72:73], v[72:73], v[76:77]
    v_pk_add_f32 v[74:75], v[74:75], v[78:79]
    v_pk_add_f32 v[52:53], v[52:53], v[72:73]
    v_pk_add_f32 v[54:55], v[54:55], v[74:75]
    s_nop 0
    v_add_f32_dpp v52, v52, v52 row_ror:8 row_mask:0xf bank_mask:0xf
    v_add_f32_dpp v53, v53, v53 row_ror:8 row_mask:0xf bank_mask:0xf
    v_add_f32_dpp v54, v54, v54 row_ror:8 row_mask:0xf bank_mask:0xf
    v_add_f32_dpp v55, v55, v55 row_ror:8 row_mask:0xf bank_mask:0xf
    v_mov_b32 v56, v52
    v_mov_b32 v57, v53
    v_mov_b32 v58, v54
    v_mov_b32 v59, v55
    v_permlane16_swap_b32 v52, v56
    v_permlane16_swap_b32 v53, v57
    v_permlane16_swap_b32 v54, v58
    v_permlane16_swap_b32 v55, v59
    v_pk_add_f32 v[52:53], v[52:53], v[56:57]
    v_pk_add_f32 v[54:55], v[54:55], v[58:59]
    v_mov_b32 v56, v52
    v_mov_b32 v57, v53
    v_mov_b32 v58, v54
    v_mov_b32 v59, v55
    v_permlane32_swap_b32 v52, v56
    v_permlane32_swap_b32 v53, v57
    v_permlane32_swap_b32 v54, v58
    v_permlane32_swap_b32 v55, v59
    v_pk_add_f32 v[52:53], v[52:53], v[56:57]
    v_pk_add_f32 v[54:55], v[54:55], v[58:59]
    v_cvt_pk_bf16_f32 v56, v52, v53
    v_cvt_pk_bf16_f32 v57, v54, v55
    v_lshlrev_b32 v52, 16, v56
    v_and_b32 v53, 0xffff0000, v56
    v_lshlrev_b32 v54, 16, v57
    v_and_b32 v55, 0xffff0000, v57
    v_pk_add_f32 v[52:53], v[52:53], v[68:69]
    v_pk_add_f32 v[54:55], v[54:55], v[70:71]
    v_cvt_pk_bf16_f32 v56, v52, v53
    v_cvt_pk_bf16_f32 v57, v54, v55
    s_mov_b32 exec_lo, 0xff
    s_mov_b32 exec_hi, 0x0
    buffer_store_dwordx2 v[56:57], v8, s[32:35], s53 offen sc1
    s_mov_b64 exec, -1
L_helper_end:
L_exit:
    s_endpgm
L_stream:
    s_lshl_b32 s45, s3, 2
    v_mov_b32 v248, s45
    v_mov_b32 v249, 0
    v_mov_b32 v250, 0
    s_mov_b64 vcc, 0
    s_waitcnt vmcnt(4)
    s_add_u32 s41, s41, s42
    buffer_load_dwordx4 v[80:83], v1, s[28:31], s41 offen offset:0 nt
    s_waitcnt vmcnt(4)
    buffer_load_dwordx4 v[84:87], v1, s[28:31], s41 offen offset:1024 nt
    s_waitcnt vmcnt(4)
    buffer_load_dwordx4 v[88:91], v1, s[28:31], s41 offen offset:2048 nt
    s_waitcnt vmcnt(4)
    buffer_load_dwordx4 v[92:95], v1, s[28:31], s41 offen offset:3072 nt
    s_waitcnt vmcnt(4)
    s_add_u32 s41, s41, s42
    buffer_load_dwordx4 v[96:99], v1, s[28:31], s41 offen offset:0 nt
    s_waitcnt vmcnt(4)
    buffer_load_dwordx4 v[100:103], v1, s[28:31], s41 offen offset:1024 nt
    s_waitcnt vmcnt(4)
    buffer_load_dwordx4 v[104:107], v1, s[28:31], s41 offen offset:2048 nt
    s_waitcnt vmcnt(4)
    buffer_load_dwordx4 v[108:111], v1, s[28:31], s41 offen offset:3072 nt
    s_waitcnt vmcnt(4)
    s_add_u32 s41, s41, s42
    buffer_load_dwordx4 v[112:115], v1, s[28:31], s41 offen offset:0 nt
    s_waitcnt vmcnt(4)
    buffer_load_dwordx4 v[116:119], v1, s[28:31], s41 offen offset:1024 nt
    s_waitcnt vmcnt(4)
    buffer_load_dwordx4 v[120:123], v1, s[28:31], s41 offen offset:2048 nt
    s_waitcnt vmcnt(4)
    buffer_load_dwordx4 v[124:127], v1, s[28:31], s41 offen offset:3072 nt
    s_waitcnt vmcnt(4)
    s_add_u32 s41, s41, s42
    buffer_load_dwordx4 v[128:131], v1, s[28:31], s41 offen offset:0 nt
    s_waitcnt vmcnt(4)
    buffer_load_dwordx4 v[132:135], v1, s[28:31], s41 offen offset:1024 nt
    s_waitcnt vmcnt(4)
    buffer_load_dwordx4 v[136:139], v1, s[28:31], s41 offen offset:2048 nt
    s_waitcnt vmcnt(4)
    buffer_load_dwordx4 v[140:143], v1, s[28:31], s41 offen offset:3072 nt
    s_waitcnt vmcnt(4)
    s_add_u32 s41, s41, s42
    buffer_load_dwordx4 v[144:147], v1, s[28:31], s41 offen offset:0 nt
    s_waitcnt vmcnt(4)
    buffer_load_dwordx4 v[148:151], v1, s[28:31], s41 offen offset:1024 nt
    s_waitcnt vmcnt(4)
    buffer_load_dwordx4 v[152:155], v1, s[28:31], s41 offen offset:2048 nt
    s_waitcnt vmcnt(4)
    buffer_load_dwordx4 v[156:159], v1, s[28:31], s41 offen offset:3072 nt
    s_waitcnt vmcnt(4)
    s_add_u32 s41, s41, s42
    buffer_load_dwordx4 v[160:163], v1, s[28:31], s41 offen offset:0 nt
    s_waitcnt vmcnt(4)
    buffer_load_dwordx4 v[164:167], v1, s[28:31], s41 offen offset:1024 nt
    s_waitcnt vmcnt(4)
    buffer_load_dwordx4 v[168:171], v1, s[28:31], s41 offen offset:2048 nt
    s_waitcnt vmcnt(4)
    buffer_load_dwordx4 v[172:175], v1, s[28:31], s41 offen offset:3072 nt
    s_waitcnt vmcnt(4)
    s_add_u32 s41, s41, s42
    buffer_load_dwordx4 v[176:179], v1, s[28:31], s41 offen offset:0 nt
    s_waitcnt vmcnt(4)
    buffer_load_dwordx4 v[180:183], v1, s[28:31], s41 offen offset:1024 nt
    s_waitcnt vmcnt(4)
    buffer_load_dwordx4 v[184:187], v1, s[28:31], s41 offen offset:2048 nt
    s_waitcnt vmcnt(4)
    buffer_load_dwordx4 v[188:191], v1, s[28:31], s41 offen offset:3072 nt
    s_waitcnt vmcnt(4)
    s_add_u32 s41, s41, s42
    buffer_load_dwordx4 v[192:195], v1, s[28:31], s41 offen offset:0 nt
    s_waitcnt vmcnt(4)
    buffer_load_dwordx4 v[196:199], v1, s[28:31], s41 offen offset:1024 nt
    s_waitcnt vmcnt(4)
    buffer_load_dwordx4 v[200:203], v1, s[28:31], s41 offen offset:2048 nt
    s_waitcnt vmcnt(4)
    buffer_load_dwordx4 v[204:207], v1, s[28:31], s41 offen offset:3072 nt
    s_waitcnt vmcnt(4)
    s_add_u32 s41, s41, s42
    buffer_load_dwordx4 v[208:211], v1, s[28:31], s41 offen offset:0 nt
    s_waitcnt vmcnt(4)
    buffer_load_dwordx4 v[212:215], v1, s[28:31], s41 offen offset:1024 nt
    s_waitcnt vmcnt(4)
    buffer_load_dwordx4 v[216:219], v1, s[28:31], s41 offen offset:2048 nt
    s_waitcnt vmcnt(4)
    buffer_load_dwordx4 v[220:223], v1, s[28:31], s41 offen offset:3072 nt
    s_mov_b32 s32, s8
    s_and_b32 s33, s9, 0xffff
    s_mov_b32 s34, 268435456
    s_mov_b32 s35, 0x20000
    s_mov_b32 s36, s26
    s_and_b32 s37, s27, 0xffff
    s_mov_b32 s38, 3145728
    s_mov_b32 s39, 0x20000
    v_lshrrev_b32 v3, 5, v2
    s_lshl_b32 s43, s3, 11
    s_add_u32 s43, s43, 1024
    v_lshlrev_b32 v13, 10, v3
    v_add_u32 v13, s43, v13
    v_bfe_u32 v14, v2, 2, 3
    v_lshl_add_u32 v12, v14, 3, v13
    v_and_b32 v14, 31, v2
    v_and_b32 v17, 1, v2
    v_lshlrev_b32 v17, 4, v17
    v_mov_b32 v16, 0xffff
    v_lshlrev_b32 v17, v17, v16
    v_lshrrev_b32 v16, 1, v14
    v_cmp_eq_u32 vcc, 0, v16
    s_nop 1
    v_cndmask_b32 v8, 0, v17, vcc
    v_cmp_eq_u32 vcc, 1, v16
    s_nop 1
    v_cndmask_b32 v9, 0, v17, vcc
    v_cmp_eq_u32 vcc, 2, v16
    s_nop 1
    v_cndmask_b32 v10, 0, v17, vcc
    v_cmp_eq_u32 vcc, 3, v16
    s_nop 1
    v_cndmask_b32 v11, 0, v17, vcc
    s_mov_b64 vcc, 0
    s_mul_i32 s46, s3, 12288
    s_add_u32 s46, s46, 105472
    v_lshl_add_u32 v247, v2, 4, s46
    s_waitcnt vmcnt(4)
    s_add_u32 s41, s41, s42
    buffer_load_dwordx4 v[224:227], v1, s[28:31], s41 offen offset:0 nt
    s_waitcnt vmcnt(4)
    buffer_load_dwordx4 v[228:231], v1, s[28:31], s41 offen offset:1024 nt
    s_waitcnt vmcnt(4)
    buffer_load_dwordx4 v[232:235], v1, s[28:31], s41 offen offset:2048 nt
    s_waitcnt vmcnt(4)
    buffer_load_dwordx4 v[236:239], v1, s[28:31], s41 offen offset:3072 nt
    s_waitcnt vmcnt(4)
    s_add_u32 s41, s41, s42
    s_add_u32 m0, s46, 0
    s_nop 0
    buffer_load_dwordx4 v1, s[28:31], s41 offen offset:0 nt lds
    s_waitcnt vmcnt(4)
    buffer_load_dwordx4 v1, s[28:31], s41 offen offset:1024 nt lds
    s_waitcnt vmcnt(4)
    buffer_load_dwordx4 v1, s[28:31], s41 offen offset:2048 nt lds
    s_waitcnt vmcnt(4)
    buffer_load_dwordx4 v1, s[28:31], s41 offen offset:3072 nt lds
    s_waitcnt vmcnt(4)
    s_add_u32 s41, s41, s42
    s_add_u32 m0, s46, 4096
    s_nop 0
    buffer_load_dwordx4 v1, s[28:31], s41 offen offset:0 nt lds
    s_waitcnt vmcnt(4)
    buffer_load_dwordx4 v1, s[28:31], s41 offen offset:1024 nt lds
    s_waitcnt vmcnt(4)
    buffer_load_dwordx4 v1, s[28:31], s41 offen offset:2048 nt lds
    s_waitcnt vmcnt(4)
    buffer_load_dwordx4 v1, s[28:31], s41 offen offset:3072 nt lds
    s_waitcnt vmcnt(4)
    s_add_u32 s41, s41, s42
    s_add_u32 m0, s46, 8192
    s_nop 0
    buffer_load_dwordx4 v1, s[28:31], s41 offen offset:0 nt lds
    s_waitcnt vmcnt(4)
    buffer_load_dwordx4 v1, s[28:31], s41 offen offset:1024 nt lds
    s_waitcnt vmcnt(4)
    buffer_load_dwordx4 v1, s[28:31], s41 offen offset:2048 nt lds
    s_waitcnt vmcnt(4)
    buffer_load_dwordx4 v1, s[28:31], s41 offen offset:3072 nt lds
L_spin_60:
    ds_read_b32 v240, v15 offset:0
    s_waitcnt lgkmcnt(0)
    v_readfirstlane_b32 s58, v240
    s_cmp_ge_u32 s58, 1
    s_cbranch_scc1 L_spun_61
    s_sleep 1
    s_branch L_spin_60
L_spun_61:
    v_lshlrev_b32 v14, 4, v14
    ds_read_b128 v[4:7], v14 offset:256
    ds_write_b32 v15, v240 offset:24
    s_waitcnt lgkmcnt(0)
    v_dot2_f32_bf16 v16, v48, v4, 0
    v_dot2_f32_bf16 v16, v49, v5, v16
    v_dot2_f32_bf16 v16, v50, v6, v16
    v_dot2_f32_bf16 v16, v51, v7, v16
    s_cbranch_vccnz L_w_62
    s_waitcnt vmcnt(4)
L_w_62:
    s_add_u32 s41, s41, s42
    buffer_load_dwordx4 v[48:51], v1, s[28:31], s41 offen offset:0 nt
    v_dot2_f32_bf16 v17, v52, v4, 0
    v_dot2_f32_bf16 v17, v53, v5, v17
    v_dot2_f32_bf16 v17, v54, v6, v17
    v_dot2_f32_bf16 v17, v55, v7, v17
    v_dot2_f32_bf16 v18, v56, v4, 0
    v_dot2_f32_bf16 v18, v57, v5, v18
    v_dot2_f32_bf16 v18, v58, v6, v18
    v_dot2_f32_bf16 v18, v59, v7, v18
    s_cbranch_vccnz L_w_63
    s_waitcnt vmcnt(4)
L_w_63:
    buffer_load_dwordx4 v[52:55], v1, s[28:31], s41 offen offset:1024 nt
    v_dot2_f32_bf16 v19, v60, v4, 0
    v_dot2_f32_bf16 v19, v61, v5, v19
    v_dot2_f32_bf16 v19, v62, v6, v19
    v_dot2_f32_bf16 v19, v63, v7, v19
    s_waitcnt lgkmcnt(0)
    v_cmp_lt_u32 vcc, v250, v249
    ds_read_b32 v249, v15 offset:28
    v_dot2_f32_bf16 v20, v64, v4, 0
    v_dot2_f32_bf16 v20, v65, v5, v20
    v_dot2_f32_bf16 v20, v66, v6, v20
    v_dot2_f32_bf16 v20, v67, v7, v20
    s_waitcnt vmcnt(6)
    s_cbranch_vccnz L_w_64
    s_waitcnt vmcnt(4)
L_w_64:
    buffer_load_dwordx4 v[56:59], v1, s[28:31], s41 offen offset:2048 nt
    v_dot2_f32_bf16 v21, v68, v4, 0
    v_dot2_f32_bf16 v21, v69, v5, v21
    v_dot2_f32_bf16 v21, v70, v6, v21
    v_dot2_f32_bf16 v21, v71, v7, v21
    v_dot2_f32_bf16 v22, v72, v4, 0
    v_dot2_f32_bf16 v22, v73, v5, v22
    v_dot2_f32_bf16 v22, v74, v6, v22
    v_dot2_f32_bf16 v22, v75, v7, v22
    s_waitcnt vmcnt(6)
    s_cbranch_vccnz L_w_65
    s_waitcnt vmcnt(4)
L_w_65:
    buffer_load_dwordx4 v[60:63], v1, s[28:31], s41 offen offset:3072 nt
    v_mov_b32 v250, 64
    ds_write_b32 v248, v250 offset:96
    v_dot2_f32_bf16 v23, v76, v4, 0
    v_dot2_f32_bf16 v23, v77, v5, v23
    v_dot2_f32_bf16 v23, v78, v6, v23
    v_dot2_f32_bf16 v23, v79, v7, v23
    s_waitcnt lgkmcnt(0)
    v_cmp_lt_u32 vcc, v250, v249
    ds_read_b32 v249, v15 offset:28
    v_dot2_f32_bf16 v24, v80, v4, 0
    v_dot2_f32_bf16 v24, v81, v5, v24
    v_dot2_f32_bf16 v24, v82, v6, v24
    v_dot2_f32_bf16 v24, v83, v7, v24
    s_waitcnt vmcnt(6)
    s_cbranch_vccnz L_w_66
    s_waitcnt vmcnt(4)
L_w_66:
    s_add_u32 s41, s41, s42
    buffer_load_dwordx4 v[64:67], v1, s[28:31], s41 offen offset:0 nt
    v_dot2_f32_bf16 v25, v84, v4, 0
    v_dot2_f32_bf16 v25, v85, v5, v25
    v_dot2_f32_bf16 v25, v86, v6, v25
    v_dot2_f32_bf16 v25, v87, v7, v25
    v_dot2_f32_bf16 v26, v88, v4, 0
    v_dot2_f32_bf16 v26, v89, v5, v26
    v_dot2_f32_bf16 v26, v90, v6, v26
    v_dot2_f32_bf16 v26, v91, v7, v26
    s_waitcnt vmcnt(6)
    s_cbranch_vccnz L_w_67
    s_waitcnt vmcnt(4)
L_w_67:
    buffer_load_dwordx4 v[68:71], v1, s[28:31], s41 offen offset:1024 nt
    v_dot2_f32_bf16 v27, v92, v4, 0
    v_dot2_f32_bf16 v27, v93, v5, v27
    v_dot2_f32_bf16 v27, v94, v6, v27
    v_dot2_f32_bf16 v27, v95, v7, v27
    s_waitcnt lgkmcnt(0)
    v_cmp_lt_u32 vcc, v250, v249
    ds_read_b32 v249, v15 offset:28
    v_dot2_f32_bf16 v28, v96, v4, 0
    v_dot2_f32_bf16 v28, v97, v5, v28
    v_dot2_f32_bf16 v28, v98, v6, v28
    v_dot2_f32_bf16 v28, v99, v7, v28
    s_waitcnt vmcnt(6)
    s_cbranch_vccnz L_w_68
    s_waitcnt vmcnt(4)
L_w_68:
    buffer_load_dwordx4 v[72:75], v1, s[28:31], s41 offen offset:2048 nt
    v_dot2_f32_bf16 v29, v100, v4, 0
    v_dot2_f32_bf16 v29, v101, v5, v29
    v_dot2_f32_bf16 v29, v102, v6, v29
    v_dot2_f32_bf16 v29, v103, v7, v29
    v_dot2_f32_bf16 v30, v104, v4, 0
    v_dot2_f32_bf16 v30, v105, v5, v30
    v_dot2_f32_bf16 v30, v106, v6, v30
    v_dot2_f32_bf16 v30, v107, v7, v30
    s_waitcnt vmcnt(6)
    s_cbranch_vccnz L_w_69
    s_waitcnt vmcnt(4)
L_w_69:
    buffer_load_dwordx4 v[76:79], v1, s[28:31], s41 offen offset:3072 nt
    v_mov_b32 v250, 68
    ds_write_b32 v248, v250 offset:96
    v_dot2_f32_bf16 v31, v108, v4, 0
    v_dot2_f32_bf16 v31, v109, v5, v31
    v_dot2_f32_bf16 v31, v110, v6, v31
    v_dot2_f32_bf16 v31, v111, v7, v31
    v_permlane16_swap_b32 v16, v24
    v_permlane16_swap_b32 v17, v25
    v_permlane16_swap_b32 v18, v26
    v_permlane16_swap_b32 v19, v27
    v_permlane16_swap_b32 v20, v28
    v_permlane16_swap_b32 v21, v29
    v_permlane16_swap_b32 v22, v30
    v_permlane16_swap_b32 v23, v31
    v_add_f32 v16, v16, v24
    v_add_f32 v17, v17, v25
    v_add_f32 v18, v18, v26
    v_add_f32 v19, v19, v27
    v_add_f32 v20, v20, v28
    v_add_f32 v21, v21, v29
    v_add_f32 v22, v22, v30
    v_add_f32 v23, v23, v31
    v_add_f32_dpp v24, v16, v16 row_ror:8 row_mask:0xf bank_mask:0x3
    v_add_f32_dpp v25, v17, v17 row_ror:8 row_mask:0xf bank_mask:0x3
    v_add_f32_dpp v26, v18, v18 row_ror:8 row_mask:0xf bank_mask:0x3
    v_add_f32_dpp v27, v19, v19 row_ror:8 row_mask:0xf bank_mask:0x3
    v_add_f32_dpp v24, v20, v20 row_ror:8 row_mask:0xf bank_mask:0xc
    v_add_f32_dpp v25, v21, v21 row_ror:8 row_mask:0xf bank_mask:0xc
    v_add_f32_dpp v26, v22, v22 row_ror:8 row_mask:0xf bank_mask:0xc
    v_add_f32_dpp v27, v23, v23 row_ror:8 row_mask:0xf bank_mask:0xc
    v_add_f32_dpp v16, v24, v24 row_shl:4 row_mask:0xf bank_mask:0x5
    v_add_f32_dpp v17, v25, v25 row_shl:4 row_mask:0xf bank_mask:0x5
    s_nop 0
    v_add_f32_dpp v16, v26, v26 row_shr:4 row_mask:0xf bank_mask:0xa
    v_add_f32_dpp v17, v27, v27 row_shr:4 row_mask:0xf bank_mask:0xa
    s_nop 0
    v_add_f32_dpp v16, v16, v16 quad_perm:[1,0,3,2] row_mask:0xf bank_mask:0xf
    v_add_f32_dpp v17, v17, v17 quad_perm:[1,0,3,2] row_mask:0xf bank_mask:0xf
    s_nop 0
    v_add_f32_dpp v16, v16, v16 quad_perm:[2,3,0,1] row_mask:0xf bank_mask:0xf
    v_add_f32_dpp v17, v17, v17 quad_perm:[2,3,0,1] row_mask:0xf bank_mask:0xf
    ds_write_b64 v12, v[16:17] offset:0
    s_waitcnt lgkmcnt(1)
    v_cmp_lt_u32 vcc, v250, v249
    ds_read_b32 v249, v15 offset:28
    v_dot2_f32_bf16 v16, v112, v4, 0
    v_dot2_f32_bf16 v16, v113, v5, v16
    v_dot2_f32_bf16 v16, v114, v6, v16
    v_dot2_f32_bf16 v16, v115, v7, v16
    s_waitcnt vmcnt(6)
    s_cbranch_vccnz L_w_70
    s_waitcnt vmcnt(4)
L_w_70:
    s_add_u32 s41, s41, s42
    buffer_load_dwordx4 v[80:83], v1, s[28:31], s41 offen offset:0 nt
    v_dot2_f32_bf16 v17, v116, v4, 0
    v_dot2_f32_bf16 v17, v117, v5, v17
    v_dot2_f32_bf16 v17, v118, v6, v17
    v_dot2_f32_bf16 v17, v119, v7, v17
    v_dot2_f32_bf16 v18, v120, v4, 0
    v_dot2_f32_bf16 v18, v121, v5, v18
    v_dot2_f32_bf16 v18, v122, v6, v18
    v_dot2_f32_bf16 v18, v123, v7, v18
    s_waitcnt vmcnt(6)
    s_cbranch_vccnz L_w_71
    s_waitcnt vmcnt(4)
L_w_71:
    buffer_load_dwordx4 v[84:87], v1, s[28:31], s41 offen offset:1024 nt
    v_dot2_f32_bf16 v19, v124, v4, 0
    v_dot2_f32_bf16 v19, v125, v5, v19
    v_dot2_f32_bf16 v19, v126, v6, v19
    v_dot2_f32_bf16 v19, v127, v7, v19
    s_waitcnt lgkmcnt(0)
    v_cmp_lt_u32 vcc, v250, v249
    ds_read_b32 v249, v15 offset:28
    v_dot2_f32_bf16 v20, v128, v4, 0
    v_dot2_f32_bf16 v20, v129, v5, v20
    v_dot2_f32_bf16 v20, v130, v6, v20
    v_dot2_f32_bf16 v20, v131, v7, v20
    s_waitcnt vmcnt(6)
    s_cbranch_vccnz L_w_72
    s_waitcnt vmcnt(4)
L_w_72:
    buffer_load_dwordx4 v[88:91], v1, s[28:31], s41 offen offset:2048 nt
    v_dot2_f32_bf16 v21, v132, v4, 0
    v_dot2_f32_bf16 v21, v133, v5, v21
    v_dot2_f32_bf16 v21, v134, v6, v21
    v_dot2_f32_bf16 v21, v135, v7, v21
    v_dot2_f32_bf16 v22, v136, v4, 0
    v_dot2_f32_bf16 v22, v137, v5, v22
    v_dot2_f32_bf16 v22, v138, v6, v22
    v_dot2_f32_bf16 v22, v139, v7, v22
    s_waitcnt vmcnt(6)
    s_cbranch_vccnz L_w_73
    s_waitcnt vmcnt(4)
L_w_73:
    buffer_load_dwordx4 v[92:95], v1, s[28:31], s41 offen offset:3072 nt
    v_mov_b32 v250, 72
    ds_write_b32 v248, v250 offset:96
    v_dot2_f32_bf16 v23, v140, v4, 0
    v_dot2_f32_bf16 v23, v141, v5, v23
    v_dot2_f32_bf16 v23, v142, v6, v23
    v_dot2_f32_bf16 v23, v143, v7, v23
    s_waitcnt lgkmcnt(0)
    v_cmp_lt_u32 vcc, v250, v249
    ds_read_b32 v249, v15 offset:28
    v_dot2_f32_bf16 v24, v144, v4, 0
    v_dot2_f32_bf16 v24, v145, v5, v24
    v_dot2_f32_bf16 v24, v146, v6, v24
    v_dot2_f32_bf16 v24, v147, v7, v24
    s_waitcnt vmcnt(6)
    s_cbranch_vccnz L_w_74
    s_waitcnt vmcnt(4)
L_w_74:
    s_add_u32 s41, s41, s42
    buffer_load_dwordx4 v[96:99], v1, s[28:31], s41 offen offset:0 nt
    v_dot2_f32_bf16 v25, v148, v4, 0
    v_dot2_f32_bf16 v25, v149, v5, v25
    v_dot2_f32_bf16 v25, v150, v6, v25
    v_dot2_f32_bf16 v25, v151, v7, v25
    v_dot2_f32_bf16 v26, v152, v4, 0
    v_dot2_f32_bf16 v26, v153, v5, v26
    v_dot2_f32_bf16 v26, v154, v6, v26
    v_dot2_f32_bf16 v26, v155, v7, v26
    s_waitcnt vmcnt(6)
    s_cbranch_vccnz L_w_75
    s_waitcnt vmcnt(4)
L_w_75:
    buffer_load_dwordx4 v[100:103], v1, s[28:31], s41 offen offset:1024 nt
    v_dot2_f32_bf16 v27, v156, v4, 0
    v_dot2_f32_bf16 v27, v157, v5, v27
    v_dot2_f32_bf16 v27, v158, v6, v27
    v_dot2_f32_bf16 v27, v159, v7, v27
    s_waitcnt lgkmcnt(0)
    v_cmp_lt_u32 vcc, v250, v249
    ds_read_b32 v249, v15 offset:28
    v_dot2_f32_bf16 v28, v160, v4, 0
    v_dot2_f32_bf16 v28, v161, v5, v28
    v_dot2_f32_bf16 v28, v162, v6, v28
    v_dot2_f32_bf16 v28, v163, v7, v28
    s_waitcnt vmcnt(6)
    s_cbranch_vccnz L_w_76
    s_waitcnt vmcnt(4)
L_w_76:
    buffer_load_dwordx4 v[104:107], v1, s[28:31], s41 offen offset:2048 nt
    v_dot2_f32_bf16 v29, v164, v4, 0
    v_dot2_f32_bf16 v29, v165, v5, v29
    v_dot2_f32_bf16 v29, v166, v6, v29
    v_dot2_f32_bf16 v29, v167, v7, v29
    v_dot2_f32_bf16 v30, v168, v4, 0
    v_dot2_f32_bf16 v30, v169, v5, v30
    v_dot2_f32_bf16 v30, v170, v6, v30
    v_dot2_f32_bf16 v30, v171, v7, v30
    s_waitcnt vmcnt(6)
    s_cbranch_vccnz L_w_77
    s_waitcnt vmcnt(4)
L_w_77:
    buffer_load_dwordx4 v[108:111], v1, s[28:31], s41 offen offset:3072 nt
    v_mov_b32 v250, 76
    ds_write_b32 v248, v250 offset:96
    v_dot2_f32_bf16 v31, v172, v4, 0
    v_dot2_f32_bf16 v31, v173, v5, v31
    v_dot2_f32_bf16 v31, v174, v6, v31
    v_dot2_f32_bf16 v31, v175, v7, v31
    v_permlane16_swap_b32 v16, v24
    v_permlane16_swap_b32 v17, v25
    v_permlane16_swap_b32 v18, v26
    v_permlane16_swap_b32 v19, v27
    v_permlane16_swap_b32 v20, v28
    v_permlane16_swap_b32 v21, v29
    v_permlane16_swap_b32 v22, v30
    v_permlane16_swap_b32 v23, v31
    v_add_f32 v16, v16, v24
    v_add_f32 v17, v17, v25
    v_add_f32 v18, v18, v26
    v_add_f32 v19, v19, v27
    v_add_f32 v20, v20, v28
    v_add_f32 v21, v21, v29
    v_add_f32 v22, v22, v30
    v_add_f32 v23, v23, v31
    v_add_f32_dpp v24, v16, v16 row_ror:8 row_mask:0xf bank_mask:0x3
    v_add_f32_dpp v25, v17, v17 row_ror:8 row_mask:0xf bank_mask:0x3
    v_add_f32_dpp v26, v18, v18 row_ror:8 row_mask:0xf bank_mask:0x3
    v_add_f32_dpp v27, v19, v19 row_ror:8 row_mask:0xf bank_mask:0x3
    v_add_f32_dpp v24, v20, v20 row_ror:8 row_mask:0xf bank_mask:0xc
    v_add_f32_dpp v25, v21, v21 row_ror:8 row_mask:0xf bank_mask:0xc
    v_add_f32_dpp v26, v22, v22 row_ror:8 row_mask:0xf bank_mask:0xc
    v_add_f32_dpp v27, v23, v23 row_ror:8 row_mask:0xf bank_mask:0xc
    v_add_f32_dpp v16, v24, v24 row_shl:4 row_mask:0xf bank_mask:0x5
    v_add_f32_dpp v17, v25, v25 row_shl:4 row_mask:0xf bank_mask:0x5
    s_nop 0
    v_add_f32_dpp v16, v26, v26 row_shr:4 row_mask:0xf bank_mask:0xa
    v_add_f32_dpp v17, v27, v27 row_shr:4 row_mask:0xf bank_mask:0xa
    s_nop 0
    v_add_f32_dpp v16, v16, v16 quad_perm:[1,0,3,2] row_mask:0xf bank_mask:0xf
    v_add_f32_dpp v17, v17, v17 quad_perm:[1,0,3,2] row_mask:0xf bank_mask:0xf
    s_nop 0
    v_add_f32_dpp v16, v16, v16 quad_perm:[2,3,0,1] row_mask:0xf bank_mask:0xf
    v_add_f32_dpp v17, v17, v17 quad_perm:[2,3,0,1] row_mask:0xf bank_mask:0xf
    ds_write_b64 v12, v[16:17] offset:64
    s_waitcnt lgkmcnt(1)
    v_cmp_lt_u32 vcc, v250, v249
    ds_read_b32 v249, v15 offset:28
    v_dot2_f32_bf16 v16, v176, v4, 0
    v_dot2_f32_bf16 v16, v177, v5, v16
    v_dot2_f32_bf16 v16, v178, v6, v16
    v_dot2_f32_bf16 v16, v179, v7, v16
    s_waitcnt vmcnt(6)
    s_cbranch_vccnz L_w_78
    s_waitcnt vmcnt(4)
L_w_78:
    s_add_u32 s41, s41, s42
    buffer_load_dwordx4 v[112:115], v1, s[28:31], s41 offen offset:0 nt
    v_dot2_f32_bf16 v17, v180, v4, 0
    v_dot2_f32_bf16 v17, v181, v5, v17
    v_dot2_f32_bf16 v17, v182, v6, v17
    v_dot2_f32_bf16 v17, v183, v7, v17
    v_dot2_f32_bf16 v18, v184, v4, 0
    v_dot2_f32_bf16 v18, v185, v5, v18
    v_dot2_f32_bf16 v18, v186, v6, v18
    v_dot2_f32_bf16 v18, v187, v7, v18
    s_waitcnt vmcnt(6)
    s_cbranch_vccnz L_w_79
    s_waitcnt vmcnt(4)
L_w_79:
    buffer_load_dwordx4 v[116:119], v1, s[28:31], s41 offen offset:1024 nt
    v_dot2_f32_bf16 v19, v188, v4, 0
    v_dot2_f32_bf16 v19, v189, v5, v19
    v_dot2_f32_bf16 v19, v190, v6, v19
    v_dot2_f32_bf16 v19, v191, v7, v19
    s_waitcnt lgkmcnt(0)
    v_cmp_lt_u32 vcc, v250, v249
    ds_read_b32 v249, v15 offset:28
    v_dot2_f32_bf16 v20, v192, v4, 0
    v_dot2_f32_bf16 v20, v193, v5, v20
    v_dot2_f32_bf16 v20, v194, v6, v20
    v_dot2_f32_bf16 v20, v195, v7, v20
    s_waitcnt vmcnt(6)
    s_cbranch_vccnz L_w_80
    s_waitcnt vmcnt(4)
L_w_80:
    buffer_load_dwordx4 v[120:123], v1, s[28:31], s41 offen offset:2048 nt
    v_dot2_f32_bf16 v21, v196, v4, 0
    v_dot2_f32_bf16 v21, v197, v5, v21
    v_dot2_f32_bf16 v21, v198, v6, v21
    v_dot2_f32_bf16 v21, v199, v7, v21
    v_dot2_f32_bf16 v22, v200, v4, 0
    v_dot2_f32_bf16 v22, v201, v5, v22
    v_dot2_f32_bf16 v22, v202, v6, v22
    v_dot2_f32_bf16 v22, v203, v7, v22
    s_waitcnt vmcnt(6)
    s_cbranch_vccnz L_w_81
    s_waitcnt vmcnt(4)
L_w_81:
    buffer_load_dwordx4 v[124:127], v1, s[28:31], s41 offen offset:3072 nt
    v_mov_b32 v250, 80
    ds_write_b32 v248, v250 offset:96
    v_dot2_f32_bf16 v23, v204, v4, 0
    v_dot2_f32_bf16 v23, v205, v5, v23
    v_dot2_f32_bf16 v23, v206, v6, v23
    v_dot2_f32_bf16 v23, v207, v7, v23
    s_waitcnt lgkmcnt(0)
    v_cmp_lt_u32 vcc, v250, v249
    ds_read_b32 v249, v15 offset:28
    v_dot2_f32_bf16 v24, v208, v4, 0
    v_dot2_f32_bf16 v24, v209, v5, v24
    v_dot2_f32_bf16 v24, v210, v6, v24
    v_dot2_f32_bf16 v24, v211, v7, v24
    s_waitcnt vmcnt(6)
    s_cbranch_vccnz L_w_82
    s_waitcnt vmcnt(4)
L_w_82:
    s_add_u32 s41, s41, s42
    buffer_load_dwordx4 v[128:131], v1, s[28:31], s41 offen offset:0 nt
    v_dot2_f32_bf16 v25, v212, v4, 0
    v_dot2_f32_bf16 v25, v213, v5, v25
    v_dot2_f32_bf16 v25, v214, v6, v25
    v_dot2_f32_bf16 v25, v215, v7, v25
    v_dot2_f32_bf16 v26, v216, v4, 0
    v_dot2_f32_bf16 v26, v217, v5, v26
    v_dot2_f32_bf16 v26, v218, v6, v26
    v_dot2_f32_bf16 v26, v219, v7, v26
    s_waitcnt vmcnt(6)
    s_cbranch_vccnz L_w_83
    s_waitcnt vmcnt(4)
L_w_83:
    buffer_load_dwordx4 v[132:135], v1, s[28:31], s41 offen offset:1024 nt
    v_dot2_f32_bf16 v27, v220, v4, 0
    v_dot2_f32_bf16 v27, v221, v5, v27
    v_dot2_f32_bf16 v27, v222, v6, v27
    v_dot2_f32_bf16 v27, v223, v7, v27
    s_waitcnt lgkmcnt(0)
    v_cmp_lt_u32 vcc, v250, v249
    ds_read_b32 v249, v15 offset:28
    v_dot2_f32_bf16 v28, v224, v4, 0
    v_dot2_f32_bf16 v28, v225, v5, v28
    v_dot2_f32_bf16 v28, v226, v6, v28
    v_dot2_f32_bf16 v28, v227, v7, v28
    s_waitcnt vmcnt(6)
    s_cbranch_vccnz L_w_84
    s_waitcnt vmcnt(4)
L_w_84:
    buffer_load_dwordx4 v[136:139], v1, s[28:31], s41 offen offset:2048 nt
    v_dot2_f32_bf16 v29, v228, v4, 0
    v_dot2_f32_bf16 v29, v229, v5, v29
    v_dot2_f32_bf16 v29, v230, v6, v29
    v_dot2_f32_bf16 v29, v231, v7, v29
    v_dot2_f32_bf16 v30, v232, v4, 0
    v_dot2_f32_bf16 v30, v233, v5, v30
    v_dot2_f32_bf16 v30, v234, v6, v30
    v_dot2_f32_bf16 v30, v235, v7, v30
    s_waitcnt vmcnt(6)
    s_cbranch_vccnz L_w_85
    s_waitcnt vmcnt(4)
L_w_85:
    buffer_load_dwordx4 v[140:143], v1, s[28:31], s41 offen offset:3072 nt
    v_mov_b32 v250, 84
    ds_write_b32 v248, v250 offset:96
    ds_read_b128 v[32:35], v247 offset:0
    v_dot2_f32_bf16 v31, v236, v4, 0
    v_dot2_f32_bf16 v31, v237, v5, v31
    v_dot2_f32_bf16 v31, v238, v6, v31
    v_dot2_f32_bf16 v31, v239, v7, v31
    v_permlane16_swap_b32 v16, v24
    v_permlane16_swap_b32 v17, v25
    v_permlane16_swap_b32 v18, v26
    v_permlane16_swap_b32 v19, v27
    v_permlane16_swap_b32 v20, v28
    v_permlane16_swap_b32 v21, v29
    v_permlane16_swap_b32 v22, v30
    v_permlane16_swap_b32 v23, v31
    v_add_f32 v16, v16, v24
    v_add_f32 v17, v17, v25
    v_add_f32 v18, v18, v26
    v_add_f32 v19, v19, v27
    v_add_f32 v20, v20, v28
    v_add_f32 v21, v21, v29
    v_add_f32 v22, v22, v30
    v_add_f32 v23, v23, v31
    v_add_f32_dpp v24, v16, v16 row_ror:8 row_mask:0xf bank_mask:0x3
    v_add_f32_dpp v25, v17, v17 row_ror:8 row_mask:0xf bank_mask:0x3
    v_add_f32_dpp v26, v18, v18 row_ror:8 row_mask:0xf bank_mask:0x3
    v_add_f32_dpp v27, v19, v19 row_ror:8 row_mask:0xf bank_mask:0x3
    v_add_f32_dpp v24, v20, v20 row_ror:8 row_mask:0xf bank_mask:0xc
    v_add_f32_dpp v25, v21, v21 row_ror:8 row_mask:0xf bank_mask:0xc
    v_add_f32_dpp v26, v22, v22 row_ror:8 row_mask:0xf bank_mask:0xc
    v_add_f32_dpp v27, v23, v23 row_ror:8 row_mask:0xf bank_mask:0xc
    v_add_f32_dpp v16, v24, v24 row_shl:4 row_mask:0xf bank_mask:0x5
    v_add_f32_dpp v17, v25, v25 row_shl:4 row_mask:0xf bank_mask:0x5
    s_nop 0
    v_add_f32_dpp v16, v26, v26 row_shr:4 row_mask:0xf bank_mask:0xa
    v_add_f32_dpp v17, v27, v27 row_shr:4 row_mask:0xf bank_mask:0xa
    s_nop 0
    v_add_f32_dpp v16, v16, v16 quad_perm:[1,0,3,2] row_mask:0xf bank_mask:0xf
    v_add_f32_dpp v17, v17, v17 quad_perm:[1,0,3,2] row_mask:0xf bank_mask:0xf
    s_nop 0
    v_add_f32_dpp v16, v16, v16 quad_perm:[2,3,0,1] row_mask:0xf bank_mask:0xf
    v_add_f32_dpp v17, v17, v17 quad_perm:[2,3,0,1] row_mask:0xf bank_mask:0xf
    ds_write_b64 v12, v[16:17] offset:128
    s_waitcnt lgkmcnt(1)
    v_cmp_lt_u32 vcc, v250, v249
    ds_read_b32 v249, v15 offset:28
    s_waitcnt lgkmcnt(0)
    ds_read_b128 v[36:39], v247 offset:1024
    v_dot2_f32_bf16 v16, v32, v4, 0
    v_dot2_f32_bf16 v16, v33, v5, v16
    v_dot2_f32_bf16 v16, v34, v6, v16
    v_dot2_f32_bf16 v16, v35, v7, v16
    s_waitcnt vmcnt(6)
    s_cbranch_vccnz L_w_86
    s_waitcnt vmcnt(4)
L_w_86:
    s_add_u32 s41, s41, s42
    buffer_load_dwordx4 v[144:147], v1, s[28:31], s41 offen offset:0 nt
    s_waitcnt lgkmcnt(0)
    ds_read_b128 v[32:35], v247 offset:2048
    v_dot2_f32_bf16 v17, v36, v4, 0
    v_dot2_f32_bf16 v17, v37, v5, v17
    v_dot2_f32_bf16 v17, v38, v6, v17
    v_dot2_f32_bf16 v17, v39, v7, v17
    s_waitcnt lgkmcnt(0)
    ds_read_b128 v[36:39], v247 offset:3072
    v_dot2_f32_bf16 v18, v32, v4, 0
    v_dot2_f32_bf16 v18, v33, v5, v18
    v_dot2_f32_bf16 v18, v34, v6, v18
    v_dot2_f32_bf16 v18, v35, v7, v18
    s_waitcnt vmcnt(6)
    s_cbranch_vccnz L_w_87
    s_waitcnt vmcnt(4)
L_w_87:
    buffer_load_dwordx4 v[148:151], v1, s[28:31], s41 offen offset:1024 nt
    s_waitcnt lgkmcnt(0)
    ds_read_b128 v[32:35], v247 offset:4096
    v_dot2_f32_bf16 v19, v36, v4, 0
    v_dot2_f32_bf16 v19, v37, v5, v19
    v_dot2_f32_bf16 v19, v38, v6, v19
    v_dot2_f32_bf16 v19, v39, v7, v19
    s_waitcnt lgkmcnt(0)
    v_cmp_lt_u32 vcc, v250, v249
    ds_read_b32 v249, v15 offset:28
    s_waitcnt lgkmcnt(0)
    ds_read_b128 v[36:39], v247 offset:5120
    v_dot2_f32_bf16 v20, v32, v4, 0
    v_dot2_f32_bf16 v20, v33, v5, v20
    v_dot2_f32_bf16 v20, v34, v6, v20
    v_dot2_f32_bf16 v20, v35, v7, v20
    s_waitcnt vmcnt(6)
    s_cbranch_vccnz L_w_88
    s_waitcnt vmcnt(4)
L_w_88:
    buffer_load_dwordx4 v[152:155], v1, s[28:31], s41 offen offset:2048 nt
    s_waitcnt lgkmcnt(0)
    ds_read_b128 v[32:35], v247 offset:6144
    v_dot2_f32_bf16 v21, v36, v4, 0
    v_dot2_f32_bf16 v21, v37, v5, v21
    v_dot2_f32_bf16 v21, v38, v6, v21
    v_dot2_f32_bf16 v21, v39, v7, v21
    s_waitcnt lgkmcnt(0)
    ds_read_b128 v[36:39], v247 offset:7168
    v_dot2_f32_bf16 v22, v32, v4, 0
    v_dot2_f32_bf16 v22, v33, v5, v22
    v_dot2_f32_bf16 v22, v34, v6, v22
    v_dot2_f32_bf16 v22, v35, v7, v22
    s_waitcnt vmcnt(6)
    s_cbranch_vccnz L_w_89
    s_waitcnt vmcnt(4)
L_w_89:
    buffer_load_dwordx4 v[156:159], v1, s[28:31], s41 offen offset:3072 nt
    v_mov_b32 v250, 88
    ds_write_b32 v248, v250 offset:96
    s_waitcnt lgkmcnt(0)
    ds_read_b128 v[32:35], v247 offset:8192
    v_dot2_f32_bf16 v23, v36, v4, 0
    v_dot2_f32_bf16 v23, v37, v5, v23
    v_dot2_f32_bf16 v23, v38, v6, v23
    v_dot2_f32_bf16 v23, v39, v7, v23
    s_waitcnt lgkmcnt(0)
    v_cmp_lt_u32 vcc, v250, v249
    ds_read_b32 v249, v15 offset:28
    s_waitcnt lgkmcnt(0)
    ds_read_b128 v[36:39], v247 offset:9216
    v_dot2_f32_bf16 v24, v32, v4, 0
    v_dot2_f32_bf16 v24, v33, v5, v24
    v_dot2_f32_bf16 v24, v34, v6, v24
    v_dot2_f32_bf16 v24, v35, v7, v24
    s_waitcnt vmcnt(6)
    s_cbranch_vccnz L_w_90
    s_waitcnt vmcnt(4)
L_w_90:
    s_add_u32 s41, s41, s42
    buffer_load_dwordx4 v[160:163], v1, s[28:31], s41 offen offset:0 nt
    s_waitcnt lgkmcnt(0)
    ds_read_b128 v[32:35], v247 offset:10240
    v_dot2_f32_bf16 v25, v36, v4, 0
    v_dot2_f32_bf16 v25, v37, v5, v25
    v_dot2_f32_bf16 v25, v38, v6, v25
    v_dot2_f32_bf16 v25, v39, v7, v25
    s_waitcnt lgkmcnt(0)
    ds_read_b128 v[36:39], v247 offset:11264
    v_dot2_f32_bf16 v26, v32, v4, 0
    v_dot2_f32_bf16 v26, v33, v5, v26
    v_dot2_f32_bf16 v26, v34, v6, v26
    v_dot2_f32_bf16 v26, v35, v7, v26
    s_waitcnt vmcnt(6)
    s_cbranch_vccnz L_w_91
    s_waitcnt vmcnt(4)
L_w_91:
    buffer_load_dwordx4 v[164:167], v1, s[28:31], s41 offen offset:1024 nt
    s_waitcnt lgkmcnt(0)
    v_dot2_f32_bf16 v27, v36, v4, 0
    v_dot2_f32_bf16 v27, v37, v5, v27
    v_dot2_f32_bf16 v27, v38, v6, v27
    v_dot2_f32_bf16 v27, v39, v7, v27
    s_waitcnt lgkmcnt(0)
    v_cmp_lt_u32 vcc, v250, v249
    ds_read_b32 v249, v15 offset:28
    v_dot2_f32_bf16 v28, v48, v4, 0
    v_dot2_f32_bf16 v28, v49, v5, v28
    v_dot2_f32_bf16 v28, v50, v6, v28
    v_dot2_f32_bf16 v28, v51, v7, v28
    s_waitcnt vmcnt(6)
    s_cbranch_vccnz L_w_92
    s_waitcnt vmcnt(4)
L_w_92:
    buffer_load_dwordx4 v[168:171], v1, s[28:31], s41 offen offset:2048 nt
    v_dot2_f32_bf16 v29, v52, v4, 0
    v_dot2_f32_bf16 v29, v53, v5, v29
    v_dot2_f32_bf16 v29, v54, v6, v29
    v_dot2_f32_bf16 v29, v55, v7, v29
    v_dot2_f32_bf16 v30, v56, v4, 0
    v_dot2_f32_bf16 v30, v57, v5, v30
    v_dot2_f32_bf16 v30, v58, v6, v30
    v_dot2_f32_bf16 v30, v59, v7, v30
    s_waitcnt vmcnt(6)
    s_cbranch_vccnz L_w_93
    s_waitcnt vmcnt(4)
L_w_93:
    buffer_load_dwordx4 v[172:175], v1, s[28:31], s41 offen offset:3072 nt
    v_mov_b32 v250, 92
    ds_write_b32 v248, v250 offset:96
    v_dot2_f32_bf16 v31, v60, v4, 0
    v_dot2_f32_bf16 v31, v61, v5, v31
    v_dot2_f32_bf16 v31, v62, v6, v31
    v_dot2_f32_bf16 v31, v63, v7, v31
    v_permlane16_swap_b32 v16, v24
    v_permlane16_swap_b32 v17, v25
    v_permlane16_swap_b32 v18, v26
    v_permlane16_swap_b32 v19, v27
    v_permlane16_swap_b32 v20, v28
    v_permlane16_swap_b32 v21, v29
    v_permlane16_swap_b32 v22, v30
    v_permlane16_swap_b32 v23, v31
    v_add_f32 v16, v16, v24
    v_add_f32 v17, v17, v25
    v_add_f32 v18, v18, v26
    v_add_f32 v19, v19, v27
    v_add_f32 v20, v20, v28
    v_add_f32 v21, v21, v29
    v_add_f32 v22, v22, v30
    v_add_f32 v23, v23, v31
    v_add_f32_dpp v24, v16, v16 row_ror:8 row_mask:0xf bank_mask:0x3
    v_add_f32_dpp v25, v17, v17 row_ror:8 row_mask:0xf bank_mask:0x3
    v_add_f32_dpp v26, v18, v18 row_ror:8 row_mask:0xf bank_mask:0x3
    v_add_f32_dpp v27, v19, v19 row_ror:8 row_mask:0xf bank_mask:0x3
    v_add_f32_dpp v24, v20, v20 row_ror:8 row_mask:0xf bank_mask:0xc
    v_add_f32_dpp v25, v21, v21 row_ror:8 row_mask:0xf bank_mask:0xc
    v_add_f32_dpp v26, v22, v22 row_ror:8 row_mask:0xf bank_mask:0xc
    v_add_f32_dpp v27, v23, v23 row_ror:8 row_mask:0xf bank_mask:0xc
    v_add_f32_dpp v16, v24, v24 row_shl:4 row_mask:0xf bank_mask:0x5
    v_add_f32_dpp v17, v25, v25 row_shl:4 row_mask:0xf bank_mask:0x5
    s_nop 0
    v_add_f32_dpp v16, v26, v26 row_shr:4 row_mask:0xf bank_mask:0xa
    v_add_f32_dpp v17, v27, v27 row_shr:4 row_mask:0xf bank_mask:0xa
    s_nop 0
    v_add_f32_dpp v16, v16, v16 quad_perm:[1,0,3,2] row_mask:0xf bank_mask:0xf
    v_add_f32_dpp v17, v17, v17 quad_perm:[1,0,3,2] row_mask:0xf bank_mask:0xf
    s_nop 0
    v_add_f32_dpp v16, v16, v16 quad_perm:[2,3,0,1] row_mask:0xf bank_mask:0xf
    v_add_f32_dpp v17, v17, v17 quad_perm:[2,3,0,1] row_mask:0xf bank_mask:0xf
    ds_write_b64 v12, v[16:17] offset:192
    s_waitcnt lgkmcnt(1)
    v_cmp_lt_u32 vcc, v250, v249
    ds_read_b32 v249, v15 offset:28
    v_dot2_f32_bf16 v16, v64, v4, 0
    v_dot2_f32_bf16 v16, v65, v5, v16
    v_dot2_f32_bf16 v16, v66, v6, v16
    v_dot2_f32_bf16 v16, v67, v7, v16
    s_waitcnt vmcnt(6)
    s_cbranch_vccnz L_w_94
    s_waitcnt vmcnt(4)
L_w_94:
    s_add_u32 s41, s41, s42
    buffer_load_dwordx4 v[176:179], v1, s[28:31], s41 offen offset:0 nt
    v_dot2_f32_bf16 v17, v68, v4, 0
    v_dot2_f32_bf16 v17, v69, v5, v17
    v_dot2_f32_bf16 v17, v70, v6, v17
    v_dot2_f32_bf16 v17, v71, v7, v17
    v_dot2_f32_bf16 v18, v72, v4, 0
    v_dot2_f32_bf16 v18, v73, v5, v18
    v_dot2_f32_bf16 v18, v74, v6, v18
    v_dot2_f32_bf16 v18, v75, v7, v18
    s_waitcnt vmcnt(6)
    s_cbranch_vccnz L_w_95
    s_waitcnt vmcnt(4)
L_w_95:
    buffer_load_dwordx4 v[180:183], v1, s[28:31], s41 offen offset:1024 nt
    v_dot2_f32_bf16 v19, v76, v4, 0
    v_dot2_f32_bf16 v19, v77, v5, v19
    v_dot2_f32_bf16 v19, v78, v6, v19
    v_dot2_f32_bf16 v19, v79, v7, v19
    s_waitcnt lgkmcnt(0)
    v_cmp_lt_u32 vcc, v250, v249
    ds_read_b32 v249, v15 offset:28
    v_dot2_f32_bf16 v20, v80, v4, 0
    v_dot2_f32_bf16 v20, v81, v5, v20
    v_dot2_f32_bf16 v20, v82, v6, v20
    v_dot2_f32_bf16 v20, v83, v7, v20
    s_waitcnt vmcnt(6)
    s_cbranch_vccnz L_w_96
    s_waitcnt vmcnt(4)
L_w_96:
    buffer_load_dwordx4 v[184:187], v1, s[28:31], s41 offen offset:2048 nt
    v_dot2_f32_bf16 v21, v84, v4, 0
    v_dot2_f32_bf16 v21, v85, v5, v21
    v_dot2_f32_bf16 v21, v86, v6, v21
    v_dot2_f32_bf16 v21, v87, v7, v21
    v_dot2_f32_bf16 v22, v88, v4, 0
    v_dot2_f32_bf16 v22, v89, v5, v22
    v_dot2_f32_bf16 v22, v90, v6, v22
    v_dot2_f32_bf16 v22, v91, v7, v22
    s_waitcnt vmcnt(6)
    s_cbranch_vccnz L_w_97
    s_waitcnt vmcnt(4)
L_w_97:
    buffer_load_dwordx4 v[188:191], v1, s[28:31], s41 offen offset:3072 nt
    v_mov_b32 v250, 96
    ds_write_b32 v248, v250 offset:96
    v_dot2_f32_bf16 v23, v92, v4, 0
    v_dot2_f32_bf16 v23, v93, v5, v23
    v_dot2_f32_bf16 v23, v94, v6, v23
    v_dot2_f32_bf16 v23, v95, v7, v23
    s_waitcnt lgkmcnt(0)
    v_cmp_lt_u32 vcc, v250, v249
    ds_read_b32 v249, v15 offset:28
    v_dot2_f32_bf16 v24, v96, v4, 0
    v_dot2_f32_bf16 v24, v97, v5, v24
    v_dot2_f32_bf16 v24, v98, v6, v24
    v_dot2_f32_bf16 v24, v99, v7, v24
    s_waitcnt vmcnt(6)
    s_cbranch_vccnz L_w_98
    s_waitcnt vmcnt(4)
L_w_98:
    s_add_u32 s41, s41, s42
    buffer_load_dwordx4 v[192:195], v1, s[28:31], s41 offen offset:0 nt
    v_dot2_f32_bf16 v25, v100, v4, 0
    v_dot2_f32_bf16 v25, v101, v5, v25
    v_dot2_f32_bf16 v25, v102, v6, v25
    v_dot2_f32_bf16 v25, v103, v7, v25
    v_dot2_f32_bf16 v26, v104, v4, 0
    v_dot2_f32_bf16 v26, v105, v5, v26
    v_dot2_f32_bf16 v26, v106, v6, v26
    v_dot2_f32_bf16 v26, v107, v7, v26
    s_waitcnt vmcnt(6)
    s_cbranch_vccnz L_w_99
    s_waitcnt vmcnt(4)
L_w_99:
    buffer_load_dwordx4 v[196:199], v1, s[28:31], s41 offen offset:1024 nt
    v_dot2_f32_bf16 v27, v108, v4, 0
    v_dot2_f32_bf16 v27, v109, v5, v27
    v_dot2_f32_bf16 v27, v110, v6, v27
    v_dot2_f32_bf16 v27, v111, v7, v27
    s_waitcnt lgkmcnt(0)
    v_cmp_lt_u32 vcc, v250, v249
    ds_read_b32 v249, v15 offset:28
    v_dot2_f32_bf16 v28, v112, v4, 0
    v_dot2_f32_bf16 v28, v113, v5, v28
    v_dot2_f32_bf16 v28, v114, v6, v28
    v_dot2_f32_bf16 v28, v115, v7, v28
    s_waitcnt vmcnt(6)
    s_cbranch_vccnz L_w_100
    s_waitcnt vmcnt(4)
L_w_100:
    buffer_load_dwordx4 v[200:203], v1, s[28:31], s41 offen offset:2048 nt
    v_dot2_f32_bf16 v29, v116, v4, 0
    v_dot2_f32_bf16 v29, v117, v5, v29
    v_dot2_f32_bf16 v29, v118, v6, v29
    v_dot2_f32_bf16 v29, v119, v7, v29
    v_dot2_f32_bf16 v30, v120, v4, 0
    v_dot2_f32_bf16 v30, v121, v5, v30
    v_dot2_f32_bf16 v30, v122, v6, v30
    v_dot2_f32_bf16 v30, v123, v7, v30
    s_waitcnt vmcnt(6)
    s_cbranch_vccnz L_w_101
    s_waitcnt vmcnt(4)
L_w_101:
    buffer_load_dwordx4 v[204:207], v1, s[28:31], s41 offen offset:3072 nt
    v_mov_b32 v250, 100
    ds_write_b32 v248, v250 offset:96
    v_dot2_f32_bf16 v31, v124, v4, 0
    v_dot2_f32_bf16 v31, v125, v5, v31
    v_dot2_f32_bf16 v31, v126, v6, v31
    v_dot2_f32_bf16 v31, v127, v7, v31
    v_permlane16_swap_b32 v16, v24
    v_permlane16_swap_b32 v17, v25
    v_permlane16_swap_b32 v18, v26
    v_permlane16_swap_b32 v19, v27
    v_permlane16_swap_b32 v20, v28
    v_permlane16_swap_b32 v21, v29
    v_permlane16_swap_b32 v22, v30
    v_permlane16_swap_b32 v23, v31
    v_add_f32 v16, v16, v24
    v_add_f32 v17, v17, v25
    v_add_f32 v18, v18, v26
    v_add_f32 v19, v19, v27
    v_add_f32 v20, v20, v28
    v_add_f32 v21, v21, v29
    v_add_f32 v22, v22, v30
    v_add_f32 v23, v23, v31
    v_add_f32_dpp v24, v16, v16 row_ror:8 row_mask:0xf bank_mask:0x3
    v_add_f32_dpp v25, v17, v17 row_ror:8 row_mask:0xf bank_mask:0x3
    v_add_f32_dpp v26, v18, v18 row_ror:8 row_mask:0xf bank_mask:0x3
    v_add_f32_dpp v27, v19, v19 row_ror:8 row_mask:0xf bank_mask:0x3
    v_add_f32_dpp v24, v20, v20 row_ror:8 row_mask:0xf bank_mask:0xc
    v_add_f32_dpp v25, v21, v21 row_ror:8 row_mask:0xf bank_mask:0xc
    v_add_f32_dpp v26, v22, v22 row_ror:8 row_mask:0xf bank_mask:0xc
    v_add_f32_dpp v27, v23, v23 row_ror:8 row_mask:0xf bank_mask:0xc
    v_add_f32_dpp v16, v24, v24 row_shl:4 row_mask:0xf bank_mask:0x5
    v_add_f32_dpp v17, v25, v25 row_shl:4 row_mask:0xf bank_mask:0x5
    s_nop 0
    v_add_f32_dpp v16, v26, v26 row_shr:4 row_mask:0xf bank_mask:0xa
    v_add_f32_dpp v17, v27, v27 row_shr:4 row_mask:0xf bank_mask:0xa
    s_nop 0
    v_add_f32_dpp v16, v16, v16 quad_perm:[1,0,3,2] row_mask:0xf bank_mask:0xf
    v_add_f32_dpp v17, v17, v17 quad_perm:[1,0,3,2] row_mask:0xf bank_mask:0xf
    s_nop 0
    v_add_f32_dpp v16, v16, v16 quad_perm:[2,3,0,1] row_mask:0xf bank_mask:0xf
    v_add_f32_dpp v17, v17, v17 quad_perm:[2,3,0,1] row_mask:0xf bank_mask:0xf
    ds_write_b64 v12, v[16:17] offset:256
    s_waitcnt lgkmcnt(1)
    v_cmp_lt_u32 vcc, v250, v249
    ds_read_b32 v249, v15 offset:28
    v_dot2_f32_bf16 v16, v128, v4, 0
    v_dot2_f32_bf16 v16, v129, v5, v16
    v_dot2_f32_bf16 v16, v130, v6, v16
    v_dot2_f32_bf16 v16, v131, v7, v16
    s_waitcnt vmcnt(6)
    s_cbranch_vccnz L_w_102
    s_waitcnt vmcnt(4)
L_w_102:
    s_add_u32 s41, s41, s42
    buffer_load_dwordx4 v[208:211], v1, s[28:31], s41 offen offset:0 nt
    v_dot2_f32_bf16 v17, v132, v4, 0
    v_dot2_f32_bf16 v17, v133, v5, v17
    v_dot2_f32_bf16 v17, v134, v6, v17
    v_dot2_f32_bf16 v17, v135, v7, v17
    v_dot2_f32_bf16 v18, v136, v4, 0
    v_dot2_f32_bf16 v18, v137, v5, v18
    v_dot2_f32_bf16 v18, v138, v6, v18
    v_dot2_f32_bf16 v18, v139, v7, v18
    s_waitcnt vmcnt(6)
    s_cbranch_vccnz L_w_103
    s_waitcnt vmcnt(4)
L_w_103:
    buffer_load_dwordx4 v[212:215], v1, s[28:31], s41 offen offset:1024 nt
    v_dot2_f32_bf16 v19, v140, v4, 0
    v_dot2_f32_bf16 v19, v141, v5, v19
    v_dot2_f32_bf16 v19, v142, v6, v19
    v_dot2_f32_bf16 v19, v143, v7, v19
    s_waitcnt lgkmcnt(0)
    v_cmp_lt_u32 vcc, v250, v249
    ds_read_b32 v249, v15 offset:28
    v_dot2_f32_bf16 v20, v144, v4, 0
    v_dot2_f32_bf16 v20, v145, v5, v20
    v_dot2_f32_bf16 v20, v146, v6, v20
    v_dot2_f32_bf16 v20, v147, v7, v20
    s_waitcnt vmcnt(6)
    s_cbranch_vccnz L_w_104
    s_waitcnt vmcnt(4)
L_w_104:
    buffer_load_dwordx4 v[216:219], v1, s[28:31], s41 offen offset:2048 nt
    v_dot2_f32_bf16 v21, v148, v4, 0
    v_dot2_f32_bf16 v21, v149, v5, v21
    v_dot2_f32_bf16 v21, v150, v6, v21
    v_dot2_f32_bf16 v21, v151, v7, v21
    v_dot2_f32_bf16 v22, v152, v4, 0
    v_dot2_f32_bf16 v22, v153, v5, v22
    v_dot2_f32_bf16 v22, v154, v6, v22
    v_dot2_f32_bf16 v22, v155, v7, v22
    s_waitcnt vmcnt(6)
    s_cbranch_vccnz L_w_105
    s_waitcnt vmcnt(4)
L_w_105:
    buffer_load_dwordx4 v[220:223], v1, s[28:31], s41 offen offset:3072 nt
    v_mov_b32 v250, 104
    ds_write_b32 v248, v250 offset:96
    v_dot2_f32_bf16 v23, v156, v4, 0
    v_dot2_f32_bf16 v23, v157, v5, v23
    v_dot2_f32_bf16 v23, v158, v6, v23
    v_dot2_f32_bf16 v23, v159, v7, v23
    s_waitcnt lgkmcnt(0)
    v_cmp_lt_u32 vcc, v250, v249
    ds_read_b32 v249, v15 offset:28
    v_dot2_f32_bf16 v24, v160, v4, 0
    v_dot2_f32_bf16 v24, v161, v5, v24
    v_dot2_f32_bf16 v24, v162, v6, v24
    v_dot2_f32_bf16 v24, v163, v7, v24
    s_waitcnt vmcnt(6)
    s_cbranch_vccnz L_w_106
    s_waitcnt vmcnt(4)
L_w_106:
    s_add_u32 s41, s41, s42
    buffer_load_dwordx4 v[224:227], v1, s[28:31], s41 offen offset:0 nt
    v_dot2_f32_bf16 v25, v164, v4, 0
    v_dot2_f32_bf16 v25, v165, v5, v25
    v_dot2_f32_bf16 v25, v166, v6, v25
    v_dot2_f32_bf16 v25, v167, v7, v25
    v_dot2_f32_bf16 v26, v168, v4, 0
    v_dot2_f32_bf16 v26, v169, v5, v26
    v_dot2_f32_bf16 v26, v170, v6, v26
    v_dot2_f32_bf16 v26, v171, v7, v26
    s_waitcnt vmcnt(6)
    s_cbranch_vccnz L_w_107
    s_waitcnt vmcnt(4)
L_w_107:
    buffer_load_dwordx4 v[228:231], v1, s[28:31], s41 offen offset:1024 nt
    v_dot2_f32_bf16 v27, v172, v4, 0
    v_dot2_f32_bf16 v27, v173, v5, v27
    v_dot2_f32_bf16 v27, v174, v6, v27
    v_dot2_f32_bf16 v27, v175, v7, v27
    s_waitcnt lgkmcnt(0)
    v_cmp_lt_u32 vcc, v250, v249
    ds_read_b32 v249, v15 offset:28
    v_dot2_f32_bf16 v28, v176, v4, 0
    v_dot2_f32_bf16 v28, v177, v5, v28
    v_dot2_f32_bf16 v28, v178, v6, v28
    v_dot2_f32_bf16 v28, v179, v7, v28
    s_waitcnt vmcnt(6)
    s_cbranch_vccnz L_w_108
    s_waitcnt vmcnt(4)
L_w_108:
    buffer_load_dwordx4 v[232:235], v1, s[28:31], s41 offen offset:2048 nt
    v_dot2_f32_bf16 v29, v180, v4, 0
    v_dot2_f32_bf16 v29, v181, v5, v29
    v_dot2_f32_bf16 v29, v182, v6, v29
    v_dot2_f32_bf16 v29, v183, v7, v29
    v_dot2_f32_bf16 v30, v184, v4, 0
    v_dot2_f32_bf16 v30, v185, v5, v30
    v_dot2_f32_bf16 v30, v186, v6, v30
    v_dot2_f32_bf16 v30, v187, v7, v30
    s_waitcnt vmcnt(6)
    s_cbranch_vccnz L_w_109
    s_waitcnt vmcnt(4)
L_w_109:
    buffer_load_dwordx4 v[236:239], v1, s[28:31], s41 offen offset:3072 nt
    v_mov_b32 v250, 108
    ds_write_b32 v248, v250 offset:96
    v_dot2_f32_bf16 v31, v188, v4, 0
    v_dot2_f32_bf16 v31, v189, v5, v31
    v_dot2_f32_bf16 v31, v190, v6, v31
    v_dot2_f32_bf16 v31, v191, v7, v31
    v_permlane16_swap_b32 v16, v24
    v_permlane16_swap_b32 v17, v25
    v_permlane16_swap_b32 v18, v26
    v_permlane16_swap_b32 v19, v27
    v_permlane16_swap_b32 v20, v28
    v_permlane16_swap_b32 v21, v29
    v_permlane16_swap_b32 v22, v30
    v_permlane16_swap_b32 v23, v31
    v_add_f32 v16, v16, v24
    v_add_f32 v17, v17, v25
    v_add_f32 v18, v18, v26
    v_add_f32 v19, v19, v27
    v_add_f32 v20, v20, v28
    v_add_f32 v21, v21, v29
    v_add_f32 v22, v22, v30
    v_add_f32 v23, v23, v31
    v_add_f32_dpp v24, v16, v16 row_ror:8 row_mask:0xf bank_mask:0x3
    v_add_f32_dpp v25, v17, v17 row_ror:8 row_mask:0xf bank_mask:0x3
    v_add_f32_dpp v26, v18, v18 row_ror:8 row_mask:0xf bank_mask:0x3
    v_add_f32_dpp v27, v19, v19 row_ror:8 row_mask:0xf bank_mask:0x3
    v_add_f32_dpp v24, v20, v20 row_ror:8 row_mask:0xf bank_mask:0xc
    v_add_f32_dpp v25, v21, v21 row_ror:8 row_mask:0xf bank_mask:0xc
    v_add_f32_dpp v26, v22, v22 row_ror:8 row_mask:0xf bank_mask:0xc
    v_add_f32_dpp v27, v23, v23 row_ror:8 row_mask:0xf bank_mask:0xc
    v_add_f32_dpp v16, v24, v24 row_shl:4 row_mask:0xf bank_mask:0x5
    v_add_f32_dpp v17, v25, v25 row_shl:4 row_mask:0xf bank_mask:0x5
    s_nop 0
    v_add_f32_dpp v16, v26, v26 row_shr:4 row_mask:0xf bank_mask:0xa
    v_add_f32_dpp v17, v27, v27 row_shr:4 row_mask:0xf bank_mask:0xa
    s_nop 0
    v_add_f32_dpp v16, v16, v16 quad_perm:[1,0,3,2] row_mask:0xf bank_mask:0xf
    v_add_f32_dpp v17, v17, v17 quad_perm:[1,0,3,2] row_mask:0xf bank_mask:0xf
    s_nop 0
    v_add_f32_dpp v16, v16, v16 quad_perm:[2,3,0,1] row_mask:0xf bank_mask:0xf
    v_add_f32_dpp v17, v17, v17 quad_perm:[2,3,0,1] row_mask:0xf bank_mask:0xf
    ds_write_b64 v12, v[16:17] offset:320
    s_waitcnt lgkmcnt(1)
    v_cmp_lt_u32 vcc, v250, v249
    ds_read_b32 v249, v15 offset:28
    v_dot2_f32_bf16 v16, v192, v4, 0
    v_dot2_f32_bf16 v16, v193, v5, v16
    v_dot2_f32_bf16 v16, v194, v6, v16
    v_dot2_f32_bf16 v16, v195, v7, v16
    s_waitcnt vmcnt(6)
    s_cbranch_vccnz L_w_110
    s_waitcnt vmcnt(4)
L_w_110:
    s_add_u32 s41, s41, s42
    buffer_load_dwordx4 v[48:51], v1, s[28:31], s41 offen offset:0 nt
    v_dot2_f32_bf16 v17, v196, v4, 0
    v_dot2_f32_bf16 v17, v197, v5, v17
    v_dot2_f32_bf16 v17, v198, v6, v17
    v_dot2_f32_bf16 v17, v199, v7, v17
    v_dot2_f32_bf16 v18, v200, v4, 0
    v_dot2_f32_bf16 v18, v201, v5, v18
    v_dot2_f32_bf16 v18, v202, v6, v18
    v_dot2_f32_bf16 v18, v203, v7, v18
    s_waitcnt vmcnt(6)
    s_cbranch_vccnz L_w_111
    s_waitcnt vmcnt(4)
L_w_111:
    buffer_load_dwordx4 v[52:55], v1, s[28:31], s41 offen offset:1024 nt
    v_dot2_f32_bf16 v19, v204, v4, 0
    v_dot2_f32_bf16 v19, v205, v5, v19
    v_dot2_f32_bf16 v19, v206, v6, v19
    v_dot2_f32_bf16 v19, v207, v7, v19
    s_waitcnt lgkmcnt(0)
    v_cmp_lt_u32 vcc, v250, v249
    ds_read_b32 v249, v15 offset:28
    v_dot2_f32_bf16 v20, v208, v4, 0
    v_dot2_f32_bf16 v20, v209, v5, v20
    v_dot2_f32_bf16 v20, v210, v6, v20
    v_dot2_f32_bf16 v20, v211, v7, v20
    s_waitcnt vmcnt(6)
    s_cbranch_vccnz L_w_112
    s_waitcnt vmcnt(4)
L_w_112:
    buffer_load_dwordx4 v[56:59], v1, s[28:31], s41 offen offset:2048 nt
    v_dot2_f32_bf16 v21, v212, v4, 0
    v_dot2_f32_bf16 v21, v213, v5, v21
    v_dot2_f32_bf16 v21, v214, v6, v21
    v_dot2_f32_bf16 v21, v215, v7, v21
    v_dot2_f32_bf16 v22, v216, v4, 0
    v_dot2_f32_bf16 v22, v217, v5, v22
    v_dot2_f32_bf16 v22, v218, v6, v22
    v_dot2_f32_bf16 v22, v219, v7, v22
    s_waitcnt vmcnt(6)
    s_cbranch_vccnz L_w_113
    s_waitcnt vmcnt(4)
L_w_113:
    buffer_load_dwordx4 v[60:63], v1, s[28:31], s41 offen offset:3072 nt
    v_mov_b32 v250, 112
    ds_write_b32 v248, v250 offset:96
    v_dot2_f32_bf16 v23, v220, v4, 0
    v_dot2_f32_bf16 v23, v221, v5, v23
    v_dot2_f32_bf16 v23, v222, v6, v23
    v_dot2_f32_bf16 v23, v223, v7, v23
    s_waitcnt lgkmcnt(0)
    v_cmp_lt_u32 vcc, v250, v249
    ds_read_b32 v249, v15 offset:28
    v_dot2_f32_bf16 v24, v224, v4, 0
    v_dot2_f32_bf16 v24, v225, v5, v24
    v_dot2_f32_bf16 v24, v226, v6, v24
    v_dot2_f32_bf16 v24, v227, v7, v24
    s_waitcnt vmcnt(6)
    s_cbranch_vccnz L_w_114
    s_waitcnt vmcnt(4)
L_w_114:
    s_add_u32 s41, s41, s42
    buffer_load_dwordx4 v[64:67], v1, s[28:31], s41 offen offset:0 nt
    v_dot2_f32_bf16 v25, v228, v4, 0
    v_dot2_f32_bf16 v25, v229, v5, v25
    v_dot2_f32_bf16 v25, v230, v6, v25
    v_dot2_f32_bf16 v25, v231, v7, v25
    s_waitcnt vmcnt(6)
    s_cbranch_vccnz L_w_115
    s_waitcnt vmcnt(4)
L_w_115:
    buffer_load_dwordx4 v[68:71], v1, s[28:31], s41 offen offset:1024 nt
    v_dot2_f32_bf16 v26, v232, v4, 0
    v_dot2_f32_bf16 v26, v233, v5, v26
    v_dot2_f32_bf16 v26, v234, v6, v26
    v_dot2_f32_bf16 v26, v235, v7, v26
    s_waitcnt vmcnt(6)
    s_cbranch_vccnz L_w_116
    s_waitcnt vmcnt(4)
L_w_116:
    buffer_load_dwordx4 v[72:75], v1, s[28:31], s41 offen offset:2048 nt
    v_dot2_f32_bf16 v27, v236, v4, 0
    v_dot2_f32_bf16 v27, v237, v5, v27
    v_dot2_f32_bf16 v27, v238, v6, v27
    v_dot2_f32_bf16 v27, v239, v7, v27
    s_waitcnt lgkmcnt(0)
    v_cmp_lt_u32 vcc, v250, v249
    ds_read_b32 v249, v15 offset:28
    s_waitcnt vmcnt(6)
    s_cbranch_vccnz L_w_117
    s_waitcnt vmcnt(4)
L_w_117:
    buffer_load_dwordx4 v[76:79], v1, s[28:31], s41 offen offset:3072 nt
    v_mov_b32 v250, 116
    ds_write_b32 v248, v250 offset:96
    v_dot2_f32_bf16 v28, v48, v4, 0
    v_dot2_f32_bf16 v28, v49, v5, v28
    v_dot2_f32_bf16 v28, v50, v6, v28
    v_dot2_f32_bf16 v28, v51, v7, v28
    s_waitcnt vmcnt(6)
    s_cbranch_vccnz L_w_118
    s_waitcnt vmcnt(4)
L_w_118:
    s_add_u32 s41, s41, s42
    buffer_load_dwordx4 v[80:83], v1, s[28:31], s41 offen offset:0 nt
    v_dot2_f32_bf16 v29, v52, v4, 0
    v_dot2_f32_bf16 v29, v53, v5, v29
    v_dot2_f32_bf16 v29, v54, v6, v29
    v_dot2_f32_bf16 v29, v55, v7, v29
    s_waitcnt vmcnt(6)
    s_cbranch_vccnz L_w_119
    s_waitcnt vmcnt(4)
L_w_119:
    buffer_load_dwordx4 v[84:87], v1, s[28:31], s41 offen offset:1024 nt
    v_dot2_f32_bf16 v30, v56, v4, 0
    v_dot2_f32_bf16 v30, v57, v5, v30
    v_dot2_f32_bf16 v30, v58, v6, v30
    v_dot2_f32_bf16 v30, v59, v7, v30
    s_waitcnt vmcnt(6)
    s_cbranch_vccnz L_w_120
    s_waitcnt vmcnt(4)
L_w_120:
    buffer_load_dwordx4 v[88:91], v1, s[28:31], s41 offen offset:2048 nt
    v_dot2_f32_bf16 v31, v60, v4, 0
    v_dot2_f32_bf16 v31, v61, v5, v31
    v_dot2_f32_bf16 v31, v62, v6, v31
    v_dot2_f32_bf16 v31, v63, v7, v31
    v_permlane16_swap_b32 v16, v24
    v_permlane16_swap_b32 v17, v25
    v_permlane16_swap_b32 v18, v26
    v_permlane16_swap_b32 v19, v27
    v_permlane16_swap_b32 v20, v28
    v_permlane16_swap_b32 v21, v29
    v_permlane16_swap_b32 v22, v30
    v_permlane16_swap_b32 v23, v31
    v_add_f32 v16, v16, v24
    v_add_f32 v17, v17, v25
    v_add_f32 v18, v18, v26
    v_add_f32 v19, v19, v27
    v_add_f32 v20, v20, v28
    v_add_f32 v21, v21, v29
    v_add_f32 v22, v22, v30
    v_add_f32 v23, v23, v31
    v_add_f32_dpp v24, v16, v16 row_ror:8 row_mask:0xf bank_mask:0x3
    v_add_f32_dpp v25, v17, v17 row_ror:8 row_mask:0xf bank_mask:0x3
    v_add_f32_dpp v26, v18, v18 row_ror:8 row_mask:0xf bank_mask:0x3
    v_add_f32_dpp v27, v19, v19 row_ror:8 row_mask:0xf bank_mask:0x3
    v_add_f32_dpp v24, v20, v20 row_ror:8 row_mask:0xf bank_mask:0xc
    v_add_f32_dpp v25, v21, v21 row_ror:8 row_mask:0xf bank_mask:0xc
    v_add_f32_dpp v26, v22, v22 row_ror:8 row_mask:0xf bank_mask:0xc
    v_add_f32_dpp v27, v23, v23 row_ror:8 row_mask:0xf bank_mask:0xc
    v_add_f32_dpp v16, v24, v24 row_shl:4 row_mask:0xf bank_mask:0x5
    v_add_f32_dpp v17, v25, v25 row_shl:4 row_mask:0xf bank_mask:0x5
    s_nop 0
    v_add_f32_dpp v16, v26, v26 row_shr:4 row_mask:0xf bank_mask:0xa
    v_add_f32_dpp v17, v27, v27 row_shr:4 row_mask:0xf bank_mask:0xa
    s_nop 0
    v_add_f32_dpp v16, v16, v16 quad_perm:[1,0,3,2] row_mask:0xf bank_mask:0xf
    v_add_f32_dpp v17, v17, v17 quad_perm:[1,0,3,2] row_mask:0xf bank_mask:0xf
    s_nop 0
    v_add_f32_dpp v16, v16, v16 quad_perm:[2,3,0,1] row_mask:0xf bank_mask:0xf
    v_add_f32_dpp v17, v17, v17 quad_perm:[2,3,0,1] row_mask:0xf bank_mask:0xf
    ds_write_b64 v12, v[16:17] offset:384
    s_waitcnt lgkmcnt(1)
    v_cmp_lt_u32 vcc, v250, v249
    ds_read_b32 v249, v15 offset:28
    s_waitcnt vmcnt(6)
    s_cbranch_vccnz L_w_121
    s_waitcnt vmcnt(4)
L_w_121:
    buffer_load_dwordx4 v[92:95], v1, s[28:31], s41 offen offset:3072 nt
    v_mov_b32 v250, 120
    ds_write_b32 v248, v250 offset:96
    v_dot2_f32_bf16 v16, v64, v4, 0
    v_dot2_f32_bf16 v16, v65, v5, v16
    v_dot2_f32_bf16 v16, v66, v6, v16
    v_dot2_f32_bf16 v16, v67, v7, v16
    s_waitcnt vmcnt(6)
    s_cbranch_vccnz L_w_122
    s_waitcnt vmcnt(4)
L_w_122:
    s_add_u32 s41, s41, s42
    buffer_load_dwordx4 v[96:99], v1, s[28:31], s41 offen offset:0 nt
    v_dot2_f32_bf16 v17, v68, v4, 0
    v_dot2_f32_bf16 v17, v69, v5, v17
    v_dot2_f32_bf16 v17, v70, v6, v17
    v_dot2_f32_bf16 v17, v71, v7, v17
    s_waitcnt vmcnt(6)
    s_cbranch_vccnz L_w_123
    s_waitcnt vmcnt(4)
L_w_123:
    buffer_load_dwordx4 v[100:103], v1, s[28:31], s41 offen offset:1024 nt
    v_dot2_f32_bf16 v18, v72, v4, 0
    v_dot2_f32_bf16 v18, v73, v5, v18
    v_dot2_f32_bf16 v18, v74, v6, v18
    v_dot2_f32_bf16 v18, v75, v7, v18
    s_waitcnt vmcnt(6)
    s_cbranch_vccnz L_w_124
    s_waitcnt vmcnt(4)
L_w_124:
    buffer_load_dwordx4 v[104:107], v1, s[28:31], s41 offen offset:2048 nt
    v_dot2_f32_bf16 v19, v76, v4, 0
    v_dot2_f32_bf16 v19, v77, v5, v19
    v_dot2_f32_bf16 v19, v78, v6, v19
    v_dot2_f32_bf16 v19, v79, v7, v19
    s_waitcnt lgkmcnt(0)
    v_cmp_lt_u32 vcc, v250, v249
    ds_read_b32 v249, v15 offset:28
    s_waitcnt vmcnt(6)
    s_cbranch_vccnz L_w_125
    s_waitcnt vmcnt(4)
L_w_125:
    buffer_load_dwordx4 v[108:111], v1, s[28:31], s41 offen offset:3072 nt
    v_mov_b32 v250, 124
    ds_write_b32 v248, v250 offset:96
    v_dot2_f32_bf16 v20, v80, v4, 0
    v_dot2_f32_bf16 v20, v81, v5, v20
    v_dot2_f32_bf16 v20, v82, v6, v20
    v_dot2_f32_bf16 v20, v83, v7, v20
    s_waitcnt vmcnt(6)
    s_cbranch_vccnz L_w_126
    s_waitcnt vmcnt(4)
L_w_126:
    s_add_u32 s41, s41, s42
    buffer_load_dwordx4 v[112:115], v1, s[28:31], s41 offen offset:0 nt
    v_dot2_f32_bf16 v21, v84, v4, 0
    v_dot2_f32_bf16 v21, v85, v5, v21
    v_dot2_f32_bf16 v21, v86, v6, v21
    v_dot2_f32_bf16 v21, v87, v7, v21
    s_waitcnt vmcnt(6)
    s_cbranch_vccnz L_w_127
    s_waitcnt vmcnt(4)
L_w_127:
    buffer_load_dwordx4 v[116:119], v1, s[28:31], s41 offen offset:1024 nt
    v_dot2_f32_bf16 v22, v88, v4, 0
    v_dot2_f32_bf16 v22, v89, v5, v22
    v_dot2_f32_bf16 v22, v90, v6, v22
    v_dot2_f32_bf16 v22, v91, v7, v22
    s_waitcnt vmcnt(6)
    s_cbranch_vccnz L_w_128
    s_waitcnt vmcnt(4)
L_w_128:
    buffer_load_dwordx4 v[120:123], v1, s[28:31], s41 offen offset:2048 nt
    v_dot2_f32_bf16 v23, v92, v4, 0
    v_dot2_f32_bf16 v23, v93, v5, v23
    v_dot2_f32_bf16 v23, v94, v6, v23
    v_dot2_f32_bf16 v23, v95, v7, v23
    s_waitcnt lgkmcnt(0)
    v_cmp_lt_u32 vcc, v250, v249
    ds_read_b32 v249, v15 offset:28
    s_waitcnt vmcnt(6)
    s_cbranch_vccnz L_w_129
    s_waitcnt vmcnt(4)
L_w_129:
    buffer_load_dwordx4 v[124:127], v1, s[28:31], s41 offen offset:3072 nt
    v_mov_b32 v250, 128
    ds_write_b32 v248, v250 offset:96
    v_dot2_f32_bf16 v24, v96, v4, 0
    v_dot2_f32_bf16 v24, v97, v5, v24
    v_dot2_f32_bf16 v24, v98, v6, v24
    v_dot2_f32_bf16 v24, v99, v7, v24
    s_waitcnt vmcnt(6)
    s_cbranch_vccnz L_w_130
    s_waitcnt vmcnt(4)
L_w_130:
    s_add_u32 s41, s41, s42
    buffer_load_dwordx4 v[128:131], v1, s[28:31], s41 offen offset:0 nt
    v_dot2_f32_bf16 v25, v100, v4, 0
    v_dot2_f32_bf16 v25, v101, v5, v25
    v_dot2_f32_bf16 v25, v102, v6, v25
    v_dot2_f32_bf16 v25, v103, v7, v25
    s_waitcnt vmcnt(6)
    s_cbranch_vccnz L_w_131
    s_waitcnt vmcnt(4)
L_w_131:
    buffer_load_dwordx4 v[132:135], v1, s[28:31], s41 offen offset:1024 nt
    v_dot2_f32_bf16 v26, v104, v4, 0
    v_dot2_f32_bf16 v26, v105, v5, v26
    v_dot2_f32_bf16 v26, v106, v6, v26
    v_dot2_f32_bf16 v26, v107, v7, v26
    s_waitcnt vmcnt(6)
    s_cbranch_vccnz L_w_132
    s_waitcnt vmcnt(4)
L_w_132:
    buffer_load_dwordx4 v[136:139], v1, s[28:31], s41 offen offset:2048 nt
    v_dot2_f32_bf16 v27, v108, v4, 0
    v_dot2_f32_bf16 v27, v109, v5, v27
    v_dot2_f32_bf16 v27, v110, v6, v27
    v_dot2_f32_bf16 v27, v111, v7, v27
    s_waitcnt lgkmcnt(0)
    v_cmp_lt_u32 vcc, v250, v249
    ds_read_b32 v249, v15 offset:28
    s_waitcnt vmcnt(6)
    s_cbranch_vccnz L_w_133
    s_waitcnt vmcnt(4)
L_w_133:
    buffer_load_dwordx4 v[140:143], v1, s[28:31], s41 offen offset:3072 nt
    v_mov_b32 v250, 132
    ds_write_b32 v248, v250 offset:96
    v_dot2_f32_bf16 v28, v112, v4, 0
    v_dot2_f32_bf16 v28, v113, v5, v28
    v_dot2_f32_bf16 v28, v114, v6, v28
    v_dot2_f32_bf16 v28, v115, v7, v28
    s_waitcnt vmcnt(6)
    s_cbranch_vccnz L_w_134
    s_waitcnt vmcnt(4)
L_w_134:
    s_add_u32 s41, s41, s42
    buffer_load_dwordx4 v[144:147], v1, s[28:31], s41 offen offset:0 nt
    v_dot2_f32_bf16 v29, v116, v4, 0
    v_dot2_f32_bf16 v29, v117, v5, v29
    v_dot2_f32_bf16 v29, v118, v6, v29
    v_dot2_f32_bf16 v29, v119, v7, v29
    s_waitcnt vmcnt(6)
    s_cbranch_vccnz L_w_135
    s_waitcnt vmcnt(4)
L_w_135:
    buffer_load_dwordx4 v[148:151], v1, s[28:31], s41 offen offset:1024 nt
    v_dot2_f32_bf16 v30, v120, v4, 0
    v_dot2_f32_bf16 v30, v121, v5, v30
    v_dot2_f32_bf16 v30, v122, v6, v30
    v_dot2_f32_bf16 v30, v123, v7, v30
    s_waitcnt vmcnt(6)
    s_cbranch_vccnz L_w_136
    s_waitcnt vmcnt(4)
L_w_136:
    buffer_load_dwordx4 v[152:155], v1, s[28:31], s41 offen offset:2048 nt
    v_dot2_f32_bf16 v31, v124, v4, 0
    v_dot2_f32_bf16 v31, v125, v5, v31
    v_dot2_f32_bf16 v31, v126, v6, v31
    v_dot2_f32_bf16 v31, v127, v7, v31
    v_permlane16_swap_b32 v16, v24
    v_permlane16_swap_b32 v17, v25
    v_permlane16_swap_b32 v18, v26
    v_permlane16_swap_b32 v19, v27
    v_permlane16_swap_b32 v20, v28
    v_permlane16_swap_b32 v21, v29
    v_permlane16_swap_b32 v22, v30
    v_permlane16_swap_b32 v23, v31
    v_add_f32 v16, v16, v24
    v_add_f32 v17, v17, v25
    v_add_f32 v18, v18, v26
    v_add_f32 v19, v19, v27
    v_add_f32 v20, v20, v28
    v_add_f32 v21, v21, v29
    v_add_f32 v22, v22, v30
    v_add_f32 v23, v23, v31
    v_add_f32_dpp v24, v16, v16 row_ror:8 row_mask:0xf bank_mask:0x3
    v_add_f32_dpp v25, v17, v17 row_ror:8 row_mask:0xf bank_mask:0x3
    v_add_f32_dpp v26, v18, v18 row_ror:8 row_mask:0xf bank_mask:0x3
    v_add_f32_dpp v27, v19, v19 row_ror:8 row_mask:0xf bank_mask:0x3
    v_add_f32_dpp v24, v20, v20 row_ror:8 row_mask:0xf bank_mask:0xc
    v_add_f32_dpp v25, v21, v21 row_ror:8 row_mask:0xf bank_mask:0xc
    v_add_f32_dpp v26, v22, v22 row_ror:8 row_mask:0xf bank_mask:0xc
    v_add_f32_dpp v27, v23, v23 row_ror:8 row_mask:0xf bank_mask:0xc
    v_add_f32_dpp v16, v24, v24 row_shl:4 row_mask:0xf bank_mask:0x5
    v_add_f32_dpp v17, v25, v25 row_shl:4 row_mask:0xf bank_mask:0x5
    s_nop 0
    v_add_f32_dpp v16, v26, v26 row_shr:4 row_mask:0xf bank_mask:0xa
    v_add_f32_dpp v17, v27, v27 row_shr:4 row_mask:0xf bank_mask:0xa
    s_nop 0
    v_add_f32_dpp v16, v16, v16 quad_perm:[1,0,3,2] row_mask:0xf bank_mask:0xf
    v_add_f32_dpp v17, v17, v17 quad_perm:[1,0,3,2] row_mask:0xf bank_mask:0xf
    s_nop 0
    v_add_f32_dpp v16, v16, v16 quad_perm:[2,3,0,1] row_mask:0xf bank_mask:0xf
    v_add_f32_dpp v17, v17, v17 quad_perm:[2,3,0,1] row_mask:0xf bank_mask:0xf
    ds_write_b64 v12, v[16:17] offset:448
    s_waitcnt lgkmcnt(1)
    v_cmp_lt_u32 vcc, v250, v249
    ds_read_b32 v249, v15 offset:28
    s_waitcnt vmcnt(6)
    s_cbranch_vccnz L_w_137
    s_waitcnt vmcnt(4)
L_w_137:
    buffer_load_dwordx4 v[156:159], v1, s[28:31], s41 offen offset:3072 nt
    v_mov_b32 v250, 136
    ds_write_b32 v248, v250 offset:96
    v_dot2_f32_bf16 v16, v128, v4, 0
    v_dot2_f32_bf16 v16, v129, v5, v16
    v_dot2_f32_bf16 v16, v130, v6, v16
    v_dot2_f32_bf16 v16, v131, v7, v16
    s_waitcnt vmcnt(6)
    s_cbranch_vccnz L_w_138
    s_waitcnt vmcnt(4)
L_w_138:
    s_add_u32 s41, s41, s42
    buffer_load_dwordx4 v[160:163], v1, s[28:31], s41 offen offset:0 nt
    v_dot2_f32_bf16 v17, v132, v4, 0
    v_dot2_f32_bf16 v17, v133, v5, v17
    v_dot2_f32_bf16 v17, v134, v6, v17
    v_dot2_f32_bf16 v17, v135, v7, v17
    s_waitcnt vmcnt(6)
    s_cbranch_vccnz L_w_139
    s_waitcnt vmcnt(4)
L_w_139:
    buffer_load_dwordx4 v[164:167], v1, s[28:31], s41 offen offset:1024 nt
    v_dot2_f32_bf16 v18, v136, v4, 0
    v_dot2_f32_bf16 v18, v137, v5, v18
    v_dot2_f32_bf16 v18, v138, v6, v18
    v_dot2_f32_bf16 v18, v139, v7, v18
    s_waitcnt vmcnt(6)
    s_cbranch_vccnz L_w_140
    s_waitcnt vmcnt(4)
L_w_140:
    buffer_load_dwordx4 v[168:171], v1, s[28:31], s41 offen offset:2048 nt
    v_dot2_f32_bf16 v19, v140, v4, 0
    v_dot2_f32_bf16 v19, v141, v5, v19
    v_dot2_f32_bf16 v19, v142, v6, v19
    v_dot2_f32_bf16 v19, v143, v7, v19
    s_waitcnt lgkmcnt(0)
    v_cmp_lt_u32 vcc, v250, v249
    ds_read_b32 v249, v15 offset:28
    s_waitcnt vmcnt(6)
    s_cbranch_vccnz L_w_141
    s_waitcnt vmcnt(4)
L_w_141:
    buffer_load_dwordx4 v[172:175], v1, s[28:31], s41 offen offset:3072 nt
    v_mov_b32 v250, 140
    ds_write_b32 v248, v250 offset:96
    v_dot2_f32_bf16 v20, v144, v4, 0
    v_dot2_f32_bf16 v20, v145, v5, v20
    v_dot2_f32_bf16 v20, v146, v6, v20
    v_dot2_f32_bf16 v20, v147, v7, v20
    s_waitcnt vmcnt(6)
    s_cbranch_vccnz L_w_142
    s_waitcnt vmcnt(4)
L_w_142:
    s_add_u32 s41, s41, s42
    buffer_load_dwordx4 v[176:179], v1, s[28:31], s41 offen offset:0 nt
    v_dot2_f32_bf16 v21, v148, v4, 0
    v_dot2_f32_bf16 v21, v149, v5, v21
    v_dot2_f32_bf16 v21, v150, v6, v21
    v_dot2_f32_bf16 v21, v151, v7, v21
    s_waitcnt vmcnt(6)
    s_cbranch_vccnz L_w_143
    s_waitcnt vmcnt(4)
L_w_143:
    buffer_load_dwordx4 v[180:183], v1, s[28:31], s41 offen offset:1024 nt
    v_dot2_f32_bf16 v22, v152, v4, 0
    v_dot2_f32_bf16 v22, v153, v5, v22
    v_dot2_f32_bf16 v22, v154, v6, v22
    v_dot2_f32_bf16 v22, v155, v7, v22
    s_waitcnt vmcnt(6)
    s_cbranch_vccnz L_w_144
    s_waitcnt vmcnt(4)
L_w_144:
    buffer_load_dwordx4 v[184:187], v1, s[28:31], s41 offen offset:2048 nt
    v_dot2_f32_bf16 v23, v156, v4, 0
    v_dot2_f32_bf16 v23, v157, v5, v23
    v_dot2_f32_bf16 v23, v158, v6, v23
    v_dot2_f32_bf16 v23, v159, v7, v23
    s_waitcnt lgkmcnt(0)
    v_cmp_lt_u32 vcc, v250, v249
    ds_read_b32 v249, v15 offset:28
    s_waitcnt vmcnt(6)
    s_cbranch_vccnz L_w_145
    s_waitcnt vmcnt(4)
L_w_145:
    buffer_load_dwordx4 v[188:191], v1, s[28:31], s41 offen offset:3072 nt
    v_mov_b32 v250, 144
    ds_write_b32 v248, v250 offset:96
    v_dot2_f32_bf16 v24, v160, v4, 0
    v_dot2_f32_bf16 v24, v161, v5, v24
    v_dot2_f32_bf16 v24, v162, v6, v24
    v_dot2_f32_bf16 v24, v163, v7, v24
    s_waitcnt vmcnt(6)
    s_cbranch_vccnz L_w_146
    s_waitcnt vmcnt(4)
L_w_146:
    s_add_u32 s41, s41, s42
    buffer_load_dwordx4 v[192:195], v1, s[28:31], s41 offen offset:0 nt
    v_dot2_f32_bf16 v25, v164, v4, 0
    v_dot2_f32_bf16 v25, v165, v5, v25
    v_dot2_f32_bf16 v25, v166, v6, v25
    v_dot2_f32_bf16 v25, v167, v7, v25
    s_waitcnt vmcnt(6)
    s_cbranch_vccnz L_w_147
    s_waitcnt vmcnt(4)
L_w_147:
    buffer_load_dwordx4 v[196:199], v1, s[28:31], s41 offen offset:1024 nt
    v_dot2_f32_bf16 v26, v168, v4, 0
    v_dot2_f32_bf16 v26, v169, v5, v26
    v_dot2_f32_bf16 v26, v170, v6, v26
    v_dot2_f32_bf16 v26, v171, v7, v26
    s_waitcnt vmcnt(6)
    s_cbranch_vccnz L_w_148
    s_waitcnt vmcnt(4)
L_w_148:
    buffer_load_dwordx4 v[200:203], v1, s[28:31], s41 offen offset:2048 nt
    v_dot2_f32_bf16 v27, v172, v4, 0
    v_dot2_f32_bf16 v27, v173, v5, v27
    v_dot2_f32_bf16 v27, v174, v6, v27
    v_dot2_f32_bf16 v27, v175, v7, v27
    s_waitcnt lgkmcnt(0)
    v_cmp_lt_u32 vcc, v250, v249
    ds_read_b32 v249, v15 offset:28
    s_waitcnt vmcnt(6)
    s_cbranch_vccnz L_w_149
    s_waitcnt vmcnt(4)
L_w_149:
    buffer_load_dwordx4 v[204:207], v1, s[28:31], s41 offen offset:3072 nt
    v_mov_b32 v250, 148
    ds_write_b32 v248, v250 offset:96
    v_dot2_f32_bf16 v28, v176, v4, 0
    v_dot2_f32_bf16 v28, v177, v5, v28
    v_dot2_f32_bf16 v28, v178, v6, v28
    v_dot2_f32_bf16 v28, v179, v7, v28
    s_waitcnt vmcnt(6)
    s_cbranch_vccnz L_w_150
    s_waitcnt vmcnt(4)
L_w_150:
    s_add_u32 s41, s41, s42
    buffer_load_dwordx4 v[208:211], v1, s[28:31], s41 offen offset:0 nt
    v_dot2_f32_bf16 v29, v180, v4, 0
    v_dot2_f32_bf16 v29, v181, v5, v29
    v_dot2_f32_bf16 v29, v182, v6, v29
    v_dot2_f32_bf16 v29, v183, v7, v29
    s_waitcnt vmcnt(6)
    s_cbranch_vccnz L_w_151
    s_waitcnt vmcnt(4)
L_w_151:
    buffer_load_dwordx4 v[212:215], v1, s[28:31], s41 offen offset:1024 nt
    v_dot2_f32_bf16 v30, v184, v4, 0
    v_dot2_f32_bf16 v30, v185, v5, v30
    v_dot2_f32_bf16 v30, v186, v6, v30
    v_dot2_f32_bf16 v30, v187, v7, v30
    s_waitcnt vmcnt(6)
    s_cbranch_vccnz L_w_152
    s_waitcnt vmcnt(4)
L_w_152:
    buffer_load_dwordx4 v[216:219], v1, s[28:31], s41 offen offset:2048 nt
    v_dot2_f32_bf16 v31, v188, v4, 0
    v_dot2_f32_bf16 v31, v189, v5, v31
    v_dot2_f32_bf16 v31, v190, v6, v31
    v_dot2_f32_bf16 v31, v191, v7, v31
    v_permlane16_swap_b32 v16, v24
    v_permlane16_swap_b32 v17, v25
    v_permlane16_swap_b32 v18, v26
    v_permlane16_swap_b32 v19, v27
    v_permlane16_swap_b32 v20, v28
    v_permlane16_swap_b32 v21, v29
    v_permlane16_swap_b32 v22, v30
    v_permlane16_swap_b32 v23, v31
    v_add_f32 v16, v16, v24
    v_add_f32 v17, v17, v25
    v_add_f32 v18, v18, v26
    v_add_f32 v19, v19, v27
    v_add_f32 v20, v20, v28
    v_add_f32 v21, v21, v29
    v_add_f32 v22, v22, v30
    v_add_f32 v23, v23, v31
    v_add_f32_dpp v24, v16, v16 row_ror:8 row_mask:0xf bank_mask:0x3
    v_add_f32_dpp v25, v17, v17 row_ror:8 row_mask:0xf bank_mask:0x3
    v_add_f32_dpp v26, v18, v18 row_ror:8 row_mask:0xf bank_mask:0x3
    v_add_f32_dpp v27, v19, v19 row_ror:8 row_mask:0xf bank_mask:0x3
    v_add_f32_dpp v24, v20, v20 row_ror:8 row_mask:0xf bank_mask:0xc
    v_add_f32_dpp v25, v21, v21 row_ror:8 row_mask:0xf bank_mask:0xc
    v_add_f32_dpp v26, v22, v22 row_ror:8 row_mask:0xf bank_mask:0xc
    v_add_f32_dpp v27, v23, v23 row_ror:8 row_mask:0xf bank_mask:0xc
    v_add_f32_dpp v16, v24, v24 row_shl:4 row_mask:0xf bank_mask:0x5
    v_add_f32_dpp v17, v25, v25 row_shl:4 row_mask:0xf bank_mask:0x5
    s_nop 0
    v_add_f32_dpp v16, v26, v26 row_shr:4 row_mask:0xf bank_mask:0xa
    v_add_f32_dpp v17, v27, v27 row_shr:4 row_mask:0xf bank_mask:0xa
    s_nop 0
    v_add_f32_dpp v16, v16, v16 quad_perm:[1,0,3,2] row_mask:0xf bank_mask:0xf
    v_add_f32_dpp v17, v17, v17 quad_perm:[1,0,3,2] row_mask:0xf bank_mask:0xf
    s_nop 0
    v_add_f32_dpp v16, v16, v16 quad_perm:[2,3,0,1] row_mask:0xf bank_mask:0xf
    v_add_f32_dpp v17, v17, v17 quad_perm:[2,3,0,1] row_mask:0xf bank_mask:0xf
    ds_write_b64 v12, v[16:17] offset:512
    s_waitcnt lgkmcnt(1)
    v_cmp_lt_u32 vcc, v250, v249
    ds_read_b32 v249, v15 offset:28
    s_waitcnt vmcnt(6)
    s_cbranch_vccnz L_w_153
    s_waitcnt vmcnt(4)
L_w_153:
    buffer_load_dwordx4 v[220:223], v1, s[28:31], s41 offen offset:3072 nt
    v_mov_b32 v250, 152
    ds_write_b32 v248, v250 offset:96
    v_dot2_f32_bf16 v16, v192, v4, 0
    v_dot2_f32_bf16 v16, v193, v5, v16
    v_dot2_f32_bf16 v16, v194, v6, v16
    v_dot2_f32_bf16 v16, v195, v7, v16
    s_waitcnt vmcnt(6)
    s_cbranch_vccnz L_w_154
    s_waitcnt vmcnt(4)
L_w_154:
    s_add_u32 s41, s41, s42
    buffer_load_dwordx4 v[224:227], v1, s[28:31], s41 offen offset:0 nt
    v_dot2_f32_bf16 v17, v196, v4, 0
    v_dot2_f32_bf16 v17, v197, v5, v17
    v_dot2_f32_bf16 v17, v198, v6, v17
    v_dot2_f32_bf16 v17, v199, v7, v17
    s_waitcnt vmcnt(6)
    s_cbranch_vccnz L_w_155
    s_waitcnt vmcnt(4)
L_w_155:
    buffer_load_dwordx4 v[228:231], v1, s[28:31], s41 offen offset:1024 nt
    v_dot2_f32_bf16 v18, v200, v4, 0
    v_dot2_f32_bf16 v18, v201, v5, v18
    v_dot2_f32_bf16 v18, v202, v6, v18
    v_dot2_f32_bf16 v18, v203, v7, v18
    s_waitcnt vmcnt(6)
    s_cbranch_vccnz L_w_156
    s_waitcnt vmcnt(4)
L_w_156:
    buffer_load_dwordx4 v[232:235], v1, s[28:31], s41 offen offset:2048 nt
    v_dot2_f32_bf16 v19, v204, v4, 0
    v_dot2_f32_bf16 v19, v205, v5, v19
    v_dot2_f32_bf16 v19, v206, v6, v19
    v_dot2_f32_bf16 v19, v207, v7, v19
    s_waitcnt lgkmcnt(0)
    v_cmp_lt_u32 vcc, v250, v249
    ds_read_b32 v249, v15 offset:28
    s_waitcnt vmcnt(6)
    s_cbranch_vccnz L_w_157
    s_waitcnt vmcnt(4)
L_w_157:
    buffer_load_dwordx4 v[236:239], v1, s[28:31], s41 offen offset:3072 nt
    v_mov_b32 v250, 156
    ds_write_b32 v248, v250 offset:96
    v_dot2_f32_bf16 v20, v208, v4, 0
    v_dot2_f32_bf16 v20, v209, v5, v20
    v_dot2_f32_bf16 v20, v210, v6, v20
    v_dot2_f32_bf16 v20, v211, v7, v20
    s_waitcnt vmcnt(6)
    s_cbranch_vccnz L_w_158
    s_waitcnt vmcnt(4)
L_w_158:
    s_add_u32 s41, s41, s42
    buffer_load_dwordx4 v[48:51], v1, s[28:31], s41 offen offset:0 nt
    v_dot2_f32_bf16 v21, v212, v4, 0
    v_dot2_f32_bf16 v21, v213, v5, v21
    v_dot2_f32_bf16 v21, v214, v6, v21
    v_dot2_f32_bf16 v21, v215, v7, v21
    s_waitcnt vmcnt(6)
    s_cbranch_vccnz L_w_159
    s_waitcnt vmcnt(4)
L_w_159:
    buffer_load_dwordx4 v[52:55], v1, s[28:31], s41 offen offset:1024 nt
    v_dot2_f32_bf16 v22, v216, v4, 0
    v_dot2_f32_bf16 v22, v217, v5, v22
    v_dot2_f32_bf16 v22, v218, v6, v22
    v_dot2_f32_bf16 v22, v219, v7, v22
    s_waitcnt vmcnt(6)
    s_cbranch_vccnz L_w_160
    s_waitcnt vmcnt(4)
L_w_160:
    buffer_load_dwordx4 v[56:59], v1, s[28:31], s41 offen offset:2048 nt
    v_dot2_f32_bf16 v23, v220, v4, 0
    v_dot2_f32_bf16 v23, v221, v5, v23
    v_dot2_f32_bf16 v23, v222, v6, v23
    v_dot2_f32_bf16 v23, v223, v7, v23
    s_waitcnt lgkmcnt(0)
    v_cmp_lt_u32 vcc, v250, v249
    ds_read_b32 v249, v15 offset:28
    s_waitcnt vmcnt(6)
    s_cbranch_vccnz L_w_161
    s_waitcnt vmcnt(4)
L_w_161:
    buffer_load_dwordx4 v[60:63], v1, s[28:31], s41 offen offset:3072 nt
    v_mov_b32 v250, 160
    ds_write_b32 v248, v250 offset:96
    v_dot2_f32_bf16 v24, v224, v4, 0
    v_dot2_f32_bf16 v24, v225, v5, v24
    v_dot2_f32_bf16 v24, v226, v6, v24
    v_dot2_f32_bf16 v24, v227, v7, v24
    s_waitcnt vmcnt(6)
    s_cbranch_vccnz L_w_162
    s_waitcnt vmcnt(4)
L_w_162:
    s_add_u32 s41, s41, s42
    buffer_load_dwordx4 v[64:67], v1, s[28:31], s41 offen offset:0 nt
    v_dot2_f32_bf16 v25, v228, v4, 0
    v_dot2_f32_bf16 v25, v229, v5, v25
    v_dot2_f32_bf16 v25, v230, v6, v25
    v_dot2_f32_bf16 v25, v231, v7, v25
    s_waitcnt vmcnt(6)
    s_cbranch_vccnz L_w_163
    s_waitcnt vmcnt(4)
L_w_163:
    buffer_load_dwordx4 v[68:71], v1, s[28:31], s41 offen offset:1024 nt
    v_dot2_f32_bf16 v26, v232, v4, 0
    v_dot2_f32_bf16 v26, v233, v5, v26
    v_dot2_f32_bf16 v26, v234, v6, v26
    v_dot2_f32_bf16 v26, v235, v7, v26
    s_waitcnt vmcnt(6)
    s_cbranch_vccnz L_w_164
    s_waitcnt vmcnt(4)
L_w_164:
    buffer_load_dwordx4 v[72:75], v1, s[28:31], s41 offen offset:2048 nt
    v_dot2_f32_bf16 v27, v236, v4, 0
    v_dot2_f32_bf16 v27, v237, v5, v27
    v_dot2_f32_bf16 v27, v238, v6, v27
    v_dot2_f32_bf16 v27, v239, v7, v27
    s_waitcnt lgkmcnt(0)
    v_cmp_lt_u32 vcc, v250, v249
    ds_read_b32 v249, v15 offset:28
    s_waitcnt vmcnt(6)
    s_cbranch_vccnz L_w_165
    s_waitcnt vmcnt(4)
L_w_165:
    buffer_load_dwordx4 v[76:79], v1, s[28:31], s41 offen offset:3072 nt
    v_mov_b32 v250, 164
    ds_write_b32 v248, v250 offset:96
    v_dot2_f32_bf16 v28, v48, v4, 0
    v_dot2_f32_bf16 v28, v49, v5, v28
    v_dot2_f32_bf16 v28, v50, v6, v28
    v_dot2_f32_bf16 v28, v51, v7, v28
    s_waitcnt vmcnt(6)
    s_cbranch_vccnz L_w_166
    s_waitcnt vmcnt(4)
L_w_166:
    s_add_u32 s41, s41, s42
    buffer_load_dwordx4 v[80:83], v1, s[28:31], s41 offen offset:0 nt
    v_dot2_f32_bf16 v29, v52, v4, 0
    v_dot2_f32_bf16 v29, v53, v5, v29
    v_dot2_f32_bf16 v29, v54, v6, v29
    v_dot2_f32_bf16 v29, v55, v7, v29
    s_waitcnt vmcnt(6)
    s_cbranch_vccnz L_w_167
    s_waitcnt vmcnt(4)
L_w_167:
    buffer_load_dwordx4 v[84:87], v1, s[28:31], s41 offen offset:1024 nt
    v_dot2_f32_bf16 v30, v56, v4, 0
    v_dot2_f32_bf16 v30, v57, v5, v30
    v_dot2_f32_bf16 v30, v58, v6, v30
    v_dot2_f32_bf16 v30, v59, v7, v30
    s_waitcnt vmcnt(6)
    s_cbranch_vccnz L_w_168
    s_waitcnt vmcnt(4)
L_w_168:
    buffer_load_dwordx4 v[88:91], v1, s[28:31], s41 offen offset:2048 nt
    v_dot2_f32_bf16 v31, v60, v4, 0
    v_dot2_f32_bf16 v31, v61, v5, v31
    v_dot2_f32_bf16 v31, v62, v6, v31
    v_dot2_f32_bf16 v31, v63, v7, v31
    v_permlane16_swap_b32 v16, v24
    v_permlane16_swap_b32 v17, v25
    v_permlane16_swap_b32 v18, v26
    v_permlane16_swap_b32 v19, v27
    v_permlane16_swap_b32 v20, v28
    v_permlane16_swap_b32 v21, v29
    v_permlane16_swap_b32 v22, v30
    v_permlane16_swap_b32 v23, v31
    v_add_f32 v16, v16, v24
    v_add_f32 v17, v17, v25
    v_add_f32 v18, v18, v26
    v_add_f32 v19, v19, v27
    v_add_f32 v20, v20, v28
    v_add_f32 v21, v21, v29
    v_add_f32 v22, v22, v30
    v_add_f32 v23, v23, v31
    v_add_f32_dpp v24, v16, v16 row_ror:8 row_mask:0xf bank_mask:0x3
    v_add_f32_dpp v25, v17, v17 row_ror:8 row_mask:0xf bank_mask:0x3
    v_add_f32_dpp v26, v18, v18 row_ror:8 row_mask:0xf bank_mask:0x3
    v_add_f32_dpp v27, v19, v19 row_ror:8 row_mask:0xf bank_mask:0x3
    v_add_f32_dpp v24, v20, v20 row_ror:8 row_mask:0xf bank_mask:0xc
    v_add_f32_dpp v25, v21, v21 row_ror:8 row_mask:0xf bank_mask:0xc
    v_add_f32_dpp v26, v22, v22 row_ror:8 row_mask:0xf bank_mask:0xc
    v_add_f32_dpp v27, v23, v23 row_ror:8 row_mask:0xf bank_mask:0xc
    v_add_f32_dpp v16, v24, v24 row_shl:4 row_mask:0xf bank_mask:0x5
    v_add_f32_dpp v17, v25, v25 row_shl:4 row_mask:0xf bank_mask:0x5
    s_nop 0
    v_add_f32_dpp v16, v26, v26 row_shr:4 row_mask:0xf bank_mask:0xa
    v_add_f32_dpp v17, v27, v27 row_shr:4 row_mask:0xf bank_mask:0xa
    s_nop 0
    v_add_f32_dpp v16, v16, v16 quad_perm:[1,0,3,2] row_mask:0xf bank_mask:0xf
    v_add_f32_dpp v17, v17, v17 quad_perm:[1,0,3,2] row_mask:0xf bank_mask:0xf
    s_nop 0
    v_add_f32_dpp v16, v16, v16 quad_perm:[2,3,0,1] row_mask:0xf bank_mask:0xf
    v_add_f32_dpp v17, v17, v17 quad_perm:[2,3,0,1] row_mask:0xf bank_mask:0xf
    ds_write_b64 v12, v[16:17] offset:576
    s_waitcnt lgkmcnt(1)
    v_cmp_lt_u32 vcc, v250, v249
    ds_read_b32 v249, v15 offset:28
    s_waitcnt vmcnt(6)
    s_cbranch_vccnz L_w_169
    s_waitcnt vmcnt(4)
L_w_169:
    buffer_load_dwordx4 v[92:95], v1, s[28:31], s41 offen offset:3072 nt
    v_mov_b32 v250, 168
    ds_write_b32 v248, v250 offset:96
    v_dot2_f32_bf16 v16, v64, v4, 0
    v_dot2_f32_bf16 v16, v65, v5, v16
    v_dot2_f32_bf16 v16, v66, v6, v16
    v_dot2_f32_bf16 v16, v67, v7, v16
    s_waitcnt vmcnt(6)
    s_cbranch_vccnz L_w_170
    s_waitcnt vmcnt(4)
L_w_170:
    s_add_u32 s41, s41, s42
    buffer_load_dwordx4 v[96:99], v1, s[28:31], s41 offen offset:0 nt
    v_dot2_f32_bf16 v17, v68, v4, 0
    v_dot2_f32_bf16 v17, v69, v5, v17
    v_dot2_f32_bf16 v17, v70, v6, v17
    v_dot2_f32_bf16 v17, v71, v7, v17
    s_waitcnt vmcnt(6)
    s_cbranch_vccnz L_w_171
    s_waitcnt vmcnt(4)
L_w_171:
    buffer_load_dwordx4 v[100:103], v1, s[28:31], s41 offen offset:1024 nt
    v_dot2_f32_bf16 v18, v72, v4, 0
    v_dot2_f32_bf16 v18, v73, v5, v18
    v_dot2_f32_bf16 v18, v74, v6, v18
    v_dot2_f32_bf16 v18, v75, v7, v18
    s_waitcnt vmcnt(6)
    s_cbranch_vccnz L_w_172
    s_waitcnt vmcnt(4)
L_w_172:
    buffer_load_dwordx4 v[104:107], v1, s[28:31], s41 offen offset:2048 nt
    v_dot2_f32_bf16 v19, v76, v4, 0
    v_dot2_f32_bf16 v19, v77, v5, v19
    v_dot2_f32_bf16 v19, v78, v6, v19
    v_dot2_f32_bf16 v19, v79, v7, v19
    s_waitcnt lgkmcnt(0)
    v_cmp_lt_u32 vcc, v250, v249
    ds_read_b32 v249, v15 offset:28
    s_waitcnt vmcnt(6)
    s_cbranch_vccnz L_w_173
    s_waitcnt vmcnt(4)
L_w_173:
    buffer_load_dwordx4 v[108:111], v1, s[28:31], s41 offen offset:3072 nt
    v_mov_b32 v250, 172
    ds_write_b32 v248, v250 offset:96
    v_dot2_f32_bf16 v20, v80, v4, 0
    v_dot2_f32_bf16 v20, v81, v5, v20
    v_dot2_f32_bf16 v20, v82, v6, v20
    v_dot2_f32_bf16 v20, v83, v7, v20
    s_waitcnt vmcnt(6)
    s_cbranch_vccnz L_w_174
    s_waitcnt vmcnt(4)
L_w_174:
    s_add_u32 s41, s41, s42
    buffer_load_dwordx4 v[112:115], v1, s[28:31], s41 offen offset:0 nt
    v_dot2_f32_bf16 v21, v84, v4, 0
    v_dot2_f32_bf16 v21, v85, v5, v21
    v_dot2_f32_bf16 v21, v86, v6, v21
    v_dot2_f32_bf16 v21, v87, v7, v21
    s_waitcnt vmcnt(6)
    s_cbranch_vccnz L_w_175
    s_waitcnt vmcnt(4)
L_w_175:
    buffer_load_dwordx4 v[116:119], v1, s[28:31], s41 offen offset:1024 nt
    v_dot2_f32_bf16 v22, v88, v4, 0
    v_dot2_f32_bf16 v22, v89, v5, v22
    v_dot2_f32_bf16 v22, v90, v6, v22
    v_dot2_f32_bf16 v22, v91, v7, v22
    s_waitcnt vmcnt(6)
    s_cbranch_vccnz L_w_176
    s_waitcnt vmcnt(4)
L_w_176:
    buffer_load_dwordx4 v[120:123], v1, s[28:31], s41 offen offset:2048 nt
    v_dot2_f32_bf16 v23, v92, v4, 0
    v_dot2_f32_bf16 v23, v93, v5, v23
    v_dot2_f32_bf16 v23, v94, v6, v23
    v_dot2_f32_bf16 v23, v95, v7, v23
    s_waitcnt lgkmcnt(0)
    v_cmp_lt_u32 vcc, v250, v249
    ds_read_b32 v249, v15 offset:28
    s_waitcnt vmcnt(6)
    s_cbranch_vccnz L_w_177
    s_waitcnt vmcnt(4)
L_w_177:
    buffer_load_dwordx4 v[124:127], v1, s[28:31], s41 offen offset:3072 nt
    v_mov_b32 v250, 176
    ds_write_b32 v248, v250 offset:96
    v_dot2_f32_bf16 v24, v96, v4, 0
    v_dot2_f32_bf16 v24, v97, v5, v24
    v_dot2_f32_bf16 v24, v98, v6, v24
    v_dot2_f32_bf16 v24, v99, v7, v24
    s_waitcnt vmcnt(6)
    s_cbranch_vccnz L_w_178
    s_waitcnt vmcnt(4)
L_w_178:
    s_add_u32 s41, s41, s42
    buffer_load_dwordx4 v[128:131], v1, s[28:31], s41 offen offset:0 nt
    v_dot2_f32_bf16 v25, v100, v4, 0
    v_dot2_f32_bf16 v25, v101, v5, v25
    v_dot2_f32_bf16 v25, v102, v6, v25
    v_dot2_f32_bf16 v25, v103, v7, v25
    s_waitcnt vmcnt(6)
    s_cbranch_vccnz L_w_179
    s_waitcnt vmcnt(4)
L_w_179:
    buffer_load_dwordx4 v[132:135], v1, s[28:31], s41 offen offset:1024 nt
    v_dot2_f32_bf16 v26, v104, v4, 0
    v_dot2_f32_bf16 v26, v105, v5, v26
    v_dot2_f32_bf16 v26, v106, v6, v26
    v_dot2_f32_bf16 v26, v107, v7, v26
    s_waitcnt vmcnt(6)
    s_cbranch_vccnz L_w_180
    s_waitcnt vmcnt(4)
L_w_180:
    buffer_load_dwordx4 v[136:139], v1, s[28:31], s41 offen offset:2048 nt
    v_dot2_f32_bf16 v27, v108, v4, 0
    v_dot2_f32_bf16 v27, v109, v5, v27
    v_dot2_f32_bf16 v27, v110, v6, v27
    v_dot2_f32_bf16 v27, v111, v7, v27
    s_waitcnt lgkmcnt(0)
    v_cmp_lt_u32 vcc, v250, v249
    ds_read_b32 v249, v15 offset:28
    s_waitcnt vmcnt(6)
    s_cbranch_vccnz L_w_181
    s_waitcnt vmcnt(4)
L_w_181:
    buffer_load_dwordx4 v[140:143], v1, s[28:31], s41 offen offset:3072 nt
    v_mov_b32 v250, 180
    ds_write_b32 v248, v250 offset:96
    v_dot2_f32_bf16 v28, v112, v4, 0
    v_dot2_f32_bf16 v28, v113, v5, v28
    v_dot2_f32_bf16 v28, v114, v6, v28
    v_dot2_f32_bf16 v28, v115, v7, v28
    s_waitcnt vmcnt(6)
    s_cbranch_vccnz L_w_182
    s_waitcnt vmcnt(4)
L_w_182:
    s_add_u32 s41, s41, s42
    buffer_load_dwordx4 v[144:147], v1, s[28:31], s41 offen offset:0 nt
    v_dot2_f32_bf16 v29, v116, v4, 0
    v_dot2_f32_bf16 v29, v117, v5, v29
    v_dot2_f32_bf16 v29, v118, v6, v29
    v_dot2_f32_bf16 v29, v119, v7, v29
    s_waitcnt vmcnt(6)
    s_cbranch_vccnz L_w_183
    s_waitcnt vmcnt(4)
L_w_183:
    buffer_load_dwordx4 v[148:151], v1, s[28:31], s41 offen offset:1024 nt
    v_dot2_f32_bf16 v30, v120, v4, 0
    v_dot2_f32_bf16 v30, v121, v5, v30
    v_dot2_f32_bf16 v30, v122, v6, v30
    v_dot2_f32_bf16 v30, v123, v7, v30
    s_waitcnt vmcnt(6)
    s_cbranch_vccnz L_w_184
    s_waitcnt vmcnt(4)
L_w_184:
    buffer_load_dwordx4 v[152:155], v1, s[28:31], s41 offen offset:2048 nt
    v_dot2_f32_bf16 v31, v124, v4, 0
    v_dot2_f32_bf16 v31, v125, v5, v31
    v_dot2_f32_bf16 v31, v126, v6, v31
    v_dot2_f32_bf16 v31, v127, v7, v31
    v_permlane16_swap_b32 v16, v24
    v_permlane16_swap_b32 v17, v25
    v_permlane16_swap_b32 v18, v26
    v_permlane16_swap_b32 v19, v27
    v_permlane16_swap_b32 v20, v28
    v_permlane16_swap_b32 v21, v29
    v_permlane16_swap_b32 v22, v30
    v_permlane16_swap_b32 v23, v31
    v_add_f32 v16, v16, v24
    v_add_f32 v17, v17, v25
    v_add_f32 v18, v18, v26
    v_add_f32 v19, v19, v27
    v_add_f32 v20, v20, v28
    v_add_f32 v21, v21, v29
    v_add_f32 v22, v22, v30
    v_add_f32 v23, v23, v31
    v_add_f32_dpp v24, v16, v16 row_ror:8 row_mask:0xf bank_mask:0x3
    v_add_f32_dpp v25, v17, v17 row_ror:8 row_mask:0xf bank_mask:0x3
    v_add_f32_dpp v26, v18, v18 row_ror:8 row_mask:0xf bank_mask:0x3
    v_add_f32_dpp v27, v19, v19 row_ror:8 row_mask:0xf bank_mask:0x3
    v_add_f32_dpp v24, v20, v20 row_ror:8 row_mask:0xf bank_mask:0xc
    v_add_f32_dpp v25, v21, v21 row_ror:8 row_mask:0xf bank_mask:0xc
    v_add_f32_dpp v26, v22, v22 row_ror:8 row_mask:0xf bank_mask:0xc
    v_add_f32_dpp v27, v23, v23 row_ror:8 row_mask:0xf bank_mask:0xc
    v_add_f32_dpp v16, v24, v24 row_shl:4 row_mask:0xf bank_mask:0x5
    v_add_f32_dpp v17, v25, v25 row_shl:4 row_mask:0xf bank_mask:0x5
    s_nop 0
    v_add_f32_dpp v16, v26, v26 row_shr:4 row_mask:0xf bank_mask:0xa
    v_add_f32_dpp v17, v27, v27 row_shr:4 row_mask:0xf bank_mask:0xa
    s_nop 0
    v_add_f32_dpp v16, v16, v16 quad_perm:[1,0,3,2] row_mask:0xf bank_mask:0xf
    v_add_f32_dpp v17, v17, v17 quad_perm:[1,0,3,2] row_mask:0xf bank_mask:0xf
    s_nop 0
    v_add_f32_dpp v16, v16, v16 quad_perm:[2,3,0,1] row_mask:0xf bank_mask:0xf
    v_add_f32_dpp v17, v17, v17 quad_perm:[2,3,0,1] row_mask:0xf bank_mask:0xf
    ds_write_b64 v12, v[16:17] offset:640
    s_waitcnt lgkmcnt(1)
    v_cmp_lt_u32 vcc, v250, v249
    ds_read_b32 v249, v15 offset:28
    s_waitcnt vmcnt(6)
    s_cbranch_vccnz L_w_185
    s_waitcnt vmcnt(4)
L_w_185:
    buffer_load_dwordx4 v[156:159], v1, s[28:31], s41 offen offset:3072 nt
    v_mov_b32 v250, 184
    ds_write_b32 v248, v250 offset:96
    v_dot2_f32_bf16 v16, v128, v4, 0
    v_dot2_f32_bf16 v16, v129, v5, v16
    v_dot2_f32_bf16 v16, v130, v6, v16
    v_dot2_f32_bf16 v16, v131, v7, v16
    s_waitcnt vmcnt(6)
    s_cbranch_vccnz L_w_186
    s_waitcnt vmcnt(4)
L_w_186:
    s_add_u32 s41, s41, s42
    buffer_load_dwordx4 v[160:163], v1, s[28:31], s41 offen offset:0 nt
    v_dot2_f32_bf16 v17, v132, v4, 0
    v_dot2_f32_bf16 v17, v133, v5, v17
    v_dot2_f32_bf16 v17, v134, v6, v17
    v_dot2_f32_bf16 v17, v135, v7, v17
    s_waitcnt vmcnt(6)
    s_cbranch_vccnz L_w_187
    s_waitcnt vmcnt(4)
L_w_187:
    buffer_load_dwordx4 v[164:167], v1, s[28:31], s41 offen offset:1024 nt
    v_dot2_f32_bf16 v18, v136, v4, 0
    v_dot2_f32_bf16 v18, v137, v5, v18
    v_dot2_f32_bf16 v18, v138, v6, v18
    v_dot2_f32_bf16 v18, v139, v7, v18
    s_waitcnt vmcnt(6)
    s_cbranch_vccnz L_w_188
    s_waitcnt vmcnt(4)
L_w_188:
    buffer_load_dwordx4 v[168:171], v1, s[28:31], s41 offen offset:2048 nt
    v_dot2_f32_bf16 v19, v140, v4, 0
    v_dot2_f32_bf16 v19, v141, v5, v19
    v_dot2_f32_bf16 v19, v142, v6, v19
    v_dot2_f32_bf16 v19, v143, v7, v19
    s_waitcnt lgkmcnt(0)
    v_cmp_lt_u32 vcc, v250, v249
    ds_read_b32 v249, v15 offset:28
    s_waitcnt vmcnt(6)
    s_cbranch_vccnz L_w_189
    s_waitcnt vmcnt(4)
L_w_189:
    buffer_load_dwordx4 v[172:175], v1, s[28:31], s41 offen offset:3072 nt
    v_mov_b32 v250, 188
    ds_write_b32 v248, v250 offset:96
    v_dot2_f32_bf16 v20, v144, v4, 0
    v_dot2_f32_bf16 v20, v145, v5, v20
    v_dot2_f32_bf16 v20, v146, v6, v20
    v_dot2_f32_bf16 v20, v147, v7, v20
    s_waitcnt vmcnt(6)
    s_cbranch_vccnz L_w_190
    s_waitcnt vmcnt(4)
L_w_190:
    s_add_u32 s41, s41, s42
    buffer_load_dwordx4 v[176:179], v1, s[28:31], s41 offen offset:0 nt
    v_dot2_f32_bf16 v21, v148, v4, 0
    v_dot2_f32_bf16 v21, v149, v5, v21
    v_dot2_f32_bf16 v21, v150, v6, v21
    v_dot2_f32_bf16 v21, v151, v7, v21
    s_waitcnt vmcnt(6)
    s_cbranch_vccnz L_w_191
    s_waitcnt vmcnt(4)
L_w_191:
    buffer_load_dwordx4 v[180:183], v1, s[28:31], s41 offen offset:1024 nt
    v_dot2_f32_bf16 v22, v152, v4, 0
    v_dot2_f32_bf16 v22, v153, v5, v22
    v_dot2_f32_bf16 v22, v154, v6, v22
    v_dot2_f32_bf16 v22, v155, v7, v22
    s_waitcnt vmcnt(6)
    s_cbranch_vccnz L_w_192
    s_waitcnt vmcnt(4)
L_w_192:
    buffer_load_dwordx4 v[184:187], v1, s[28:31], s41 offen offset:2048 nt
    v_dot2_f32_bf16 v23, v156, v4, 0
    v_dot2_f32_bf16 v23, v157, v5, v23
    v_dot2_f32_bf16 v23, v158, v6, v23
    v_dot2_f32_bf16 v23, v159, v7, v23
    s_waitcnt lgkmcnt(0)
    v_cmp_lt_u32 vcc, v250, v249
    ds_read_b32 v249, v15 offset:28
    s_waitcnt vmcnt(6)
    s_cbranch_vccnz L_w_193
    s_waitcnt vmcnt(4)
L_w_193:
    buffer_load_dwordx4 v[188:191], v1, s[28:31], s41 offen offset:3072 nt
    v_mov_b32 v250, 192
    ds_write_b32 v248, v250 offset:96
    v_dot2_f32_bf16 v24, v160, v4, 0
    v_dot2_f32_bf16 v24, v161, v5, v24
    v_dot2_f32_bf16 v24, v162, v6, v24
    v_dot2_f32_bf16 v24, v163, v7, v24
    s_waitcnt vmcnt(6)
    s_cbranch_vccnz L_w_194
    s_waitcnt vmcnt(4)
L_w_194:
    s_add_u32 s41, s41, s42
    buffer_load_dwordx4 v[192:195], v1, s[28:31], s41 offen offset:0 nt
    v_dot2_f32_bf16 v25, v164, v4, 0
    v_dot2_f32_bf16 v25, v165, v5, v25
    v_dot2_f32_bf16 v25, v166, v6, v25
    v_dot2_f32_bf16 v25, v167, v7, v25
    s_waitcnt vmcnt(6)
    s_cbranch_vccnz L_w_195
    s_waitcnt vmcnt(4)
L_w_195:
    buffer_load_dwordx4 v[196:199], v1, s[28:31], s41 offen offset:1024 nt
    v_dot2_f32_bf16 v26, v168, v4, 0
    v_dot2_f32_bf16 v26, v169, v5, v26
    v_dot2_f32_bf16 v26, v170, v6, v26
    v_dot2_f32_bf16 v26, v171, v7, v26
    s_waitcnt vmcnt(6)
    s_cbranch_vccnz L_w_196
    s_waitcnt vmcnt(4)
L_w_196:
    buffer_load_dwordx4 v[200:203], v1, s[28:31], s41 offen offset:2048 nt
    v_dot2_f32_bf16 v27, v172, v4, 0
    v_dot2_f32_bf16 v27, v173, v5, v27
    v_dot2_f32_bf16 v27, v174, v6, v27
    v_dot2_f32_bf16 v27, v175, v7, v27
    s_waitcnt lgkmcnt(0)
    v_cmp_lt_u32 vcc, v250, v249
    ds_read_b32 v249, v15 offset:28
    s_waitcnt vmcnt(6)
    s_cbranch_vccnz L_w_197
    s_waitcnt vmcnt(4)
L_w_197:
    buffer_load_dwordx4 v[204:207], v1, s[28:31], s41 offen offset:3072 nt
    v_mov_b32 v250, 196
    ds_write_b32 v248, v250 offset:96
    v_dot2_f32_bf16 v28, v176, v4, 0
    v_dot2_f32_bf16 v28, v177, v5, v28
    v_dot2_f32_bf16 v28, v178, v6, v28
    v_dot2_f32_bf16 v28, v179, v7, v28
    s_waitcnt vmcnt(6)
    s_cbranch_vccnz L_w_198
    s_waitcnt vmcnt(4)
L_w_198:
    s_add_u32 s41, s41, s42
    buffer_load_dwordx4 v[208:211], v1, s[28:31], s41 offen offset:0 nt
    v_dot2_f32_bf16 v29, v180, v4, 0
    v_dot2_f32_bf16 v29, v181, v5, v29
    v_dot2_f32_bf16 v29, v182, v6, v29
    v_dot2_f32_bf16 v29, v183, v7, v29
    s_waitcnt vmcnt(6)
    s_cbranch_vccnz L_w_199
    s_waitcnt vmcnt(4)
L_w_199:
    buffer_load_dwordx4 v[212:215], v1, s[28:31], s41 offen offset:1024 nt
    v_dot2_f32_bf16 v30, v184, v4, 0
    v_dot2_f32_bf16 v30, v185, v5, v30
    v_dot2_f32_bf16 v30, v186, v6, v30
    v_dot2_f32_bf16 v30, v187, v7, v30
    s_waitcnt vmcnt(6)
    s_cbranch_vccnz L_w_200
    s_waitcnt vmcnt(4)
L_w_200:
    buffer_load_dwordx4 v[216:219], v1, s[28:31], s41 offen offset:2048 nt
    v_dot2_f32_bf16 v31, v188, v4, 0
    v_dot2_f32_bf16 v31, v189, v5, v31
    v_dot2_f32_bf16 v31, v190, v6, v31
    v_dot2_f32_bf16 v31, v191, v7, v31
    v_permlane16_swap_b32 v16, v24
    v_permlane16_swap_b32 v17, v25
    v_permlane16_swap_b32 v18, v26
    v_permlane16_swap_b32 v19, v27
    v_permlane16_swap_b32 v20, v28
    v_permlane16_swap_b32 v21, v29
    v_permlane16_swap_b32 v22, v30
    v_permlane16_swap_b32 v23, v31
    v_add_f32 v16, v16, v24
    v_add_f32 v17, v17, v25
    v_add_f32 v18, v18, v26
    v_add_f32 v19, v19, v27
    v_add_f32 v20, v20, v28
    v_add_f32 v21, v21, v29
    v_add_f32 v22, v22, v30
    v_add_f32 v23, v23, v31
    v_add_f32_dpp v24, v16, v16 row_ror:8 row_mask:0xf bank_mask:0x3
    v_add_f32_dpp v25, v17, v17 row_ror:8 row_mask:0xf bank_mask:0x3
    v_add_f32_dpp v26, v18, v18 row_ror:8 row_mask:0xf bank_mask:0x3
    v_add_f32_dpp v27, v19, v19 row_ror:8 row_mask:0xf bank_mask:0x3
    v_add_f32_dpp v24, v20, v20 row_ror:8 row_mask:0xf bank_mask:0xc
    v_add_f32_dpp v25, v21, v21 row_ror:8 row_mask:0xf bank_mask:0xc
    v_add_f32_dpp v26, v22, v22 row_ror:8 row_mask:0xf bank_mask:0xc
    v_add_f32_dpp v27, v23, v23 row_ror:8 row_mask:0xf bank_mask:0xc
    v_add_f32_dpp v16, v24, v24 row_shl:4 row_mask:0xf bank_mask:0x5
    v_add_f32_dpp v17, v25, v25 row_shl:4 row_mask:0xf bank_mask:0x5
    s_nop 0
    v_add_f32_dpp v16, v26, v26 row_shr:4 row_mask:0xf bank_mask:0xa
    v_add_f32_dpp v17, v27, v27 row_shr:4 row_mask:0xf bank_mask:0xa
    s_nop 0
    v_add_f32_dpp v16, v16, v16 quad_perm:[1,0,3,2] row_mask:0xf bank_mask:0xf
    v_add_f32_dpp v17, v17, v17 quad_perm:[1,0,3,2] row_mask:0xf bank_mask:0xf
    s_nop 0
    v_add_f32_dpp v16, v16, v16 quad_perm:[2,3,0,1] row_mask:0xf bank_mask:0xf
    v_add_f32_dpp v17, v17, v17 quad_perm:[2,3,0,1] row_mask:0xf bank_mask:0xf
    ds_write_b64 v12, v[16:17] offset:704
    s_waitcnt lgkmcnt(1)
    v_cmp_lt_u32 vcc, v250, v249
    ds_read_b32 v249, v15 offset:28
    s_waitcnt vmcnt(6)
    s_cbranch_vccnz L_w_201
    s_waitcnt vmcnt(4)
L_w_201:
    buffer_load_dwordx4 v[220:223], v1, s[28:31], s41 offen offset:3072 nt
    v_mov_b32 v250, 200
    ds_write_b32 v248, v250 offset:96
    v_dot2_f32_bf16 v16, v192, v4, 0
    v_dot2_f32_bf16 v16, v193, v5, v16
    v_dot2_f32_bf16 v16, v194, v6, v16
    v_dot2_f32_bf16 v16, v195, v7, v16
    s_waitcnt vmcnt(6)
    s_cbranch_vccnz L_w_202
    s_waitcnt vmcnt(4)
L_w_202:
    s_add_u32 s41, s41, s42
    buffer_load_dwordx4 v[224:227], v1, s[28:31], s41 offen offset:0 nt
    v_dot2_f32_bf16 v17, v196, v4, 0
    v_dot2_f32_bf16 v17, v197, v5, v17
    v_dot2_f32_bf16 v17, v198, v6, v17
    v_dot2_f32_bf16 v17, v199, v7, v17
    s_waitcnt vmcnt(6)
    s_cbranch_vccnz L_w_203
    s_waitcnt vmcnt(4)
L_w_203:
    buffer_load_dwordx4 v[228:231], v1, s[28:31], s41 offen offset:1024 nt
    v_dot2_f32_bf16 v18, v200, v4, 0
    v_dot2_f32_bf16 v18, v201, v5, v18
    v_dot2_f32_bf16 v18, v202, v6, v18
    v_dot2_f32_bf16 v18, v203, v7, v18
    s_waitcnt vmcnt(6)
    s_cbranch_vccnz L_w_204
    s_waitcnt vmcnt(4)
L_w_204:
    buffer_load_dwordx4 v[232:235], v1, s[28:31], s41 offen offset:2048 nt
    v_dot2_f32_bf16 v19, v204, v4, 0
    v_dot2_f32_bf16 v19, v205, v5, v19
    v_dot2_f32_bf16 v19, v206, v6, v19
    v_dot2_f32_bf16 v19, v207, v7, v19
    s_waitcnt lgkmcnt(0)
    v_cmp_lt_u32 vcc, v250, v249
    ds_read_b32 v249, v15 offset:28
    s_waitcnt vmcnt(6)
    s_cbranch_vccnz L_w_205
    s_waitcnt vmcnt(4)
L_w_205:
    buffer_load_dwordx4 v[236:239], v1, s[28:31], s41 offen offset:3072 nt
    v_mov_b32 v250, 204
    ds_write_b32 v248, v250 offset:96
    v_dot2_f32_bf16 v20, v208, v4, 0
    v_dot2_f32_bf16 v20, v209, v5, v20
    v_dot2_f32_bf16 v20, v210, v6, v20
    v_dot2_f32_bf16 v20, v211, v7, v20
    s_waitcnt vmcnt(6)
    s_cbranch_vccnz L_w_206
    s_waitcnt vmcnt(4)
L_w_206:
    s_add_u32 s41, s41, s42
    buffer_load_dwordx4 v[48:51], v1, s[28:31], s41 offen offset:0 nt
    v_dot2_f32_bf16 v21, v212, v4, 0
    v_dot2_f32_bf16 v21, v213, v5, v21
    v_dot2_f32_bf16 v21, v214, v6, v21
    v_dot2_f32_bf16 v21, v215, v7, v21
    s_waitcnt vmcnt(6)
    s_cbranch_vccnz L_w_207
    s_waitcnt vmcnt(4)
L_w_207:
    buffer_load_dwordx4 v[52:55], v1, s[28:31], s41 offen offset:1024 nt
    v_dot2_f32_bf16 v22, v216, v4, 0
    v_dot2_f32_bf16 v22, v217, v5, v22
    v_dot2_f32_bf16 v22, v218, v6, v22
    v_dot2_f32_bf16 v22, v219, v7, v22
    s_waitcnt vmcnt(6)
    s_cbranch_vccnz L_w_208
    s_waitcnt vmcnt(4)
L_w_208:
    buffer_load_dwordx4 v[56:59], v1, s[28:31], s41 offen offset:2048 nt
    v_dot2_f32_bf16 v23, v220, v4, 0
    v_dot2_f32_bf16 v23, v221, v5, v23
    v_dot2_f32_bf16 v23, v222, v6, v23
    v_dot2_f32_bf16 v23, v223, v7, v23
    s_waitcnt lgkmcnt(0)
    v_cmp_lt_u32 vcc, v250, v249
    ds_read_b32 v249, v15 offset:28
    s_waitcnt vmcnt(6)
    s_cbranch_vccnz L_w_209
    s_waitcnt vmcnt(4)
L_w_209:
    buffer_load_dwordx4 v[60:63], v1, s[28:31], s41 offen offset:3072 nt
    v_mov_b32 v250, 208
    ds_write_b32 v248, v250 offset:96
    v_dot2_f32_bf16 v24, v224, v4, 0
    v_dot2_f32_bf16 v24, v225, v5, v24
    v_dot2_f32_bf16 v24, v226, v6, v24
    v_dot2_f32_bf16 v24, v227, v7, v24
    s_waitcnt vmcnt(6)
    s_cbranch_vccnz L_w_210
    s_waitcnt vmcnt(4)
L_w_210:
    s_add_u32 s41, s41, s42
    buffer_load_dwordx4 v[64:67], v1, s[28:31], s41 offen offset:0 nt
    v_dot2_f32_bf16 v25, v228, v4, 0
    v_dot2_f32_bf16 v25, v229, v5, v25
    v_dot2_f32_bf16 v25, v230, v6, v25
    v_dot2_f32_bf16 v25, v231, v7, v25
    s_waitcnt vmcnt(6)
    s_cbranch_vccnz L_w_211
    s_waitcnt vmcnt(4)
L_w_211:
    buffer_load_dwordx4 v[68:71], v1, s[28:31], s41 offen offset:1024 nt
    v_dot2_f32_bf16 v26, v232, v4, 0
    v_dot2_f32_bf16 v26, v233, v5, v26
    v_dot2_f32_bf16 v26, v234, v6, v26
    v_dot2_f32_bf16 v26, v235, v7, v26
    s_waitcnt vmcnt(6)
    s_cbranch_vccnz L_w_212
    s_waitcnt vmcnt(4)
L_w_212:
    buffer_load_dwordx4 v[72:75], v1, s[28:31], s41 offen offset:2048 nt
    v_dot2_f32_bf16 v27, v236, v4, 0
    v_dot2_f32_bf16 v27, v237, v5, v27
    v_dot2_f32_bf16 v27, v238, v6, v27
    v_dot2_f32_bf16 v27, v239, v7, v27
    s_waitcnt lgkmcnt(0)
    v_cmp_lt_u32 vcc, v250, v249
    ds_read_b32 v249, v15 offset:28
    s_waitcnt vmcnt(6)
    s_cbranch_vccnz L_w_213
    s_waitcnt vmcnt(4)
L_w_213:
    buffer_load_dwordx4 v[76:79], v1, s[28:31], s41 offen offset:3072 nt
    v_mov_b32 v250, 212
    ds_write_b32 v248, v250 offset:96
    v_dot2_f32_bf16 v28, v48, v4, 0
    v_dot2_f32_bf16 v28, v49, v5, v28
    v_dot2_f32_bf16 v28, v50, v6, v28
    v_dot2_f32_bf16 v28, v51, v7, v28
    s_waitcnt vmcnt(6)
    s_cbranch_vccnz L_w_214
    s_waitcnt vmcnt(4)
L_w_214:
    s_add_u32 s41, s41, s42
    buffer_load_dwordx4 v[80:83], v1, s[28:31], s41 offen offset:0 nt
    v_dot2_f32_bf16 v29, v52, v4, 0
    v_dot2_f32_bf16 v29, v53, v5, v29
    v_dot2_f32_bf16 v29, v54, v6, v29
    v_dot2_f32_bf16 v29, v55, v7, v29
    s_waitcnt vmcnt(6)
    s_cbranch_vccnz L_w_215
    s_waitcnt vmcnt(4)
L_w_215:
    buffer_load_dwordx4 v[84:87], v1, s[28:31], s41 offen offset:1024 nt
    v_dot2_f32_bf16 v30, v56, v4, 0
    v_dot2_f32_bf16 v30, v57, v5, v30
    v_dot2_f32_bf16 v30, v58, v6, v30
    v_dot2_f32_bf16 v30, v59, v7, v30
    s_waitcnt vmcnt(6)
    s_cbranch_vccnz L_w_216
    s_waitcnt vmcnt(4)
L_w_216:
    buffer_load_dwordx4 v[88:91], v1, s[28:31], s41 offen offset:2048 nt
    v_dot2_f32_bf16 v31, v60, v4, 0
    v_dot2_f32_bf16 v31, v61, v5, v31
    v_dot2_f32_bf16 v31, v62, v6, v31
    v_dot2_f32_bf16 v31, v63, v7, v31
    v_permlane16_swap_b32 v16, v24
    v_permlane16_swap_b32 v17, v25
    v_permlane16_swap_b32 v18, v26
    v_permlane16_swap_b32 v19, v27
    v_permlane16_swap_b32 v20, v28
    v_permlane16_swap_b32 v21, v29
    v_permlane16_swap_b32 v22, v30
    v_permlane16_swap_b32 v23, v31
    v_add_f32 v16, v16, v24
    v_add_f32 v17, v17, v25
    v_add_f32 v18, v18, v26
    v_add_f32 v19, v19, v27
    v_add_f32 v20, v20, v28
    v_add_f32 v21, v21, v29
    v_add_f32 v22, v22, v30
    v_add_f32 v23, v23, v31
    v_add_f32_dpp v24, v16, v16 row_ror:8 row_mask:0xf bank_mask:0x3
    v_add_f32_dpp v25, v17, v17 row_ror:8 row_mask:0xf bank_mask:0x3
    v_add_f32_dpp v26, v18, v18 row_ror:8 row_mask:0xf bank_mask:0x3
    v_add_f32_dpp v27, v19, v19 row_ror:8 row_mask:0xf bank_mask:0x3
    v_add_f32_dpp v24, v20, v20 row_ror:8 row_mask:0xf bank_mask:0xc
    v_add_f32_dpp v25, v21, v21 row_ror:8 row_mask:0xf bank_mask:0xc
    v_add_f32_dpp v26, v22, v22 row_ror:8 row_mask:0xf bank_mask:0xc
    v_add_f32_dpp v27, v23, v23 row_ror:8 row_mask:0xf bank_mask:0xc
    v_add_f32_dpp v16, v24, v24 row_shl:4 row_mask:0xf bank_mask:0x5
    v_add_f32_dpp v17, v25, v25 row_shl:4 row_mask:0xf bank_mask:0x5
    s_nop 0
    v_add_f32_dpp v16, v26, v26 row_shr:4 row_mask:0xf bank_mask:0xa
    v_add_f32_dpp v17, v27, v27 row_shr:4 row_mask:0xf bank_mask:0xa
    s_nop 0
    v_add_f32_dpp v16, v16, v16 quad_perm:[1,0,3,2] row_mask:0xf bank_mask:0xf
    v_add_f32_dpp v17, v17, v17 quad_perm:[1,0,3,2] row_mask:0xf bank_mask:0xf
    s_nop 0
    v_add_f32_dpp v16, v16, v16 quad_perm:[2,3,0,1] row_mask:0xf bank_mask:0xf
    v_add_f32_dpp v17, v17, v17 quad_perm:[2,3,0,1] row_mask:0xf bank_mask:0xf
    ds_write_b64 v12, v[16:17] offset:768
    s_waitcnt lgkmcnt(1)
    v_cmp_lt_u32 vcc, v250, v249
    ds_read_b32 v249, v15 offset:28
    s_waitcnt vmcnt(6)
    s_cbranch_vccnz L_w_217
    s_waitcnt vmcnt(4)
L_w_217:
    buffer_load_dwordx4 v[92:95], v1, s[28:31], s41 offen offset:3072 nt
    v_mov_b32 v250, 216
    ds_write_b32 v248, v250 offset:96
    v_dot2_f32_bf16 v16, v64, v4, 0
    v_dot2_f32_bf16 v16, v65, v5, v16
    v_dot2_f32_bf16 v16, v66, v6, v16
    v_dot2_f32_bf16 v16, v67, v7, v16
    s_waitcnt vmcnt(6)
    s_cbranch_vccnz L_w_218
    s_waitcnt vmcnt(4)
L_w_218:
    s_add_u32 s41, s41, s42
    buffer_load_dwordx4 v[96:99], v1, s[28:31], s41 offen offset:0 nt
    v_dot2_f32_bf16 v17, v68, v4, 0
    v_dot2_f32_bf16 v17, v69, v5, v17
    v_dot2_f32_bf16 v17, v70, v6, v17
    v_dot2_f32_bf16 v17, v71, v7, v17
    s_waitcnt vmcnt(6)
    s_cbranch_vccnz L_w_219
    s_waitcnt vmcnt(4)
L_w_219:
    buffer_load_dwordx4 v[100:103], v1, s[28:31], s41 offen offset:1024 nt
    v_dot2_f32_bf16 v18, v72, v4, 0
    v_dot2_f32_bf16 v18, v73, v5, v18
    v_dot2_f32_bf16 v18, v74, v6, v18
    v_dot2_f32_bf16 v18, v75, v7, v18
    s_waitcnt vmcnt(6)
    s_cbranch_vccnz L_w_220
    s_waitcnt vmcnt(4)
L_w_220:
    buffer_load_dwordx4 v[104:107], v1, s[28:31], s41 offen offset:2048 nt
    v_dot2_f32_bf16 v19, v76, v4, 0
    v_dot2_f32_bf16 v19, v77, v5, v19
    v_dot2_f32_bf16 v19, v78, v6, v19
    v_dot2_f32_bf16 v19, v79, v7, v19
    s_waitcnt lgkmcnt(0)
    v_cmp_lt_u32 vcc, v250, v249
    ds_read_b32 v249, v15 offset:28
    s_waitcnt vmcnt(6)
    s_cbranch_vccnz L_w_221
    s_waitcnt vmcnt(4)
L_w_221:
    buffer_load_dwordx4 v[108:111], v1, s[28:31], s41 offen offset:3072 nt
    v_mov_b32 v250, 220
    ds_write_b32 v248, v250 offset:96
    v_dot2_f32_bf16 v20, v80, v4, 0
    v_dot2_f32_bf16 v20, v81, v5, v20
    v_dot2_f32_bf16 v20, v82, v6, v20
    v_dot2_f32_bf16 v20, v83, v7, v20
    s_waitcnt vmcnt(6)
    s_cbranch_vccnz L_w_222
    s_waitcnt vmcnt(4)
L_w_222:
    s_add_u32 s41, s41, s42
    buffer_load_dwordx4 v[112:115], v1, s[28:31], s41 offen offset:0 nt
    v_dot2_f32_bf16 v21, v84, v4, 0
    v_dot2_f32_bf16 v21, v85, v5, v21
    v_dot2_f32_bf16 v21, v86, v6, v21
    v_dot2_f32_bf16 v21, v87, v7, v21
    s_waitcnt vmcnt(6)
    s_cbranch_vccnz L_w_223
    s_waitcnt vmcnt(4)
L_w_223:
    buffer_load_dwordx4 v[116:119], v1, s[28:31], s41 offen offset:1024 nt
    v_dot2_f32_bf16 v22, v88, v4, 0
    v_dot2_f32_bf16 v22, v89, v5, v22
    v_dot2_f32_bf16 v22, v90, v6, v22
    v_dot2_f32_bf16 v22, v91, v7, v22
    s_waitcnt vmcnt(6)
    s_cbranch_vccnz L_w_224
    s_waitcnt vmcnt(4)
L_w_224:
    buffer_load_dwordx4 v[120:123], v1, s[28:31], s41 offen offset:2048 nt
    v_dot2_f32_bf16 v23, v92, v4, 0
    v_dot2_f32_bf16 v23, v93, v5, v23
    v_dot2_f32_bf16 v23, v94, v6, v23
    v_dot2_f32_bf16 v23, v95, v7, v23
    s_waitcnt lgkmcnt(0)
    v_cmp_lt_u32 vcc, v250, v249
    ds_read_b32 v249, v15 offset:28
    s_waitcnt vmcnt(6)
    s_cbranch_vccnz L_w_225
    s_waitcnt vmcnt(4)
L_w_225:
    buffer_load_dwordx4 v[124:127], v1, s[28:31], s41 offen offset:3072 nt
    v_mov_b32 v250, 224
    ds_write_b32 v248, v250 offset:96
    v_dot2_f32_bf16 v24, v96, v4, 0
    v_dot2_f32_bf16 v24, v97, v5, v24
    v_dot2_f32_bf16 v24, v98, v6, v24
    v_dot2_f32_bf16 v24, v99, v7, v24
    s_waitcnt vmcnt(6)
    s_cbranch_vccnz L_w_226
    s_waitcnt vmcnt(4)
L_w_226:
    s_add_u32 s41, s41, s42
    buffer_load_dwordx4 v[128:131], v1, s[28:31], s41 offen offset:0 nt
    v_dot2_f32_bf16 v25, v100, v4, 0
    v_dot2_f32_bf16 v25, v101, v5, v25
    v_dot2_f32_bf16 v25, v102, v6, v25
    v_dot2_f32_bf16 v25, v103, v7, v25
    s_waitcnt vmcnt(6)
    s_cbranch_vccnz L_w_227
    s_waitcnt vmcnt(4)
L_w_227:
    buffer_load_dwordx4 v[132:135], v1, s[28:31], s41 offen offset:1024 nt
    v_dot2_f32_bf16 v26, v104, v4, 0
    v_dot2_f32_bf16 v26, v105, v5, v26
    v_dot2_f32_bf16 v26, v106, v6, v26
    v_dot2_f32_bf16 v26, v107, v7, v26
    s_waitcnt vmcnt(6)
    s_cbranch_vccnz L_w_228
    s_waitcnt vmcnt(4)
L_w_228:
    buffer_load_dwordx4 v[136:139], v1, s[28:31], s41 offen offset:2048 nt
    v_dot2_f32_bf16 v27, v108, v4, 0
    v_dot2_f32_bf16 v27, v109, v5, v27
    v_dot2_f32_bf16 v27, v110, v6, v27
    v_dot2_f32_bf16 v27, v111, v7, v27
    s_waitcnt lgkmcnt(0)
    v_cmp_lt_u32 vcc, v250, v249
    ds_read_b32 v249, v15 offset:28
    s_waitcnt vmcnt(6)
    s_cbranch_vccnz L_w_229
    s_waitcnt vmcnt(4)
L_w_229:
    buffer_load_dwordx4 v[140:143], v1, s[28:31], s41 offen offset:3072 nt
    v_mov_b32 v250, 228
    ds_write_b32 v248, v250 offset:96
    v_dot2_f32_bf16 v28, v112, v4, 0
    v_dot2_f32_bf16 v28, v113, v5, v28
    v_dot2_f32_bf16 v28, v114, v6, v28
    v_dot2_f32_bf16 v28, v115, v7, v28
    s_waitcnt vmcnt(6)
    s_cbranch_vccnz L_w_230
    s_waitcnt vmcnt(4)
L_w_230:
    s_add_u32 s41, s41, s42
    buffer_load_dwordx4 v[144:147], v1, s[28:31], s41 offen offset:0 nt
    v_dot2_f32_bf16 v29, v116, v4, 0
    v_dot2_f32_bf16 v29, v117, v5, v29
    v_dot2_f32_bf16 v29, v118, v6, v29
    v_dot2_f32_bf16 v29, v119, v7, v29
    s_waitcnt vmcnt(6)
    s_cbranch_vccnz L_w_231
    s_waitcnt vmcnt(4)
L_w_231:
    buffer_load_dwordx4 v[148:151], v1, s[28:31], s41 offen offset:1024 nt
    v_dot2_f32_bf16 v30, v120, v4, 0
    v_dot2_f32_bf16 v30, v121, v5, v30
    v_dot2_f32_bf16 v30, v122, v6, v30
    v_dot2_f32_bf16 v30, v123, v7, v30
    s_waitcnt vmcnt(6)
    s_cbranch_vccnz L_w_232
    s_waitcnt vmcnt(4)
L_w_232:
    buffer_load_dwordx4 v[152:155], v1, s[28:31], s41 offen offset:2048 nt
    v_dot2_f32_bf16 v31, v124, v4, 0
    v_dot2_f32_bf16 v31, v125, v5, v31
    v_dot2_f32_bf16 v31, v126, v6, v31
    v_dot2_f32_bf16 v31, v127, v7, v31
    v_permlane16_swap_b32 v16, v24
    v_permlane16_swap_b32 v17, v25
    v_permlane16_swap_b32 v18, v26
    v_permlane16_swap_b32 v19, v27
    v_permlane16_swap_b32 v20, v28
    v_permlane16_swap_b32 v21, v29
    v_permlane16_swap_b32 v22, v30
    v_permlane16_swap_b32 v23, v31
    v_add_f32 v16, v16, v24
    v_add_f32 v17, v17, v25
    v_add_f32 v18, v18, v26
    v_add_f32 v19, v19, v27
    v_add_f32 v20, v20, v28
    v_add_f32 v21, v21, v29
    v_add_f32 v22, v22, v30
    v_add_f32 v23, v23, v31
    v_add_f32_dpp v24, v16, v16 row_ror:8 row_mask:0xf bank_mask:0x3
    v_add_f32_dpp v25, v17, v17 row_ror:8 row_mask:0xf bank_mask:0x3
    v_add_f32_dpp v26, v18, v18 row_ror:8 row_mask:0xf bank_mask:0x3
    v_add_f32_dpp v27, v19, v19 row_ror:8 row_mask:0xf bank_mask:0x3
    v_add_f32_dpp v24, v20, v20 row_ror:8 row_mask:0xf bank_mask:0xc
    v_add_f32_dpp v25, v21, v21 row_ror:8 row_mask:0xf bank_mask:0xc
    v_add_f32_dpp v26, v22, v22 row_ror:8 row_mask:0xf bank_mask:0xc
    v_add_f32_dpp v27, v23, v23 row_ror:8 row_mask:0xf bank_mask:0xc
    v_add_f32_dpp v16, v24, v24 row_shl:4 row_mask:0xf bank_mask:0x5
    v_add_f32_dpp v17, v25, v25 row_shl:4 row_mask:0xf bank_mask:0x5
    s_nop 0
    v_add_f32_dpp v16, v26, v26 row_shr:4 row_mask:0xf bank_mask:0xa
    v_add_f32_dpp v17, v27, v27 row_shr:4 row_mask:0xf bank_mask:0xa
    s_nop 0
    v_add_f32_dpp v16, v16, v16 quad_perm:[1,0,3,2] row_mask:0xf bank_mask:0xf
    v_add_f32_dpp v17, v17, v17 quad_perm:[1,0,3,2] row_mask:0xf bank_mask:0xf
    s_nop 0
    v_add_f32_dpp v16, v16, v16 quad_perm:[2,3,0,1] row_mask:0xf bank_mask:0xf
    v_add_f32_dpp v17, v17, v17 quad_perm:[2,3,0,1] row_mask:0xf bank_mask:0xf
    ds_write_b64 v12, v[16:17] offset:832
    s_waitcnt lgkmcnt(1)
    v_cmp_lt_u32 vcc, v250, v249
    ds_read_b32 v249, v15 offset:28
    s_waitcnt vmcnt(6)
    s_cbranch_vccnz L_w_233
    s_waitcnt vmcnt(4)
L_w_233:
    buffer_load_dwordx4 v[156:159], v1, s[28:31], s41 offen offset:3072 nt
    v_mov_b32 v250, 232
    ds_write_b32 v248, v250 offset:96
    v_dot2_f32_bf16 v16, v128, v4, 0
    v_dot2_f32_bf16 v16, v129, v5, v16
    v_dot2_f32_bf16 v16, v130, v6, v16
    v_dot2_f32_bf16 v16, v131, v7, v16
    s_waitcnt vmcnt(6)
    s_cbranch_vccnz L_w_234
    s_waitcnt vmcnt(4)
L_w_234:
    s_add_u32 s41, s41, s42
    buffer_load_dwordx4 v[160:163], v1, s[28:31], s41 offen offset:0 nt
    v_dot2_f32_bf16 v17, v132, v4, 0
    v_dot2_f32_bf16 v17, v133, v5, v17
    v_dot2_f32_bf16 v17, v134, v6, v17
    v_dot2_f32_bf16 v17, v135, v7, v17
    s_waitcnt vmcnt(6)
    s_cbranch_vccnz L_w_235
    s_waitcnt vmcnt(4)
L_w_235:
    buffer_load_dwordx4 v[164:167], v1, s[28:31], s41 offen offset:1024 nt
    v_dot2_f32_bf16 v18, v136, v4, 0
    v_dot2_f32_bf16 v18, v137, v5, v18
    v_dot2_f32_bf16 v18, v138, v6, v18
    v_dot2_f32_bf16 v18, v139, v7, v18
    s_waitcnt vmcnt(6)
    s_cbranch_vccnz L_w_236
    s_waitcnt vmcnt(4)
L_w_236:
    buffer_load_dwordx4 v[168:171], v1, s[28:31], s41 offen offset:2048 nt
    v_dot2_f32_bf16 v19, v140, v4, 0
    v_dot2_f32_bf16 v19, v141, v5, v19
    v_dot2_f32_bf16 v19, v142, v6, v19
    v_dot2_f32_bf16 v19, v143, v7, v19
    s_waitcnt lgkmcnt(0)
    v_cmp_lt_u32 vcc, v250, v249
    ds_read_b32 v249, v15 offset:28
    s_waitcnt vmcnt(6)
    s_cbranch_vccnz L_w_237
    s_waitcnt vmcnt(4)
L_w_237:
    buffer_load_dwordx4 v[172:175], v1, s[28:31], s41 offen offset:3072 nt
    v_mov_b32 v250, 236
    ds_write_b32 v248, v250 offset:96
    v_dot2_f32_bf16 v20, v144, v4, 0
    v_dot2_f32_bf16 v20, v145, v5, v20
    v_dot2_f32_bf16 v20, v146, v6, v20
    v_dot2_f32_bf16 v20, v147, v7, v20
    s_waitcnt vmcnt(6)
    s_cbranch_vccnz L_w_238
    s_waitcnt vmcnt(4)
L_w_238:
    s_add_u32 s41, s41, s42
    buffer_load_dwordx4 v[176:179], v1, s[28:31], s41 offen offset:0 nt
    v_dot2_f32_bf16 v21, v148, v4, 0
    v_dot2_f32_bf16 v21, v149, v5, v21
    v_dot2_f32_bf16 v21, v150, v6, v21
    v_dot2_f32_bf16 v21, v151, v7, v21
    s_waitcnt vmcnt(6)
    s_cbranch_vccnz L_w_239
    s_waitcnt vmcnt(4)
L_w_239:
    buffer_load_dwordx4 v[180:183], v1, s[28:31], s41 offen offset:1024 nt
    v_dot2_f32_bf16 v22, v152, v4, 0
    v_dot2_f32_bf16 v22, v153, v5, v22
    v_dot2_f32_bf16 v22, v154, v6, v22
    v_dot2_f32_bf16 v22, v155, v7, v22
    s_waitcnt vmcnt(6)
    s_cbranch_vccnz L_w_240
    s_waitcnt vmcnt(4)
L_w_240:
    buffer_load_dwordx4 v[184:187], v1, s[28:31], s41 offen offset:2048 nt
    v_dot2_f32_bf16 v23, v156, v4, 0
    v_dot2_f32_bf16 v23, v157, v5, v23
    v_dot2_f32_bf16 v23, v158, v6, v23
    v_dot2_f32_bf16 v23, v159, v7, v23
    s_waitcnt lgkmcnt(0)
    v_cmp_lt_u32 vcc, v250, v249
    ds_read_b32 v249, v15 offset:28
    s_waitcnt vmcnt(6)
    s_cbranch_vccnz L_w_241
    s_waitcnt vmcnt(4)
L_w_241:
    buffer_load_dwordx4 v[188:191], v1, s[28:31], s41 offen offset:3072 nt
    v_mov_b32 v250, 240
    ds_write_b32 v248, v250 offset:96
    v_dot2_f32_bf16 v24, v160, v4, 0
    v_dot2_f32_bf16 v24, v161, v5, v24
    v_dot2_f32_bf16 v24, v162, v6, v24
    v_dot2_f32_bf16 v24, v163, v7, v24
    s_waitcnt vmcnt(6)
    s_cbranch_vccnz L_w_242
    s_waitcnt vmcnt(4)
L_w_242:
    s_add_u32 s41, s41, s42
    buffer_load_dwordx4 v[192:195], v1, s[28:31], s41 offen offset:0 nt
    v_dot2_f32_bf16 v25, v164, v4, 0
    v_dot2_f32_bf16 v25, v165, v5, v25
    v_dot2_f32_bf16 v25, v166, v6, v25
    v_dot2_f32_bf16 v25, v167, v7, v25
    s_waitcnt vmcnt(6)
    s_cbranch_vccnz L_w_243
    s_waitcnt vmcnt(4)
L_w_243:
    buffer_load_dwordx4 v[196:199], v1, s[28:31], s41 offen offset:1024 nt
    v_dot2_f32_bf16 v26, v168, v4, 0
    v_dot2_f32_bf16 v26, v169, v5, v26
    v_dot2_f32_bf16 v26, v170, v6, v26
    v_dot2_f32_bf16 v26, v171, v7, v26
    s_waitcnt vmcnt(6)
    s_cbranch_vccnz L_w_244
    s_waitcnt vmcnt(4)
L_w_244:
    buffer_load_dwordx4 v[200:203], v1, s[28:31], s41 offen offset:2048 nt
    v_dot2_f32_bf16 v27, v172, v4, 0
    v_dot2_f32_bf16 v27, v173, v5, v27
    v_dot2_f32_bf16 v27, v174, v6, v27
    v_dot2_f32_bf16 v27, v175, v7, v27
    s_waitcnt lgkmcnt(0)
    v_cmp_lt_u32 vcc, v250, v249
    ds_read_b32 v249, v15 offset:28
    s_waitcnt vmcnt(6)
    s_cbranch_vccnz L_w_245
    s_waitcnt vmcnt(4)
L_w_245:
    buffer_load_dwordx4 v[204:207], v1, s[28:31], s41 offen offset:3072 nt
    v_mov_b32 v250, 244
    ds_write_b32 v248, v250 offset:96
    v_dot2_f32_bf16 v28, v176, v4, 0
    v_dot2_f32_bf16 v28, v177, v5, v28
    v_dot2_f32_bf16 v28, v178, v6, v28
    v_dot2_f32_bf16 v28, v179, v7, v28
    s_waitcnt vmcnt(6)
    s_cbranch_vccnz L_w_246
    s_waitcnt vmcnt(4)
L_w_246:
    s_add_u32 s41, s41, s42
    buffer_load_dwordx4 v[208:211], v1, s[28:31], s41 offen offset:0 nt
    v_dot2_f32_bf16 v29, v180, v4, 0
    v_dot2_f32_bf16 v29, v181, v5, v29
    v_dot2_f32_bf16 v29, v182, v6, v29
    v_dot2_f32_bf16 v29, v183, v7, v29
    s_waitcnt vmcnt(6)
    s_cbranch_vccnz L_w_247
    s_waitcnt vmcnt(4)
L_w_247:
    buffer_load_dwordx4 v[212:215], v1, s[28:31], s41 offen offset:1024 nt
    v_dot2_f32_bf16 v30, v184, v4, 0
    v_dot2_f32_bf16 v30, v185, v5, v30
    v_dot2_f32_bf16 v30, v186, v6, v30
    v_dot2_f32_bf16 v30, v187, v7, v30
    s_waitcnt vmcnt(6)
    s_cbranch_vccnz L_w_248
    s_waitcnt vmcnt(4)
L_w_248:
    buffer_load_dwordx4 v[216:219], v1, s[28:31], s41 offen offset:2048 nt
    v_dot2_f32_bf16 v31, v188, v4, 0
    v_dot2_f32_bf16 v31, v189, v5, v31
    v_dot2_f32_bf16 v31, v190, v6, v31
    v_dot2_f32_bf16 v31, v191, v7, v31
    v_permlane16_swap_b32 v16, v24
    v_permlane16_swap_b32 v17, v25
    v_permlane16_swap_b32 v18, v26
    v_permlane16_swap_b32 v19, v27
    v_permlane16_swap_b32 v20, v28
    v_permlane16_swap_b32 v21, v29
    v_permlane16_swap_b32 v22, v30
    v_permlane16_swap_b32 v23, v31
    v_add_f32 v16, v16, v24
    v_add_f32 v17, v17, v25
    v_add_f32 v18, v18, v26
    v_add_f32 v19, v19, v27
    v_add_f32 v20, v20, v28
    v_add_f32 v21, v21, v29
    v_add_f32 v22, v22, v30
    v_add_f32 v23, v23, v31
    v_add_f32_dpp v24, v16, v16 row_ror:8 row_mask:0xf bank_mask:0x3
    v_add_f32_dpp v25, v17, v17 row_ror:8 row_mask:0xf bank_mask:0x3
    v_add_f32_dpp v26, v18, v18 row_ror:8 row_mask:0xf bank_mask:0x3
    v_add_f32_dpp v27, v19, v19 row_ror:8 row_mask:0xf bank_mask:0x3
    v_add_f32_dpp v24, v20, v20 row_ror:8 row_mask:0xf bank_mask:0xc
    v_add_f32_dpp v25, v21, v21 row_ror:8 row_mask:0xf bank_mask:0xc
    v_add_f32_dpp v26, v22, v22 row_ror:8 row_mask:0xf bank_mask:0xc
    v_add_f32_dpp v27, v23, v23 row_ror:8 row_mask:0xf bank_mask:0xc
    v_add_f32_dpp v16, v24, v24 row_shl:4 row_mask:0xf bank_mask:0x5
    v_add_f32_dpp v17, v25, v25 row_shl:4 row_mask:0xf bank_mask:0x5
    s_nop 0
    v_add_f32_dpp v16, v26, v26 row_shr:4 row_mask:0xf bank_mask:0xa
    v_add_f32_dpp v17, v27, v27 row_shr:4 row_mask:0xf bank_mask:0xa
    s_nop 0
    v_add_f32_dpp v16, v16, v16 quad_perm:[1,0,3,2] row_mask:0xf bank_mask:0xf
    v_add_f32_dpp v17, v17, v17 quad_perm:[1,0,3,2] row_mask:0xf bank_mask:0xf
    s_nop 0
    v_add_f32_dpp v16, v16, v16 quad_perm:[2,3,0,1] row_mask:0xf bank_mask:0xf
    v_add_f32_dpp v17, v17, v17 quad_perm:[2,3,0,1] row_mask:0xf bank_mask:0xf
    ds_write_b64 v12, v[16:17] offset:896
    s_waitcnt lgkmcnt(1)
    v_cmp_lt_u32 vcc, v250, v249
    ds_read_b32 v249, v15 offset:28
    s_waitcnt vmcnt(6)
    s_cbranch_vccnz L_w_249
    s_waitcnt vmcnt(4)
L_w_249:
    buffer_load_dwordx4 v[220:223], v1, s[28:31], s41 offen offset:3072 nt
    v_mov_b32 v250, 248
    ds_write_b32 v248, v250 offset:96
    v_dot2_f32_bf16 v16, v192, v4, 0
    v_dot2_f32_bf16 v16, v193, v5, v16
    v_dot2_f32_bf16 v16, v194, v6, v16
    v_dot2_f32_bf16 v16, v195, v7, v16
    s_waitcnt vmcnt(6)
    s_cbranch_vccnz L_w_250
    s_waitcnt vmcnt(4)
L_w_250:
    s_add_u32 s41, s41, s42
    buffer_load_dwordx4 v[224:227], v1, s[28:31], s41 offen offset:0 nt
    v_dot2_f32_bf16 v17, v196, v4, 0
    v_dot2_f32_bf16 v17, v197, v5, v17
    v_dot2_f32_bf16 v17, v198, v6, v17
    v_dot2_f32_bf16 v17, v199, v7, v17
    s_waitcnt vmcnt(6)
    s_cbranch_vccnz L_w_251
    s_waitcnt vmcnt(4)
L_w_251:
    buffer_load_dwordx4 v[228:231], v1, s[28:31], s41 offen offset:1024 nt
    v_dot2_f32_bf16 v18, v200, v4, 0
    v_dot2_f32_bf16 v18, v201, v5, v18
    v_dot2_f32_bf16 v18, v202, v6, v18
    v_dot2_f32_bf16 v18, v203, v7, v18
    s_waitcnt vmcnt(6)
    s_cbranch_vccnz L_w_252
    s_waitcnt vmcnt(4)
L_w_252:
    buffer_load_dwordx4 v[232:235], v1, s[28:31], s41 offen offset:2048 nt
    v_dot2_f32_bf16 v19, v204, v4, 0
    v_dot2_f32_bf16 v19, v205, v5, v19
    v_dot2_f32_bf16 v19, v206, v6, v19
    v_dot2_f32_bf16 v19, v207, v7, v19
    s_waitcnt lgkmcnt(0)
    v_cmp_lt_u32 vcc, v250, v249
    ds_read_b32 v249, v15 offset:28
    s_waitcnt vmcnt(6)
    s_cbranch_vccnz L_w_253
    s_waitcnt vmcnt(4)
L_w_253:
    buffer_load_dwordx4 v[236:239], v1, s[28:31], s41 offen offset:3072 nt
    v_mov_b32 v250, 252
    ds_write_b32 v248, v250 offset:96
    v_dot2_f32_bf16 v20, v208, v4, 0
    v_dot2_f32_bf16 v20, v209, v5, v20
    v_dot2_f32_bf16 v20, v210, v6, v20
    v_dot2_f32_bf16 v20, v211, v7, v20
    s_waitcnt vmcnt(6)
    s_cbranch_vccnz L_w_254
    s_waitcnt vmcnt(4)
L_w_254:
    s_add_u32 s41, s41, s42
    buffer_load_dwordx4 v[48:51], v1, s[28:31], s41 offen offset:0 nt
    v_dot2_f32_bf16 v21, v212, v4, 0
    v_dot2_f32_bf16 v21, v213, v5, v21
    v_dot2_f32_bf16 v21, v214, v6, v21
    v_dot2_f32_bf16 v21, v215, v7, v21
    s_waitcnt vmcnt(6)
    s_cbranch_vccnz L_w_255
    s_waitcnt vmcnt(4)
L_w_255:
    buffer_load_dwordx4 v[52:55], v1, s[28:31], s41 offen offset:1024 nt
    v_dot2_f32_bf16 v22, v216, v4, 0
    v_dot2_f32_bf16 v22, v217, v5, v22
    v_dot2_f32_bf16 v22, v218, v6, v22
    v_dot2_f32_bf16 v22, v219, v7, v22
    s_waitcnt vmcnt(6)
    s_cbranch_vccnz L_w_256
    s_waitcnt vmcnt(4)
L_w_256:
    buffer_load_dwordx4 v[56:59], v1, s[28:31], s41 offen offset:2048 nt
    v_dot2_f32_bf16 v23, v220, v4, 0
    v_dot2_f32_bf16 v23, v221, v5, v23
    v_dot2_f32_bf16 v23, v222, v6, v23
    v_dot2_f32_bf16 v23, v223, v7, v23
    s_waitcnt lgkmcnt(0)
    v_cmp_lt_u32 vcc, v250, v249
    ds_read_b32 v249, v15 offset:28
    s_waitcnt vmcnt(6)
    s_cbranch_vccnz L_w_257
    s_waitcnt vmcnt(4)
L_w_257:
    buffer_load_dwordx4 v[60:63], v1, s[28:31], s41 offen offset:3072 nt
    v_mov_b32 v250, 256
    ds_write_b32 v248, v250 offset:96
    v_dot2_f32_bf16 v24, v224, v4, 0
    v_dot2_f32_bf16 v24, v225, v5, v24
    v_dot2_f32_bf16 v24, v226, v6, v24
    v_dot2_f32_bf16 v24, v227, v7, v24
    s_waitcnt vmcnt(6)
    s_cbranch_vccnz L_w_258
    s_waitcnt vmcnt(4)
L_w_258:
    s_mov_b32 s41, s40
    buffer_load_dwordx4 v[64:67], v1, s[32:35], s41 offen offset:0 nt
    v_dot2_f32_bf16 v25, v228, v4, 0
    v_dot2_f32_bf16 v25, v229, v5, v25
    v_dot2_f32_bf16 v25, v230, v6, v25
    v_dot2_f32_bf16 v25, v231, v7, v25
    s_waitcnt vmcnt(6)
    s_cbranch_vccnz L_w_259
    s_waitcnt vmcnt(4)
L_w_259:
    buffer_load_dwordx4 v[68:71], v1, s[32:35], s41 offen offset:1024 nt
    v_dot2_f32_bf16 v26, v232, v4, 0
    v_dot2_f32_bf16 v26, v233, v5, v26
    v_dot2_f32_bf16 v26, v234, v6, v26
    v_dot2_f32_bf16 v26, v235, v7, v26
    s_waitcnt vmcnt(6)
    s_cbranch_vccnz L_w_260
    s_waitcnt vmcnt(4)
L_w_260:
    buffer_load_dwordx4 v[72:75], v1, s[32:35], s41 offen offset:2048 nt
    v_dot2_f32_bf16 v27, v236, v4, 0
    v_dot2_f32_bf16 v27, v237, v5, v27
    v_dot2_f32_bf16 v27, v238, v6, v27
    v_dot2_f32_bf16 v27, v239, v7, v27
    s_waitcnt lgkmcnt(0)
    v_cmp_lt_u32 vcc, v250, v249
    ds_read_b32 v249, v15 offset:28
    s_waitcnt vmcnt(6)
    s_cbranch_vccnz L_w_261
    s_waitcnt vmcnt(4)
L_w_261:
    buffer_load_dwordx4 v[76:79], v1, s[32:35], s41 offen offset:3072 nt
    v_mov_b32 v250, 260
    ds_write_b32 v248, v250 offset:96
    v_dot2_f32_bf16 v28, v48, v4, 0
    v_dot2_f32_bf16 v28, v49, v5, v28
    v_dot2_f32_bf16 v28, v50, v6, v28
    v_dot2_f32_bf16 v28, v51, v7, v28
    s_waitcnt vmcnt(6)
    s_cbranch_vccnz L_w_262
    s_waitcnt vmcnt(4)
L_w_262:
    s_add_u32 s41, s41, s42
    buffer_load_dwordx4 v[80:83], v1, s[32:35], s41 offen offset:0 nt
    v_dot2_f32_bf16 v29, v52, v4, 0
    v_dot2_f32_bf16 v29, v53, v5, v29
    v_dot2_f32_bf16 v29, v54, v6, v29
    v_dot2_f32_bf16 v29, v55, v7, v29
    s_waitcnt vmcnt(6)
    s_cbranch_vccnz L_w_263
    s_waitcnt vmcnt(4)
L_w_263:
    buffer_load_dwordx4 v[84:87], v1, s[32:35], s41 offen offset:1024 nt
    v_dot2_f32_bf16 v30, v56, v4, 0
    v_dot2_f32_bf16 v30, v57, v5, v30
    v_dot2_f32_bf16 v30, v58, v6, v30
    v_dot2_f32_bf16 v30, v59, v7, v30
    s_waitcnt vmcnt(6)
    s_cbranch_vccnz L_w_264
    s_waitcnt vmcnt(4)
L_w_264:
    buffer_load_dwordx4 v[88:91], v1, s[32:35], s41 offen offset:2048 nt
    v_dot2_f32_bf16 v31, v60, v4, 0
    v_dot2_f32_bf16 v31, v61, v5, v31
    v_dot2_f32_bf16 v31, v62, v6, v31
    v_dot2_f32_bf16 v31, v63, v7, v31
    v_permlane16_swap_b32 v16, v24
    v_permlane16_swap_b32 v17, v25
    v_permlane16_swap_b32 v18, v26
    v_permlane16_swap_b32 v19, v27
    v_permlane16_swap_b32 v20, v28
    v_permlane16_swap_b32 v21, v29
    v_permlane16_swap_b32 v22, v30
    v_permlane16_swap_b32 v23, v31
    v_add_f32 v16, v16, v24
    v_add_f32 v17, v17, v25
    v_add_f32 v18, v18, v26
    v_add_f32 v19, v19, v27
    v_add_f32 v20, v20, v28
    v_add_f32 v21, v21, v29
    v_add_f32 v22, v22, v30
    v_add_f32 v23, v23, v31
    v_add_f32_dpp v24, v16, v16 row_ror:8 row_mask:0xf bank_mask:0x3
    v_add_f32_dpp v25, v17, v17 row_ror:8 row_mask:0xf bank_mask:0x3
    v_add_f32_dpp v26, v18, v18 row_ror:8 row_mask:0xf bank_mask:0x3
    v_add_f32_dpp v27, v19, v19 row_ror:8 row_mask:0xf bank_mask:0x3
    v_add_f32_dpp v24, v20, v20 row_ror:8 row_mask:0xf bank_mask:0xc
    v_add_f32_dpp v25, v21, v21 row_ror:8 row_mask:0xf bank_mask:0xc
    v_add_f32_dpp v26, v22, v22 row_ror:8 row_mask:0xf bank_mask:0xc
    v_add_f32_dpp v27, v23, v23 row_ror:8 row_mask:0xf bank_mask:0xc
    v_add_f32_dpp v16, v24, v24 row_shl:4 row_mask:0xf bank_mask:0x5
    v_add_f32_dpp v17, v25, v25 row_shl:4 row_mask:0xf bank_mask:0x5
    s_nop 0
    v_add_f32_dpp v16, v26, v26 row_shr:4 row_mask:0xf bank_mask:0xa
    v_add_f32_dpp v17, v27, v27 row_shr:4 row_mask:0xf bank_mask:0xa
    s_nop 0
    v_add_f32_dpp v16, v16, v16 quad_perm:[1,0,3,2] row_mask:0xf bank_mask:0xf
    v_add_f32_dpp v17, v17, v17 quad_perm:[1,0,3,2] row_mask:0xf bank_mask:0xf
    s_nop 0
    v_add_f32_dpp v16, v16, v16 quad_perm:[2,3,0,1] row_mask:0xf bank_mask:0xf
    v_add_f32_dpp v17, v17, v17 quad_perm:[2,3,0,1] row_mask:0xf bank_mask:0xf
    ds_write_b64 v12, v[16:17] offset:960
    s_waitcnt lgkmcnt(1)
    v_cmp_lt_u32 vcc, v250, v249
    ds_read_b32 v249, v15 offset:28
    v_lshl_add_u32 v14, v2, 5, s43
    s_waitcnt lgkmcnt(0)
    ds_read_b128 v[16:19], v14
    ds_read_b128 v[20:23], v14 offset:16
    s_mov_b32 s44, 0x3db8aa3b
    s_waitcnt lgkmcnt(0)
    v_cvt_pk_bf16_f32 v24, v16, v17
    v_cvt_pk_bf16_f32 v25, v18, v19
    v_cvt_pk_bf16_f32 v26, v20, v21
    v_cvt_pk_bf16_f32 v27, v22, v23
    v_lshlrev_b32 v16, 16, v24
    v_and_b32 v17, 0xffff0000, v24
    v_lshlrev_b32 v18, 16, v25
    v_and_b32 v19, 0xffff0000, v25
    v_lshlrev_b32 v20, 16, v26
    v_and_b32 v21, 0xffff0000, v26
    v_lshlrev_b32 v22, 16, v27
    v_and_b32 v23, 0xffff0000, v27
    v_max3_f32 v240, v16, v17, v18
    v_max3_f32 v241, v19, v20, v21
    v_max3_f32 v240, v240, v22, v23
    v_max_f32 v240, v240, v241
    s_waitcnt vmcnt(6)
    s_cbranch_vccnz L_w_265
    s_waitcnt vmcnt(4)
L_w_265:
    buffer_load_dwordx4 v[92:95], v1, s[32:35], s41 offen offset:3072 nt
    v_mov_b32 v250, 264
    ds_write_b32 v248, v250 offset:96
    s_nop 1
    v_max_f32_dpp v240, v240, v240 quad_perm:[1,0,3,2] row_mask:0xf bank_mask:0xf
    s_nop 1
    v_max_f32_dpp v240, v240, v240 quad_perm:[2,3,0,1] row_mask:0xf bank_mask:0xf
    s_nop 1
    v_max_f32_dpp v240, v240, v240 row_half_mirror row_mask:0xf bank_mask:0xf
    s_nop 1
    v_max_f32_dpp v240, v240, v240 row_mirror row_mask:0xf bank_mask:0xf
    s_nop 1
    v_mov_b32 v241, v240
    s_nop 1
    v_permlane16_swap_b32 v240, v241
    v_max_f32 v240, v240, v241
    v_mov_b32 v241, v240
    s_nop 1
    v_permlane32_swap_b32 v240, v241
    v_max_f32 v240, v240, v241
    v_mul_f32 v242, s44, v240
    v_fma_f32 v16, v16, s44, -v242
    v_fma_f32 v17, v17, s44, -v242
    v_fma_f32 v18, v18, s44, -v242
    v_fma_f32 v19, v19, s44, -v242
    v_fma_f32 v20, v20, s44, -v242
    v_fma_f32 v21, v21, s44, -v242
    v_fma_f32 v22, v22, s44, -v242
    v_fma_f32 v23, v23, s44, -v242
    v_exp_f32 v16, v16
    v_exp_f32 v17, v17
    v_exp_f32 v18, v18
    v_exp_f32 v19, v19
    v_exp_f32 v20, v20
    v_exp_f32 v21, v21
    v_exp_f32 v22, v22
    v_exp_f32 v23, v23
    s_waitcnt vmcnt(6)
    s_cbranch_vccnz L_w_266
    s_waitcnt vmcnt(4)
L_w_266:
    s_add_u32 s41, s41, s42
    buffer_load_dwordx4 v[96:99], v1, s[32:35], s41 offen offset:0 nt
    v_add_f32 v241, v16, v17
    v_add_f32 v242, v18, v19
    v_add_f32 v243, v20, v21
    v_add_f32 v244, v22, v23
    v_cvt_pk_bf16_f32 v16, v16, v16
    v_cvt_pk_bf16_f32 v17, v17, v17
    v_cvt_pk_bf16_f32 v18, v18, v18
    v_cvt_pk_bf16_f32 v19, v19, v19
    v_cvt_pk_bf16_f32 v20, v20, v20
    v_cvt_pk_bf16_f32 v21, v21, v21
    v_cvt_pk_bf16_f32 v22, v22, v22
    v_cvt_pk_bf16_f32 v23, v23, v23
    ds_write_b128 v14, v[16:19]
    ds_write_b128 v14, v[20:23] offset:16
    v_add_f32 v241, v241, v242
    v_add_f32 v243, v243, v244
    v_add_f32 v241, v241, v243
    s_nop 1
    v_add_f32_dpp v241, v241, v241 quad_perm:[1,0,3,2] row_mask:0xf bank_mask:0xf
    s_nop 1
    v_add_f32_dpp v241, v241, v241 quad_perm:[2,3,0,1] row_mask:0xf bank_mask:0xf
    s_nop 1
    v_add_f32_dpp v241, v241, v241 row_half_mirror row_mask:0xf bank_mask:0xf
    s_nop 1
    v_add_f32_dpp v241, v241, v241 row_mirror row_mask:0xf bank_mask:0xf
    s_nop 1
    v_mov_b32 v242, v241
    s_nop 1
    v_permlane16_swap_b32 v241, v242
    v_add_f32 v241, v241, v242
    v_mov_b32 v242, v241
    s_nop 1
    v_permlane32_swap_b32 v241, v242
    v_add_f32 v241, v241, v242
    s_lshl_b32 s45, s3, 3
    v_mov_b32 v14, s45
    v_mov_b32 v243, 1
    s_mov_b64 exec, 1
    ds_write_b64 v14, v[240:241] offset:64
    s_waitcnt lgkmcnt(0)
    ds_add_u32 v15, v243 offset:20
    s_mov_b64 exec, -1
    s_waitcnt vmcnt(6)
    s_cbranch_vccnz L_w_267
    s_waitcnt vmcnt(4)
L_w_267:
    buffer_load_dwordx4 v[100:103], v1, s[32:35], s41 offen offset:1024 nt
    s_waitcnt lgkmcnt(0)
    ds_read_b128 v[32:35], v13
    s_waitcnt lgkmcnt(0)
    v_cmp_lt_u32 vcc, v250, v249
    ds_read_b32 v249, v15 offset:28
    ds_read_b128 v[36:39], v13 offset:16
    v_and_b32 v40, v32, v8
    v_and_b32 v41, v32, v9
    v_and_b32 v42, v32, v10
    v_and_b32 v43, v32, v11
    s_nop 1
    v_mfma_f32_32x32x16_bf16 v[16:31], v[40:43], v[64:67], 0
    v_and_b32 v44, v33, v8
    v_and_b32 v45, v33, v9
    v_and_b32 v46, v33, v10
    v_and_b32 v47, v33, v11
    s_waitcnt vmcnt(6)
    s_cbranch_vccnz L_w_268
    s_waitcnt vmcnt(4)
L_w_268:
    buffer_load_dwordx4 v[104:107], v1, s[32:35], s41 offen offset:2048 nt
    v_mfma_f32_32x32x16_bf16 v[16:31], v[44:47], v[68:71], v[16:31]
    v_and_b32 v40, v34, v8
    v_and_b32 v41, v34, v9
    v_and_b32 v42, v34, v10
    v_and_b32 v43, v34, v11
    s_nop 1
    v_mfma_f32_32x32x16_bf16 v[16:31], v[40:43], v[72:75], v[16:31]
    v_and_b32 v44, v35, v8
    v_and_b32 v45, v35, v9
    v_and_b32 v46, v35, v10
    v_and_b32 v47, v35, v11
    s_waitcnt vmcnt(6)
    s_cbranch_vccnz L_w_269
    s_waitcnt vmcnt(4)
L_w_269:
    buffer_load_dwordx4 v[108:111], v1, s[32:35], s41 offen offset:3072 nt
    v_mov_b32 v250, 268
    ds_write_b32 v248, v250 offset:96
    v_mfma_f32_32x32x16_bf16 v[16:31], v[44:47], v[76:79], v[16:31]
    s_waitcnt lgkmcnt(0)
    v_cmp_lt_u32 vcc, v250, v249
    ds_read_b32 v249, v15 offset:28
    ds_read_b128 v[32:35], v13 offset:32
    v_and_b32 v40, v36, v8
    v_and_b32 v41, v36, v9
    v_and_b32 v42, v36, v10
    v_and_b32 v43, v36, v11
    s_nop 1
    v_mfma_f32_32x32x16_bf16 v[16:31], v[40:43], v[80:83], v[16:31]
    v_and_b32 v44, v37, v8
    v_and_b32 v45, v37, v9
    v_and_b32 v46, v37, v10
    v_and_b32 v47, v37, v11
    s_waitcnt vmcnt(6)
    s_cbranch_vccnz L_w_270
    s_waitcnt vmcnt(4)
L_w_270:
    s_add_u32 s41, s41, s42
    buffer_load_dwordx4 v[112:115], v1, s[32:35], s41 offen offset:0 nt
    v_mfma_f32_32x32x16_bf16 v[16:31], v[44:47], v[84:87], v[16:31]
    v_and_b32 v40, v38, v8
    v_and_b32 v41, v38, v9
    v_and_b32 v42, v38, v10
    v_and_b32 v43, v38, v11
    s_waitcnt vmcnt(6)
    s_cbranch_vccnz L_w_271
    s_waitcnt vmcnt(4)
L_w_271:
    buffer_load_dwordx4 v[116:119], v1, s[32:35], s41 offen offset:1024 nt
    v_mfma_f32_32x32x16_bf16 v[16:31], v[40:43], v[88:91], v[16:31]
    v_and_b32 v44, v39, v8
    v_and_b32 v45, v39, v9
    v_and_b32 v46, v39, v10
    v_and_b32 v47, v39, v11
    s_waitcnt vmcnt(6)
    s_cbranch_vccnz L_w_272
    s_waitcnt vmcnt(4)
L_w_272:
    buffer_load_dwordx4 v[120:123], v1, s[32:35], s41 offen offset:2048 nt
    v_mfma_f32_32x32x16_bf16 v[16:31], v[44:47], v[92:95], v[16:31]
    s_waitcnt lgkmcnt(0)
    v_cmp_lt_u32 vcc, v250, v249
    ds_read_b32 v249, v15 offset:28
    ds_read_b128 v[36:39], v13 offset:48
    v_and_b32 v40, v32, v8
    v_and_b32 v41, v32, v9
    v_and_b32 v42, v32, v10
    v_and_b32 v43, v32, v11
    s_waitcnt vmcnt(6)
    s_cbranch_vccnz L_w_273
    s_waitcnt vmcnt(4)
L_w_273:
    buffer_load_dwordx4 v[124:127], v1, s[32:35], s41 offen offset:3072 nt
    v_mov_b32 v250, 272
    ds_write_b32 v248, v250 offset:96
    v_mfma_f32_32x32x16_bf16 v[16:31], v[40:43], v[96:99], v[16:31]
    v_and_b32 v44, v33, v8
    v_and_b32 v45, v33, v9
    v_and_b32 v46, v33, v10
    v_and_b32 v47, v33, v11
    s_waitcnt vmcnt(6)
    s_cbranch_vccnz L_w_274
    s_waitcnt vmcnt(4)
L_w_274:
    s_add_u32 s41, s41, s42
    buffer_load_dwordx4 v[128:131], v1, s[32:35], s41 offen offset:0 nt
    v_mfma_f32_32x32x16_bf16 v[16:31], v[44:47], v[100:103], v[16:31]
    v_and_b32 v40, v34, v8
    v_and_b32 v41, v34, v9
    v_and_b32 v42, v34, v10
    v_and_b32 v43, v34, v11
    s_waitcnt vmcnt(6)
    s_cbranch_vccnz L_w_275
    s_waitcnt vmcnt(4)
L_w_275:
    buffer_load_dwordx4 v[132:135], v1, s[32:35], s41 offen offset:1024 nt
    v_mfma_f32_32x32x16_bf16 v[16:31], v[40:43], v[104:107], v[16:31]
    v_and_b32 v44, v35, v8
    v_and_b32 v45, v35, v9
    v_and_b32 v46, v35, v10
    v_and_b32 v47, v35, v11
    s_waitcnt vmcnt(6)
    s_cbranch_vccnz L_w_276
    s_waitcnt vmcnt(4)
L_w_276:
    buffer_load_dwordx4 v[136:139], v1, s[32:35], s41 offen offset:2048 nt
    v_mfma_f32_32x32x16_bf16 v[16:31], v[44:47], v[108:111], v[16:31]
    s_waitcnt lgkmcnt(0)
    v_cmp_lt_u32 vcc, v250, v249
    ds_read_b32 v249, v15 offset:28
    ds_read_b128 v[32:35], v13 offset:64
    v_and_b32 v40, v36, v8
    v_and_b32 v41, v36, v9
    v_and_b32 v42, v36, v10
    v_and_b32 v43, v36, v11
    s_waitcnt vmcnt(6)
    s_cbranch_vccnz L_w_277
    s_waitcnt vmcnt(4)
L_w_277:
    buffer_load_dwordx4 v[140:143], v1, s[32:35], s41 offen offset:3072 nt
    v_mov_b32 v250, 276
    ds_write_b32 v248, v250 offset:96
    v_mfma_f32_32x32x16_bf16 v[16:31], v[40:43], v[112:115], v[16:31]
    v_and_b32 v44, v37, v8
    v_and_b32 v45, v37, v9
    v_and_b32 v46, v37, v10
    v_and_b32 v47, v37, v11
    s_waitcnt vmcnt(6)
    s_cbranch_vccnz L_w_278
    s_waitcnt vmcnt(4)
L_w_278:
    s_add_u32 s41, s41, s42
    buffer_load_dwordx4 v[144:147], v1, s[32:35], s41 offen offset:0 nt
    v_mfma_f32_32x32x16_bf16 v[16:31], v[44:47], v[116:119], v[16:31]
    v_and_b32 v40, v38, v8
    v_and_b32 v41, v38, v9
    v_and_b32 v42, v38, v10
    v_and_b32 v43, v38, v11
    s_waitcnt vmcnt(6)
    s_cbranch_vccnz L_w_279
    s_waitcnt vmcnt(4)
L_w_279:
    buffer_load_dwordx4 v[148:151], v1, s[32:35], s41 offen offset:1024 nt
    v_mfma_f32_32x32x16_bf16 v[16:31], v[40:43], v[120:123], v[16:31]
    v_and_b32 v44, v39, v8
    v_and_b32 v45, v39, v9
    v_and_b32 v46, v39, v10
    v_and_b32 v47, v39, v11
    s_waitcnt vmcnt(6)
    s_cbranch_vccnz L_w_280
    s_waitcnt vmcnt(4)
L_w_280:
    buffer_load_dwordx4 v[152:155], v1, s[32:35], s41 offen offset:2048 nt
    v_mfma_f32_32x32x16_bf16 v[16:31], v[44:47], v[124:127], v[16:31]
    s_waitcnt lgkmcnt(0)
    v_cmp_lt_u32 vcc, v250, v249
    ds_read_b32 v249, v15 offset:28
    ds_read_b128 v[36:39], v13 offset:80
    v_and_b32 v40, v32, v8
    v_and_b32 v41, v32, v9
    v_and_b32 v42, v32, v10
    v_and_b32 v43, v32, v11
    s_waitcnt vmcnt(6)
    s_cbranch_vccnz L_w_281
    s_waitcnt vmcnt(4)
L_w_281:
    buffer_load_dwordx4 v[156:159], v1, s[32:35], s41 offen offset:3072 nt
    v_mov_b32 v250, 280
    ds_write_b32 v248, v250 offset:96
    v_mfma_f32_32x32x16_bf16 v[16:31], v[40:43], v[128:131], v[16:31]
    v_and_b32 v44, v33, v8
    v_and_b32 v45, v33, v9
    v_and_b32 v46, v33, v10
    v_and_b32 v47, v33, v11
    s_waitcnt vmcnt(6)
    s_cbranch_vccnz L_w_282
    s_waitcnt vmcnt(4)
L_w_282:
    s_add_u32 s41, s41, s42
    buffer_load_dwordx4 v[160:163], v1, s[32:35], s41 offen offset:0 nt
    v_mfma_f32_32x32x16_bf16 v[16:31], v[44:47], v[132:135], v[16:31]
    v_and_b32 v40, v34, v8
    v_and_b32 v41, v34, v9
    v_and_b32 v42, v34, v10
    v_and_b32 v43, v34, v11
    s_waitcnt vmcnt(6)
    s_cbranch_vccnz L_w_283
    s_waitcnt vmcnt(4)
L_w_283:
    buffer_load_dwordx4 v[164:167], v1, s[32:35], s41 offen offset:1024 nt
    v_mfma_f32_32x32x16_bf16 v[16:31], v[40:43], v[136:139], v[16:31]
    v_and_b32 v44, v35, v8
    v_and_b32 v45, v35, v9
    v_and_b32 v46, v35, v10
    v_and_b32 v47, v35, v11
    s_waitcnt vmcnt(6)
    s_cbranch_vccnz L_w_284
    s_waitcnt vmcnt(4)
L_w_284:
    buffer_load_dwordx4 v[168:171], v1, s[32:35], s41 offen offset:2048 nt
    v_mfma_f32_32x32x16_bf16 v[16:31], v[44:47], v[140:143], v[16:31]
    s_waitcnt lgkmcnt(0)
    v_cmp_lt_u32 vcc, v250, v249
    ds_read_b32 v249, v15 offset:28
    ds_read_b128 v[32:35], v13 offset:96
    v_and_b32 v40, v36, v8
    v_and_b32 v41, v36, v9
    v_and_b32 v42, v36, v10
    v_and_b32 v43, v36, v11
    s_waitcnt vmcnt(6)
    s_cbranch_vccnz L_w_285
    s_waitcnt vmcnt(4)
L_w_285:
    buffer_load_dwordx4 v[172:175], v1, s[32:35], s41 offen offset:3072 nt
    v_mov_b32 v250, 284
    ds_write_b32 v248, v250 offset:96
    v_mfma_f32_32x32x16_bf16 v[16:31], v[40:43], v[144:147], v[16:31]
    v_and_b32 v44, v37, v8
    v_and_b32 v45, v37, v9
    v_and_b32 v46, v37, v10
    v_and_b32 v47, v37, v11
    s_waitcnt vmcnt(6)
    s_cbranch_vccnz L_w_286
    s_waitcnt vmcnt(4)
L_w_286:
    s_add_u32 s41, s41, s42
    buffer_load_dwordx4 v[176:179], v1, s[32:35], s41 offen offset:0 nt
    v_mfma_f32_32x32x16_bf16 v[16:31], v[44:47], v[148:151], v[16:31]
    v_and_b32 v40, v38, v8
    v_and_b32 v41, v38, v9
    v_and_b32 v42, v38, v10
    v_and_b32 v43, v38, v11
    s_waitcnt vmcnt(6)
    s_cbranch_vccnz L_w_287
    s_waitcnt vmcnt(4)
L_w_287:
    buffer_load_dwordx4 v[180:183], v1, s[32:35], s41 offen offset:1024 nt
    v_mfma_f32_32x32x16_bf16 v[16:31], v[40:43], v[152:155], v[16:31]
    v_and_b32 v44, v39, v8
    v_and_b32 v45, v39, v9
    v_and_b32 v46, v39, v10
    v_and_b32 v47, v39, v11
    s_waitcnt vmcnt(6)
    s_cbranch_vccnz L_w_288
    s_waitcnt vmcnt(4)
L_w_288:
    buffer_load_dwordx4 v[184:187], v1, s[32:35], s41 offen offset:2048 nt
    v_mfma_f32_32x32x16_bf16 v[16:31], v[44:47], v[156:159], v[16:31]
    s_waitcnt lgkmcnt(0)
    v_cmp_lt_u32 vcc, v250, v249
    ds_read_b32 v249, v15 offset:28
    ds_read_b128 v[36:39], v13 offset:112
    v_and_b32 v40, v32, v8
    v_and_b32 v41, v32, v9
    v_and_b32 v42, v32, v10
    v_and_b32 v43, v32, v11
    s_waitcnt vmcnt(6)
    s_cbranch_vccnz L_w_289
    s_waitcnt vmcnt(4)
L_w_289:
    buffer_load_dwordx4 v[188:191], v1, s[32:35], s41 offen offset:3072 nt
    v_mov_b32 v250, 288
    ds_write_b32 v248, v250 offset:96
    v_mfma_f32_32x32x16_bf16 v[16:31], v[40:43], v[160:163], v[16:31]
    v_and_b32 v44, v33, v8
    v_and_b32 v45, v33, v9
    v_and_b32 v46, v33, v10
    v_and_b32 v47, v33, v11
    s_waitcnt vmcnt(6)
    s_cbranch_vccnz L_w_290
    s_waitcnt vmcnt(4)
L_w_290:
    s_add_u32 s41, s41, s42
    buffer_load_dwordx4 v[192:195], v1, s[32:35], s41 offen offset:0 nt
    v_mfma_f32_32x32x16_bf16 v[16:31], v[44:47], v[164:167], v[16:31]
    v_and_b32 v40, v34, v8
    v_and_b32 v41, v34, v9
    v_and_b32 v42, v34, v10
    v_and_b32 v43, v34, v11
    s_waitcnt vmcnt(6)
    s_cbranch_vccnz L_w_291
    s_waitcnt vmcnt(4)
L_w_291:
    buffer_load_dwordx4 v[196:199], v1, s[32:35], s41 offen offset:1024 nt
    v_mfma_f32_32x32x16_bf16 v[16:31], v[40:43], v[168:171], v[16:31]
    v_and_b32 v44, v35, v8
    v_and_b32 v45, v35, v9
    v_and_b32 v46, v35, v10
    v_and_b32 v47, v35, v11
    s_waitcnt vmcnt(6)
    s_cbranch_vccnz L_w_292
    s_waitcnt vmcnt(4)
L_w_292:
    buffer_load_dwordx4 v[200:203], v1, s[32:35], s41 offen offset:2048 nt
    v_mfma_f32_32x32x16_bf16 v[16:31], v[44:47], v[172:175], v[16:31]
    s_waitcnt lgkmcnt(0)
    v_cmp_lt_u32 vcc, v250, v249
    ds_read_b32 v249, v15 offset:28
    ds_read_b128 v[32:35], v13 offset:128
    v_and_b32 v40, v36, v8
    v_and_b32 v41, v36, v9
    v_and_b32 v42, v36, v10
    v_and_b32 v43, v36, v11
    s_waitcnt vmcnt(6)
    s_cbranch_vccnz L_w_293
    s_waitcnt vmcnt(4)
L_w_293:
    buffer_load_dwordx4 v[204:207], v1, s[32:35], s41 offen offset:3072 nt
    v_mov_b32 v250, 292
    ds_write_b32 v248, v250 offset:96
    v_mfma_f32_32x32x16_bf16 v[16:31], v[40:43], v[176:179], v[16:31]
    v_and_b32 v44, v37, v8
    v_and_b32 v45, v37, v9
    v_and_b32 v46, v37, v10
    v_and_b32 v47, v37, v11
    s_waitcnt vmcnt(6)
    s_cbranch_vccnz L_w_294
    s_waitcnt vmcnt(4)
L_w_294:
    s_add_u32 s41, s41, s42
    buffer_load_dwordx4 v[208:211], v1, s[32:35], s41 offen offset:0 nt
    v_mfma_f32_32x32x16_bf16 v[16:31], v[44:47], v[180:183], v[16:31]
    v_and_b32 v40, v38, v8
    v_and_b32 v41, v38, v9
    v_and_b32 v42, v38, v10
    v_and_b32 v43, v38, v11
    s_waitcnt vmcnt(6)
    s_cbranch_vccnz L_w_295
    s_waitcnt vmcnt(4)
L_w_295:
    buffer_load_dwordx4 v[212:215], v1, s[32:35], s41 offen offset:1024 nt
    v_mfma_f32_32x32x16_bf16 v[16:31], v[40:43], v[184:187], v[16:31]
    v_and_b32 v44, v39, v8
    v_and_b32 v45, v39, v9
    v_and_b32 v46, v39, v10
    v_and_b32 v47, v39, v11
    s_waitcnt vmcnt(6)
    s_cbranch_vccnz L_w_296
    s_waitcnt vmcnt(4)
L_w_296:
    buffer_load_dwordx4 v[216:219], v1, s[32:35], s41 offen offset:2048 nt
    v_mfma_f32_32x32x16_bf16 v[16:31], v[44:47], v[188:191], v[16:31]
    s_waitcnt lgkmcnt(0)
    v_cmp_lt_u32 vcc, v250, v249
    ds_read_b32 v249, v15 offset:28
    ds_read_b128 v[36:39], v13 offset:144
    v_and_b32 v40, v32, v8
    v_and_b32 v41, v32, v9
    v_and_b32 v42, v32, v10
    v_and_b32 v43, v32, v11
    s_waitcnt vmcnt(6)
    s_cbranch_vccnz L_w_297
    s_waitcnt vmcnt(4)
L_w_297:
    buffer_load_dwordx4 v[220:223], v1, s[32:35], s41 offen offset:3072 nt
    v_mov_b32 v250, 296
    ds_write_b32 v248, v250 offset:96
    v_mfma_f32_32x32x16_bf16 v[16:31], v[40:43], v[192:195], v[16:31]
    v_and_b32 v44, v33, v8
    v_and_b32 v45, v33, v9
    v_and_b32 v46, v33, v10
    v_and_b32 v47, v33, v11
    s_waitcnt vmcnt(6)
    s_cbranch_vccnz L_w_298
    s_waitcnt vmcnt(4)
L_w_298:
    s_add_u32 s41, s41, s42
    buffer_load_dwordx4 v[224:227], v1, s[32:35], s41 offen offset:0 nt
    v_mfma_f32_32x32x16_bf16 v[16:31], v[44:47], v[196:199], v[16:31]
    v_and_b32 v40, v34, v8
    v_and_b32 v41, v34, v9
    v_and_b32 v42, v34, v10
    v_and_b32 v43, v34, v11
    s_waitcnt vmcnt(6)
    s_cbranch_vccnz L_w_299
    s_waitcnt vmcnt(4)
L_w_299:
    buffer_load_dwordx4 v[228:231], v1, s[32:35], s41 offen offset:1024 nt
    v_mfma_f32_32x32x16_bf16 v[16:31], v[40:43], v[200:203], v[16:31]
    v_and_b32 v44, v35, v8
    v_and_b32 v45, v35, v9
    v_and_b32 v46, v35, v10
    v_and_b32 v47, v35, v11
    s_waitcnt vmcnt(6)
    s_cbranch_vccnz L_w_300
    s_waitcnt vmcnt(4)
L_w_300:
    buffer_load_dwordx4 v[232:235], v1, s[32:35], s41 offen offset:2048 nt
    v_mfma_f32_32x32x16_bf16 v[16:31], v[44:47], v[204:207], v[16:31]
    s_waitcnt lgkmcnt(0)
    v_cmp_lt_u32 vcc, v250, v249
    ds_read_b32 v249, v15 offset:28
    ds_read_b128 v[32:35], v13 offset:160
    v_and_b32 v40, v36, v8
    v_and_b32 v41, v36, v9
    v_and_b32 v42, v36, v10
    v_and_b32 v43, v36, v11
    s_waitcnt vmcnt(6)
    s_cbranch_vccnz L_w_301
    s_waitcnt vmcnt(4)
L_w_301:
    buffer_load_dwordx4 v[236:239], v1, s[32:35], s41 offen offset:3072 nt
    v_mov_b32 v250, 300
    ds_write_b32 v248, v250 offset:96
    v_mfma_f32_32x32x16_bf16 v[16:31], v[40:43], v[208:211], v[16:31]
    v_and_b32 v44, v37, v8
    v_and_b32 v45, v37, v9
    v_and_b32 v46, v37, v10
    v_and_b32 v47, v37, v11
    s_waitcnt vmcnt(6)
    s_cbranch_vccnz L_w_302
    s_waitcnt vmcnt(4)
L_w_302:
    s_add_u32 s41, s41, s42
    buffer_load_dwordx4 v[48:51], v1, s[32:35], s41 offen offset:0 nt
    v_mfma_f32_32x32x16_bf16 v[16:31], v[44:47], v[212:215], v[16:31]
    v_and_b32 v40, v38, v8
    v_and_b32 v41, v38, v9
    v_and_b32 v42, v38, v10
    v_and_b32 v43, v38, v11
    s_waitcnt vmcnt(6)
    s_cbranch_vccnz L_w_303
    s_waitcnt vmcnt(4)
L_w_303:
    buffer_load_dwordx4 v[52:55], v1, s[32:35], s41 offen offset:1024 nt
    v_mfma_f32_32x32x16_bf16 v[16:31], v[40:43], v[216:219], v[16:31]
    v_and_b32 v44, v39, v8
    v_and_b32 v45, v39, v9
    v_and_b32 v46, v39, v10
    v_and_b32 v47, v39, v11
    s_waitcnt vmcnt(6)
    s_cbranch_vccnz L_w_304
    s_waitcnt vmcnt(4)
L_w_304:
    buffer_load_dwordx4 v[56:59], v1, s[32:35], s41 offen offset:2048 nt
    v_mfma_f32_32x32x16_bf16 v[16:31], v[44:47], v[220:223], v[16:31]
    s_waitcnt lgkmcnt(0)
    v_cmp_lt_u32 vcc, v250, v249
    ds_read_b32 v249, v15 offset:28
    ds_read_b128 v[36:39], v13 offset:176
    v_and_b32 v40, v32, v8
    v_and_b32 v41, v32, v9
    v_and_b32 v42, v32, v10
    v_and_b32 v43, v32, v11
    s_waitcnt vmcnt(6)
    s_cbranch_vccnz L_w_305
    s_waitcnt vmcnt(4)
L_w_305:
    buffer_load_dwordx4 v[60:63], v1, s[32:35], s41 offen offset:3072 nt
    v_mov_b32 v250, 304
    ds_write_b32 v248, v250 offset:96
    v_mfma_f32_32x32x16_bf16 v[16:31], v[40:43], v[224:227], v[16:31]
    v_and_b32 v44, v33, v8
    v_and_b32 v45, v33, v9
    v_and_b32 v46, v33, v10
    v_and_b32 v47, v33, v11
    s_waitcnt vmcnt(6)
    s_cbranch_vccnz L_w_306
    s_waitcnt vmcnt(4)
L_w_306:
    s_add_u32 s41, s41, s42
    buffer_load_dwordx4 v[64:67], v1, s[32:35], s41 offen offset:0 nt
    v_mfma_f32_32x32x16_bf16 v[16:31], v[44:47], v[228:231], v[16:31]
    v_and_b32 v40, v34, v8
    v_and_b32 v41, v34, v9
    v_and_b32 v42, v34, v10
    v_and_b32 v43, v34, v11
    s_waitcnt vmcnt(6)
    s_cbranch_vccnz L_w_307
    s_waitcnt vmcnt(4)
L_w_307:
    buffer_load_dwordx4 v[68:71], v1, s[32:35], s41 offen offset:1024 nt
    v_mfma_f32_32x32x16_bf16 v[16:31], v[40:43], v[232:235], v[16:31]
    v_and_b32 v44, v35, v8
    v_and_b32 v45, v35, v9
    v_and_b32 v46, v35, v10
    v_and_b32 v47, v35, v11
    s_waitcnt vmcnt(6)
    s_cbranch_vccnz L_w_308
    s_waitcnt vmcnt(4)
L_w_308:
    buffer_load_dwordx4 v[72:75], v1, s[32:35], s41 offen offset:2048 nt
    v_mfma_f32_32x32x16_bf16 v[16:31], v[44:47], v[236:239], v[16:31]
    s_waitcnt lgkmcnt(0)
    v_cmp_lt_u32 vcc, v250, v249
    ds_read_b32 v249, v15 offset:28
    ds_read_b128 v[32:35], v13 offset:192
    v_and_b32 v40, v36, v8
    v_and_b32 v41, v36, v9
    v_and_b32 v42, v36, v10
    v_and_b32 v43, v36, v11
    s_waitcnt vmcnt(6)
    s_cbranch_vccnz L_w_309
    s_waitcnt vmcnt(4)
L_w_309:
    buffer_load_dwordx4 v[76:79], v1, s[32:35], s41 offen offset:3072 nt
    v_mov_b32 v250, 308
    ds_write_b32 v248, v250 offset:96
    v_mfma_f32_32x32x16_bf16 v[16:31], v[40:43], v[48:51], v[16:31]
    v_and_b32 v44, v37, v8
    v_and_b32 v45, v37, v9
    v_and_b32 v46, v37, v10
    v_and_b32 v47, v37, v11
    s_waitcnt vmcnt(6)
    s_cbranch_vccnz L_w_310
    s_waitcnt vmcnt(4)
L_w_310:
    s_add_u32 s41, s41, s42
    buffer_load_dwordx4 v[80:83], v1, s[32:35], s41 offen offset:0 nt
    v_mfma_f32_32x32x16_bf16 v[16:31], v[44:47], v[52:55], v[16:31]
    v_and_b32 v40, v38, v8
    v_and_b32 v41, v38, v9
    v_and_b32 v42, v38, v10
    v_and_b32 v43, v38, v11
    s_waitcnt vmcnt(6)
    s_cbranch_vccnz L_w_311
    s_waitcnt vmcnt(4)
L_w_311:
    buffer_load_dwordx4 v[84:87], v1, s[32:35], s41 offen offset:1024 nt
    v_mfma_f32_32x32x16_bf16 v[16:31], v[40:43], v[56:59], v[16:31]
    v_and_b32 v44, v39, v8
    v_and_b32 v45, v39, v9
    v_and_b32 v46, v39, v10
    v_and_b32 v47, v39, v11
    s_waitcnt vmcnt(6)
    s_cbranch_vccnz L_w_312
    s_waitcnt vmcnt(4)
L_w_312:
    buffer_load_dwordx4 v[88:91], v1, s[32:35], s41 offen offset:2048 nt
    v_mfma_f32_32x32x16_bf16 v[16:31], v[44:47], v[60:63], v[16:31]
    s_waitcnt lgkmcnt(0)
    v_cmp_lt_u32 vcc, v250, v249
    ds_read_b32 v249, v15 offset:28
    ds_read_b128 v[36:39], v13 offset:208
    v_and_b32 v40, v32, v8
    v_and_b32 v41, v32, v9
    v_and_b32 v42, v32, v10
    v_and_b32 v43, v32, v11
    s_waitcnt vmcnt(6)
    s_cbranch_vccnz L_w_313
    s_waitcnt vmcnt(4)
L_w_313:
    buffer_load_dwordx4 v[92:95], v1, s[32:35], s41 offen offset:3072 nt
    v_mov_b32 v250, 312
    ds_write_b32 v248, v250 offset:96
    v_mfma_f32_32x32x16_bf16 v[16:31], v[40:43], v[64:67], v[16:31]
    v_and_b32 v44, v33, v8
    v_and_b32 v45, v33, v9
    v_and_b32 v46, v33, v10
    v_and_b32 v47, v33, v11
    s_waitcnt vmcnt(6)
    s_cbranch_vccnz L_w_314
    s_waitcnt vmcnt(4)
L_w_314:
    s_add_u32 s41, s41, s42
    buffer_load_dwordx4 v[96:99], v1, s[32:35], s41 offen offset:0 nt
    v_mfma_f32_32x32x16_bf16 v[16:31], v[44:47], v[68:71], v[16:31]
    v_and_b32 v40, v34, v8
    v_and_b32 v41, v34, v9
    v_and_b32 v42, v34, v10
    v_and_b32 v43, v34, v11
    s_waitcnt vmcnt(6)
    s_cbranch_vccnz L_w_315
    s_waitcnt vmcnt(4)
L_w_315:
    buffer_load_dwordx4 v[100:103], v1, s[32:35], s41 offen offset:1024 nt
    v_mfma_f32_32x32x16_bf16 v[16:31], v[40:43], v[72:75], v[16:31]
    v_and_b32 v44, v35, v8
    v_and_b32 v45, v35, v9
    v_and_b32 v46, v35, v10
    v_and_b32 v47, v35, v11
    s_waitcnt vmcnt(6)
    s_cbranch_vccnz L_w_316
    s_waitcnt vmcnt(4)
L_w_316:
    buffer_load_dwordx4 v[104:107], v1, s[32:35], s41 offen offset:2048 nt
    v_mfma_f32_32x32x16_bf16 v[16:31], v[44:47], v[76:79], v[16:31]
    s_waitcnt lgkmcnt(0)
    v_cmp_lt_u32 vcc, v250, v249
    ds_read_b32 v249, v15 offset:28
    ds_read_b128 v[32:35], v13 offset:224
    v_and_b32 v40, v36, v8
    v_and_b32 v41, v36, v9
    v_and_b32 v42, v36, v10
    v_and_b32 v43, v36, v11
    s_waitcnt vmcnt(6)
    s_cbranch_vccnz L_w_317
    s_waitcnt vmcnt(4)
L_w_317:
    buffer_load_dwordx4 v[108:111], v1, s[32:35], s41 offen offset:3072 nt
    v_mov_b32 v250, 316
    ds_write_b32 v248, v250 offset:96
    v_mfma_f32_32x32x16_bf16 v[16:31], v[40:43], v[80:83], v[16:31]
    v_and_b32 v44, v37, v8
    v_and_b32 v45, v37, v9
    v_and_b32 v46, v37, v10
    v_and_b32 v47, v37, v11
    s_waitcnt vmcnt(6)
    s_cbranch_vccnz L_w_318
    s_waitcnt vmcnt(4)
L_w_318:
    s_add_u32 s41, s41, s42
    buffer_load_dwordx4 v[112:115], v1, s[32:35], s41 offen offset:0 nt
    v_mfma_f32_32x32x16_bf16 v[16:31], v[44:47], v[84:87], v[16:31]
    v_and_b32 v40, v38, v8
    v_and_b32 v41, v38, v9
    v_and_b32 v42, v38, v10
    v_and_b32 v43, v38, v11
    s_waitcnt vmcnt(6)
    s_cbranch_vccnz L_w_319
    s_waitcnt vmcnt(4)
L_w_319:
    buffer_load_dwordx4 v[116:119], v1, s[32:35], s41 offen offset:1024 nt
    v_mfma_f32_32x32x16_bf16 v[16:31], v[40:43], v[88:91], v[16:31]
    v_and_b32 v44, v39, v8
    v_and_b32 v45, v39, v9
    v_and_b32 v46, v39, v10
    v_and_b32 v47, v39, v11
    s_waitcnt vmcnt(6)
    s_cbranch_vccnz L_w_320
    s_waitcnt vmcnt(4)
L_w_320:
    buffer_load_dwordx4 v[120:123], v1, s[32:35], s41 offen offset:2048 nt
    v_mfma_f32_32x32x16_bf16 v[16:31], v[44:47], v[92:95], v[16:31]
    s_waitcnt lgkmcnt(0)
    v_cmp_lt_u32 vcc, v250, v249
    ds_read_b32 v249, v15 offset:28
    ds_read_b128 v[36:39], v13 offset:240
    v_and_b32 v40, v32, v8
    v_and_b32 v41, v32, v9
    v_and_b32 v42, v32, v10
    v_and_b32 v43, v32, v11
    s_waitcnt vmcnt(6)
    s_cbranch_vccnz L_w_321
    s_waitcnt vmcnt(4)
L_w_321:
    buffer_load_dwordx4 v[124:127], v1, s[32:35], s41 offen offset:3072 nt
    v_mov_b32 v250, 320
    ds_write_b32 v248, v250 offset:96
    v_mfma_f32_32x32x16_bf16 v[16:31], v[40:43], v[96:99], v[16:31]
    v_and_b32 v44, v33, v8
    v_and_b32 v45, v33, v9
    v_and_b32 v46, v33, v10
    v_and_b32 v47, v33, v11
    s_waitcnt vmcnt(6)
    s_cbranch_vccnz L_w_322
    s_waitcnt vmcnt(4)
L_w_322:
    s_add_u32 s41, s41, s42
    buffer_load_dwordx4 v[128:131], v1, s[32:35], s41 offen offset:0 nt
    v_mfma_f32_32x32x16_bf16 v[16:31], v[44:47], v[100:103], v[16:31]
    v_and_b32 v40, v34, v8
    v_and_b32 v41, v34, v9
    v_and_b32 v42, v34, v10
    v_and_b32 v43, v34, v11
    s_waitcnt vmcnt(6)
    s_cbranch_vccnz L_w_323
    s_waitcnt vmcnt(4)
L_w_323:
    buffer_load_dwordx4 v[132:135], v1, s[32:35], s41 offen offset:1024 nt
    v_mfma_f32_32x32x16_bf16 v[16:31], v[40:43], v[104:107], v[16:31]
    v_and_b32 v44, v35, v8
    v_and_b32 v45, v35, v9
    v_and_b32 v46, v35, v10
    v_and_b32 v47, v35, v11
    s_waitcnt vmcnt(6)
    s_cbranch_vccnz L_w_324
    s_waitcnt vmcnt(4)
L_w_324:
    buffer_load_dwordx4 v[136:139], v1, s[32:35], s41 offen offset:2048 nt
    v_mfma_f32_32x32x16_bf16 v[16:31], v[44:47], v[108:111], v[16:31]
    s_waitcnt lgkmcnt(0)
    v_cmp_lt_u32 vcc, v250, v249
    ds_read_b32 v249, v15 offset:28
    ds_read_b128 v[32:35], v13 offset:256
    v_and_b32 v40, v36, v8
    v_and_b32 v41, v36, v9
    v_and_b32 v42, v36, v10
    v_and_b32 v43, v36, v11
    s_waitcnt vmcnt(6)
    s_cbranch_vccnz L_w_325
    s_waitcnt vmcnt(4)
L_w_325:
    buffer_load_dwordx4 v[140:143], v1, s[32:35], s41 offen offset:3072 nt
    v_mov_b32 v250, 324
    ds_write_b32 v248, v250 offset:96
    v_mfma_f32_32x32x16_bf16 v[16:31], v[40:43], v[112:115], v[16:31]
    v_and_b32 v44, v37, v8
    v_and_b32 v45, v37, v9
    v_and_b32 v46, v37, v10
    v_and_b32 v47, v37, v11
    s_waitcnt vmcnt(6)
    s_cbranch_vccnz L_w_326
    s_waitcnt vmcnt(4)
L_w_326:
    s_add_u32 s41, s41, s42
    buffer_load_dwordx4 v[144:147], v1, s[32:35], s41 offen offset:0 nt
    v_mfma_f32_32x32x16_bf16 v[16:31], v[44:47], v[116:119], v[16:31]
    v_and_b32 v40, v38, v8
    v_and_b32 v41, v38, v9
    v_and_b32 v42, v38, v10
    v_and_b32 v43, v38, v11
    s_waitcnt vmcnt(6)
    s_cbranch_vccnz L_w_327
    s_waitcnt vmcnt(4)
L_w_327:
    buffer_load_dwordx4 v[148:151], v1, s[32:35], s41 offen offset:1024 nt
    v_mfma_f32_32x32x16_bf16 v[16:31], v[40:43], v[120:123], v[16:31]
    v_and_b32 v44, v39, v8
    v_and_b32 v45, v39, v9
    v_and_b32 v46, v39, v10
    v_and_b32 v47, v39, v11
    s_waitcnt vmcnt(6)
    s_cbranch_vccnz L_w_328
    s_waitcnt vmcnt(4)
L_w_328:
    buffer_load_dwordx4 v[152:155], v1, s[32:35], s41 offen offset:2048 nt
    v_mfma_f32_32x32x16_bf16 v[16:31], v[44:47], v[124:127], v[16:31]
    s_waitcnt lgkmcnt(0)
    v_cmp_lt_u32 vcc, v250, v249
    ds_read_b32 v249, v15 offset:28
    ds_read_b128 v[36:39], v13 offset:272
    v_and_b32 v40, v32, v8
    v_and_b32 v41, v32, v9
    v_and_b32 v42, v32, v10
    v_and_b32 v43, v32, v11
    s_waitcnt vmcnt(6)
    s_cbranch_vccnz L_w_329
    s_waitcnt vmcnt(4)
L_w_329:
    buffer_load_dwordx4 v[156:159], v1, s[32:35], s41 offen offset:3072 nt
    v_mov_b32 v250, 328
    ds_write_b32 v248, v250 offset:96
    v_mfma_f32_32x32x16_bf16 v[16:31], v[40:43], v[128:131], v[16:31]
    v_and_b32 v44, v33, v8
    v_and_b32 v45, v33, v9
    v_and_b32 v46, v33, v10
    v_and_b32 v47, v33, v11
    s_waitcnt vmcnt(6)
    s_cbranch_vccnz L_w_330
    s_waitcnt vmcnt(4)
L_w_330:
    s_add_u32 s41, s41, s42
    buffer_load_dwordx4 v[160:163], v1, s[32:35], s41 offen offset:0 nt
    v_mfma_f32_32x32x16_bf16 v[16:31], v[44:47], v[132:135], v[16:31]
    v_and_b32 v40, v34, v8
    v_and_b32 v41, v34, v9
    v_and_b32 v42, v34, v10
    v_and_b32 v43, v34, v11
    s_waitcnt vmcnt(6)
    s_cbranch_vccnz L_w_331
    s_waitcnt vmcnt(4)
L_w_331:
    buffer_load_dwordx4 v[164:167], v1, s[32:35], s41 offen offset:1024 nt
    v_mfma_f32_32x32x16_bf16 v[16:31], v[40:43], v[136:139], v[16:31]
    v_and_b32 v44, v35, v8
    v_and_b32 v45, v35, v9
    v_and_b32 v46, v35, v10
    v_and_b32 v47, v35, v11
    s_waitcnt vmcnt(6)
    s_cbranch_vccnz L_w_332
    s_waitcnt vmcnt(4)
L_w_332:
    buffer_load_dwordx4 v[168:171], v1, s[32:35], s41 offen offset:2048 nt
    v_mfma_f32_32x32x16_bf16 v[16:31], v[44:47], v[140:143], v[16:31]
    s_waitcnt lgkmcnt(0)
    v_cmp_lt_u32 vcc, v250, v249
    ds_read_b32 v249, v15 offset:28
    ds_read_b128 v[32:35], v13 offset:288
    v_and_b32 v40, v36, v8
    v_and_b32 v41, v36, v9
    v_and_b32 v42, v36, v10
    v_and_b32 v43, v36, v11
    s_waitcnt vmcnt(6)
    s_cbranch_vccnz L_w_333
    s_waitcnt vmcnt(4)
L_w_333:
    buffer_load_dwordx4 v[172:175], v1, s[32:35], s41 offen offset:3072 nt
    v_mov_b32 v250, 332
    ds_write_b32 v248, v250 offset:96
    v_mfma_f32_32x32x16_bf16 v[16:31], v[40:43], v[144:147], v[16:31]
    v_and_b32 v44, v37, v8
    v_and_b32 v45, v37, v9
    v_and_b32 v46, v37, v10
    v_and_b32 v47, v37, v11
    s_waitcnt vmcnt(6)
    s_cbranch_vccnz L_w_334
    s_waitcnt vmcnt(4)
L_w_334:
    s_add_u32 s41, s41, s42
    buffer_load_dwordx4 v[176:179], v1, s[32:35], s41 offen offset:0 nt
    v_mfma_f32_32x32x16_bf16 v[16:31], v[44:47], v[148:151], v[16:31]
    v_and_b32 v40, v38, v8
    v_and_b32 v41, v38, v9
    v_and_b32 v42, v38, v10
    v_and_b32 v43, v38, v11
    s_waitcnt vmcnt(6)
    s_cbranch_vccnz L_w_335
    s_waitcnt vmcnt(4)
L_w_335:
    buffer_load_dwordx4 v[180:183], v1, s[32:35], s41 offen offset:1024 nt
    v_mfma_f32_32x32x16_bf16 v[16:31], v[40:43], v[152:155], v[16:31]
    v_and_b32 v44, v39, v8
    v_and_b32 v45, v39, v9
    v_and_b32 v46, v39, v10
    v_and_b32 v47, v39, v11
    s_waitcnt vmcnt(6)
    s_cbranch_vccnz L_w_336
    s_waitcnt vmcnt(4)
L_w_336:
    buffer_load_dwordx4 v[184:187], v1, s[32:35], s41 offen offset:2048 nt
    v_mfma_f32_32x32x16_bf16 v[16:31], v[44:47], v[156:159], v[16:31]
    s_waitcnt lgkmcnt(0)
    v_cmp_lt_u32 vcc, v250, v249
    ds_read_b32 v249, v15 offset:28
    ds_read_b128 v[36:39], v13 offset:304
    v_and_b32 v40, v32, v8
    v_and_b32 v41, v32, v9
    v_and_b32 v42, v32, v10
    v_and_b32 v43, v32, v11
    s_waitcnt vmcnt(6)
    s_cbranch_vccnz L_w_337
    s_waitcnt vmcnt(4)
L_w_337:
    buffer_load_dwordx4 v[188:191], v1, s[32:35], s41 offen offset:3072 nt
    v_mov_b32 v250, 336
    ds_write_b32 v248, v250 offset:96
    v_mfma_f32_32x32x16_bf16 v[16:31], v[40:43], v[160:163], v[16:31]
    v_and_b32 v44, v33, v8
    v_and_b32 v45, v33, v9
    v_and_b32 v46, v33, v10
    v_and_b32 v47, v33, v11
    s_waitcnt vmcnt(6)
    s_cbranch_vccnz L_w_338
    s_waitcnt vmcnt(4)
L_w_338:
    s_add_u32 s41, s41, s42
    buffer_load_dwordx4 v[192:195], v1, s[32:35], s41 offen offset:0 nt
    v_mfma_f32_32x32x16_bf16 v[16:31], v[44:47], v[164:167], v[16:31]
    v_and_b32 v40, v34, v8
    v_and_b32 v41, v34, v9
    v_and_b32 v42, v34, v10
    v_and_b32 v43, v34, v11
    s_waitcnt vmcnt(6)
    s_cbranch_vccnz L_w_339
    s_waitcnt vmcnt(4)
L_w_339:
    buffer_load_dwordx4 v[196:199], v1, s[32:35], s41 offen offset:1024 nt
    v_mfma_f32_32x32x16_bf16 v[16:31], v[40:43], v[168:171], v[16:31]
    v_and_b32 v44, v35, v8
    v_and_b32 v45, v35, v9
    v_and_b32 v46, v35, v10
    v_and_b32 v47, v35, v11
    s_waitcnt vmcnt(6)
    s_cbranch_vccnz L_w_340
    s_waitcnt vmcnt(4)
L_w_340:
    buffer_load_dwordx4 v[200:203], v1, s[32:35], s41 offen offset:2048 nt
    v_mfma_f32_32x32x16_bf16 v[16:31], v[44:47], v[172:175], v[16:31]
    s_waitcnt lgkmcnt(0)
    v_cmp_lt_u32 vcc, v250, v249
    ds_read_b32 v249, v15 offset:28
    ds_read_b128 v[32:35], v13 offset:320
    v_and_b32 v40, v36, v8
    v_and_b32 v41, v36, v9
    v_and_b32 v42, v36, v10
    v_and_b32 v43, v36, v11
    s_waitcnt vmcnt(6)
    s_cbranch_vccnz L_w_341
    s_waitcnt vmcnt(4)
L_w_341:
    buffer_load_dwordx4 v[204:207], v1, s[32:35], s41 offen offset:3072 nt
    v_mov_b32 v250, 340
    ds_write_b32 v248, v250 offset:96
    v_mfma_f32_32x32x16_bf16 v[16:31], v[40:43], v[176:179], v[16:31]
    v_and_b32 v44, v37, v8
    v_and_b32 v45, v37, v9
    v_and_b32 v46, v37, v10
    v_and_b32 v47, v37, v11
    s_waitcnt vmcnt(6)
    s_cbranch_vccnz L_w_342
    s_waitcnt vmcnt(4)
L_w_342:
    s_add_u32 s41, s41, s42
    buffer_load_dwordx4 v[208:211], v1, s[32:35], s41 offen offset:0 nt
    v_mfma_f32_32x32x16_bf16 v[16:31], v[44:47], v[180:183], v[16:31]
    v_and_b32 v40, v38, v8
    v_and_b32 v41, v38, v9
    v_and_b32 v42, v38, v10
    v_and_b32 v43, v38, v11
    s_waitcnt vmcnt(6)
    s_cbranch_vccnz L_w_343
    s_waitcnt vmcnt(4)
L_w_343:
    buffer_load_dwordx4 v[212:215], v1, s[32:35], s41 offen offset:1024 nt
    v_mfma_f32_32x32x16_bf16 v[16:31], v[40:43], v[184:187], v[16:31]
    v_and_b32 v44, v39, v8
    v_and_b32 v45, v39, v9
    v_and_b32 v46, v39, v10
    v_and_b32 v47, v39, v11
    s_waitcnt vmcnt(6)
    s_cbranch_vccnz L_w_344
    s_waitcnt vmcnt(4)
L_w_344:
    buffer_load_dwordx4 v[216:219], v1, s[32:35], s41 offen offset:2048 nt
    v_mfma_f32_32x32x16_bf16 v[16:31], v[44:47], v[188:191], v[16:31]
    s_waitcnt lgkmcnt(0)
    v_cmp_lt_u32 vcc, v250, v249
    ds_read_b32 v249, v15 offset:28
    ds_read_b128 v[36:39], v13 offset:336
    v_and_b32 v40, v32, v8
    v_and_b32 v41, v32, v9
    v_and_b32 v42, v32, v10
    v_and_b32 v43, v32, v11
    s_waitcnt vmcnt(6)
    s_cbranch_vccnz L_w_345
    s_waitcnt vmcnt(4)
L_w_345:
    buffer_load_dwordx4 v[220:223], v1, s[32:35], s41 offen offset:3072 nt
    v_mov_b32 v250, 344
    ds_write_b32 v248, v250 offset:96
    v_mfma_f32_32x32x16_bf16 v[16:31], v[40:43], v[192:195], v[16:31]
    v_and_b32 v44, v33, v8
    v_and_b32 v45, v33, v9
    v_and_b32 v46, v33, v10
    v_and_b32 v47, v33, v11
    s_waitcnt vmcnt(6)
    s_cbranch_vccnz L_w_346
    s_waitcnt vmcnt(4)
L_w_346:
    s_add_u32 s41, s41, s42
    buffer_load_dwordx4 v[224:227], v1, s[32:35], s41 offen offset:0 nt
    v_mfma_f32_32x32x16_bf16 v[16:31], v[44:47], v[196:199], v[16:31]
    v_and_b32 v40, v34, v8
    v_and_b32 v41, v34, v9
    v_and_b32 v42, v34, v10
    v_and_b32 v43, v34, v11
    s_waitcnt vmcnt(6)
    s_cbranch_vccnz L_w_347
    s_waitcnt vmcnt(4)
L_w_347:
    buffer_load_dwordx4 v[228:231], v1, s[32:35], s41 offen offset:1024 nt
    v_mfma_f32_32x32x16_bf16 v[16:31], v[40:43], v[200:203], v[16:31]
    v_and_b32 v44, v35, v8
    v_and_b32 v45, v35, v9
    v_and_b32 v46, v35, v10
    v_and_b32 v47, v35, v11
    s_waitcnt vmcnt(6)
    s_cbranch_vccnz L_w_348
    s_waitcnt vmcnt(4)
L_w_348:
    buffer_load_dwordx4 v[232:235], v1, s[32:35], s41 offen offset:2048 nt
    v_mfma_f32_32x32x16_bf16 v[16:31], v[44:47], v[204:207], v[16:31]
    s_waitcnt lgkmcnt(0)
    v_cmp_lt_u32 vcc, v250, v249
    ds_read_b32 v249, v15 offset:28
    ds_read_b128 v[32:35], v13 offset:352
    v_and_b32 v40, v36, v8
    v_and_b32 v41, v36, v9
    v_and_b32 v42, v36, v10
    v_and_b32 v43, v36, v11
    s_waitcnt vmcnt(6)
    s_cbranch_vccnz L_w_349
    s_waitcnt vmcnt(4)
L_w_349:
    buffer_load_dwordx4 v[236:239], v1, s[32:35], s41 offen offset:3072 nt
    v_mov_b32 v250, 348
    ds_write_b32 v248, v250 offset:96
    v_mfma_f32_32x32x16_bf16 v[16:31], v[40:43], v[208:211], v[16:31]
    v_and_b32 v44, v37, v8
    v_and_b32 v45, v37, v9
    v_and_b32 v46, v37, v10
    v_and_b32 v47, v37, v11
    s_waitcnt vmcnt(6)
    s_cbranch_vccnz L_w_350
    s_waitcnt vmcnt(4)
L_w_350:
    s_add_u32 s41, s41, s42
    buffer_load_dwordx4 v[48:51], v1, s[32:35], s41 offen offset:0 nt
    v_mfma_f32_32x32x16_bf16 v[16:31], v[44:47], v[212:215], v[16:31]
    v_and_b32 v40, v38, v8
    v_and_b32 v41, v38, v9
    v_and_b32 v42, v38, v10
    v_and_b32 v43, v38, v11
    s_waitcnt vmcnt(6)
    s_cbranch_vccnz L_w_351
    s_waitcnt vmcnt(4)
L_w_351:
    buffer_load_dwordx4 v[52:55], v1, s[32:35], s41 offen offset:1024 nt
    v_mfma_f32_32x32x16_bf16 v[16:31], v[40:43], v[216:219], v[16:31]
    v_and_b32 v44, v39, v8
    v_and_b32 v45, v39, v9
    v_and_b32 v46, v39, v10
    v_and_b32 v47, v39, v11
    s_waitcnt vmcnt(6)
    s_cbranch_vccnz L_w_352
    s_waitcnt vmcnt(4)
L_w_352:
    buffer_load_dwordx4 v[56:59], v1, s[32:35], s41 offen offset:2048 nt
    v_mfma_f32_32x32x16_bf16 v[16:31], v[44:47], v[220:223], v[16:31]
    s_waitcnt lgkmcnt(0)
    v_cmp_lt_u32 vcc, v250, v249
    ds_read_b32 v249, v15 offset:28
    ds_read_b128 v[36:39], v13 offset:368
    v_and_b32 v40, v32, v8
    v_and_b32 v41, v32, v9
    v_and_b32 v42, v32, v10
    v_and_b32 v43, v32, v11
    s_waitcnt vmcnt(6)
    s_cbranch_vccnz L_w_353
    s_waitcnt vmcnt(4)
L_w_353:
    buffer_load_dwordx4 v[60:63], v1, s[32:35], s41 offen offset:3072 nt
    v_mov_b32 v250, 352
    ds_write_b32 v248, v250 offset:96
    v_mfma_f32_32x32x16_bf16 v[16:31], v[40:43], v[224:227], v[16:31]
    v_and_b32 v44, v33, v8
    v_and_b32 v45, v33, v9
    v_and_b32 v46, v33, v10
    v_and_b32 v47, v33, v11
    s_waitcnt vmcnt(6)
    s_cbranch_vccnz L_w_354
    s_waitcnt vmcnt(4)
L_w_354:
    s_add_u32 s41, s41, s42
    buffer_load_dwordx4 v[64:67], v1, s[32:35], s41 offen offset:0 nt
    v_mfma_f32_32x32x16_bf16 v[16:31], v[44:47], v[228:231], v[16:31]
    v_and_b32 v40, v34, v8
    v_and_b32 v41, v34, v9
    v_and_b32 v42, v34, v10
    v_and_b32 v43, v34, v11
    s_waitcnt vmcnt(6)
    s_cbranch_vccnz L_w_355
    s_waitcnt vmcnt(4)
L_w_355:
    buffer_load_dwordx4 v[68:71], v1, s[32:35], s41 offen offset:1024 nt
    v_mfma_f32_32x32x16_bf16 v[16:31], v[40:43], v[232:235], v[16:31]
    v_and_b32 v44, v35, v8
    v_and_b32 v45, v35, v9
    v_and_b32 v46, v35, v10
    v_and_b32 v47, v35, v11
    s_waitcnt vmcnt(6)
    s_cbranch_vccnz L_w_356
    s_waitcnt vmcnt(4)
L_w_356:
    buffer_load_dwordx4 v[72:75], v1, s[32:35], s41 offen offset:2048 nt
    v_mfma_f32_32x32x16_bf16 v[16:31], v[44:47], v[236:239], v[16:31]
    s_waitcnt lgkmcnt(0)
    v_cmp_lt_u32 vcc, v250, v249
    ds_read_b32 v249, v15 offset:28
    ds_read_b128 v[32:35], v13 offset:384
    v_and_b32 v40, v36, v8
    v_and_b32 v41, v36, v9
    v_and_b32 v42, v36, v10
    v_and_b32 v43, v36, v11
    s_waitcnt vmcnt(6)
    s_cbranch_vccnz L_w_357
    s_waitcnt vmcnt(4)
L_w_357:
    buffer_load_dwordx4 v[76:79], v1, s[32:35], s41 offen offset:3072 nt
    v_mov_b32 v250, 356
    ds_write_b32 v248, v250 offset:96
    v_mfma_f32_32x32x16_bf16 v[16:31], v[40:43], v[48:51], v[16:31]
    v_and_b32 v44, v37, v8
    v_and_b32 v45, v37, v9
    v_and_b32 v46, v37, v10
    v_and_b32 v47, v37, v11
    s_waitcnt vmcnt(6)
    s_cbranch_vccnz L_w_358
    s_waitcnt vmcnt(4)
L_w_358:
    s_add_u32 s41, s41, s42
    buffer_load_dwordx4 v[80:83], v1, s[32:35], s41 offen offset:0 nt
    v_mfma_f32_32x32x16_bf16 v[16:31], v[44:47], v[52:55], v[16:31]
    v_and_b32 v40, v38, v8
    v_and_b32 v41, v38, v9
    v_and_b32 v42, v38, v10
    v_and_b32 v43, v38, v11
    s_waitcnt vmcnt(6)
    s_cbranch_vccnz L_w_359
    s_waitcnt vmcnt(4)
L_w_359:
    buffer_load_dwordx4 v[84:87], v1, s[32:35], s41 offen offset:1024 nt
    v_mfma_f32_32x32x16_bf16 v[16:31], v[40:43], v[56:59], v[16:31]
    v_and_b32 v44, v39, v8
    v_and_b32 v45, v39, v9
    v_and_b32 v46, v39, v10
    v_and_b32 v47, v39, v11
    s_waitcnt vmcnt(6)
    s_cbranch_vccnz L_w_360
    s_waitcnt vmcnt(4)
L_w_360:
    buffer_load_dwordx4 v[88:91], v1, s[32:35], s41 offen offset:2048 nt
    v_mfma_f32_32x32x16_bf16 v[16:31], v[44:47], v[60:63], v[16:31]
    s_waitcnt lgkmcnt(0)
    v_cmp_lt_u32 vcc, v250, v249
    ds_read_b32 v249, v15 offset:28
    ds_read_b128 v[36:39], v13 offset:400
    v_and_b32 v40, v32, v8
    v_and_b32 v41, v32, v9
    v_and_b32 v42, v32, v10
    v_and_b32 v43, v32, v11
    s_waitcnt vmcnt(6)
    s_cbranch_vccnz L_w_361
    s_waitcnt vmcnt(4)
L_w_361:
    buffer_load_dwordx4 v[92:95], v1, s[32:35], s41 offen offset:3072 nt
    v_mov_b32 v250, 360
    ds_write_b32 v248, v250 offset:96
    v_mfma_f32_32x32x16_bf16 v[16:31], v[40:43], v[64:67], v[16:31]
    v_and_b32 v44, v33, v8
    v_and_b32 v45, v33, v9
    v_and_b32 v46, v33, v10
    v_and_b32 v47, v33, v11
    s_waitcnt vmcnt(6)
    s_cbranch_vccnz L_w_362
    s_waitcnt vmcnt(4)
L_w_362:
    s_add_u32 s41, s41, s42
    buffer_load_dwordx4 v[96:99], v1, s[32:35], s41 offen offset:0 nt
    v_mfma_f32_32x32x16_bf16 v[16:31], v[44:47], v[68:71], v[16:31]
    v_and_b32 v40, v34, v8
    v_and_b32 v41, v34, v9
    v_and_b32 v42, v34, v10
    v_and_b32 v43, v34, v11
    s_waitcnt vmcnt(6)
    s_cbranch_vccnz L_w_363
    s_waitcnt vmcnt(4)
L_w_363:
    buffer_load_dwordx4 v[100:103], v1, s[32:35], s41 offen offset:1024 nt
    v_mfma_f32_32x32x16_bf16 v[16:31], v[40:43], v[72:75], v[16:31]
    v_and_b32 v44, v35, v8
    v_and_b32 v45, v35, v9
    v_and_b32 v46, v35, v10
    v_and_b32 v47, v35, v11
    s_waitcnt vmcnt(6)
    s_cbranch_vccnz L_w_364
    s_waitcnt vmcnt(4)
L_w_364:
    buffer_load_dwordx4 v[104:107], v1, s[32:35], s41 offen offset:2048 nt
    v_mfma_f32_32x32x16_bf16 v[16:31], v[44:47], v[76:79], v[16:31]
    s_waitcnt lgkmcnt(0)
    v_cmp_lt_u32 vcc, v250, v249
    ds_read_b32 v249, v15 offset:28
    ds_read_b128 v[32:35], v13 offset:416
    v_and_b32 v40, v36, v8
    v_and_b32 v41, v36, v9
    v_and_b32 v42, v36, v10
    v_and_b32 v43, v36, v11
    s_waitcnt vmcnt(6)
    s_cbranch_vccnz L_w_365
    s_waitcnt vmcnt(4)
L_w_365:
    buffer_load_dwordx4 v[108:111], v1, s[32:35], s41 offen offset:3072 nt
    v_mov_b32 v250, 364
    ds_write_b32 v248, v250 offset:96
    v_mfma_f32_32x32x16_bf16 v[16:31], v[40:43], v[80:83], v[16:31]
    v_and_b32 v44, v37, v8
    v_and_b32 v45, v37, v9
    v_and_b32 v46, v37, v10
    v_and_b32 v47, v37, v11
    s_waitcnt vmcnt(6)
    s_cbranch_vccnz L_w_366
    s_waitcnt vmcnt(4)
L_w_366:
    s_add_u32 s41, s41, s42
    buffer_load_dwordx4 v[112:115], v1, s[32:35], s41 offen offset:0 nt
    v_mfma_f32_32x32x16_bf16 v[16:31], v[44:47], v[84:87], v[16:31]
    v_and_b32 v40, v38, v8
    v_and_b32 v41, v38, v9
    v_and_b32 v42, v38, v10
    v_and_b32 v43, v38, v11
    s_waitcnt vmcnt(6)
    s_cbranch_vccnz L_w_367
    s_waitcnt vmcnt(4)
L_w_367:
    buffer_load_dwordx4 v[116:119], v1, s[32:35], s41 offen offset:1024 nt
    v_mfma_f32_32x32x16_bf16 v[16:31], v[40:43], v[88:91], v[16:31]
    v_and_b32 v44, v39, v8
    v_and_b32 v45, v39, v9
    v_and_b32 v46, v39, v10
    v_and_b32 v47, v39, v11
    s_waitcnt vmcnt(6)
    s_cbranch_vccnz L_w_368
    s_waitcnt vmcnt(4)
L_w_368:
    buffer_load_dwordx4 v[120:123], v1, s[32:35], s41 offen offset:2048 nt
    v_mfma_f32_32x32x16_bf16 v[16:31], v[44:47], v[92:95], v[16:31]
    s_waitcnt lgkmcnt(0)
    v_cmp_lt_u32 vcc, v250, v249
    ds_read_b32 v249, v15 offset:28
    ds_read_b128 v[36:39], v13 offset:432
    v_and_b32 v40, v32, v8
    v_and_b32 v41, v32, v9
    v_and_b32 v42, v32, v10
    v_and_b32 v43, v32, v11
    s_waitcnt vmcnt(6)
    s_cbranch_vccnz L_w_369
    s_waitcnt vmcnt(4)
L_w_369:
    buffer_load_dwordx4 v[124:127], v1, s[32:35], s41 offen offset:3072 nt
    v_mov_b32 v250, 368
    ds_write_b32 v248, v250 offset:96
    v_mfma_f32_32x32x16_bf16 v[16:31], v[40:43], v[96:99], v[16:31]
    v_and_b32 v44, v33, v8
    v_and_b32 v45, v33, v9
    v_and_b32 v46, v33, v10
    v_and_b32 v47, v33, v11
    s_waitcnt vmcnt(6)
    s_cbranch_vccnz L_w_370
    s_waitcnt vmcnt(4)
L_w_370:
    s_add_u32 s41, s41, s42
    buffer_load_dwordx4 v[128:131], v1, s[32:35], s41 offen offset:0 nt
    v_mfma_f32_32x32x16_bf16 v[16:31], v[44:47], v[100:103], v[16:31]
    v_and_b32 v40, v34, v8
    v_and_b32 v41, v34, v9
    v_and_b32 v42, v34, v10
    v_and_b32 v43, v34, v11
    s_waitcnt vmcnt(6)
    s_cbranch_vccnz L_w_371
    s_waitcnt vmcnt(4)
L_w_371:
    buffer_load_dwordx4 v[132:135], v1, s[32:35], s41 offen offset:1024 nt
    v_mfma_f32_32x32x16_bf16 v[16:31], v[40:43], v[104:107], v[16:31]
    v_and_b32 v44, v35, v8
    v_and_b32 v45, v35, v9
    v_and_b32 v46, v35, v10
    v_and_b32 v47, v35, v11
    s_waitcnt vmcnt(6)
    s_cbranch_vccnz L_w_372
    s_waitcnt vmcnt(4)
L_w_372:
    buffer_load_dwordx4 v[136:139], v1, s[32:35], s41 offen offset:2048 nt
    v_mfma_f32_32x32x16_bf16 v[16:31], v[44:47], v[108:111], v[16:31]
    s_waitcnt lgkmcnt(0)
    v_cmp_lt_u32 vcc, v250, v249
    ds_read_b32 v249, v15 offset:28
    ds_read_b128 v[32:35], v13 offset:448
    v_and_b32 v40, v36, v8
    v_and_b32 v41, v36, v9
    v_and_b32 v42, v36, v10
    v_and_b32 v43, v36, v11
    s_waitcnt vmcnt(6)
    s_cbranch_vccnz L_w_373
    s_waitcnt vmcnt(4)
L_w_373:
    buffer_load_dwordx4 v[140:143], v1, s[32:35], s41 offen offset:3072 nt
    v_mov_b32 v250, 372
    ds_write_b32 v248, v250 offset:96
    v_mfma_f32_32x32x16_bf16 v[16:31], v[40:43], v[112:115], v[16:31]
    v_and_b32 v44, v37, v8
    v_and_b32 v45, v37, v9
    v_and_b32 v46, v37, v10
    v_and_b32 v47, v37, v11
    s_waitcnt vmcnt(6)
    s_cbranch_vccnz L_w_374
    s_waitcnt vmcnt(4)
L_w_374:
    s_add_u32 s41, s41, s42
    buffer_load_dwordx4 v[144:147], v1, s[32:35], s41 offen offset:0 nt
    v_mfma_f32_32x32x16_bf16 v[16:31], v[44:47], v[116:119], v[16:31]
    v_and_b32 v40, v38, v8
    v_and_b32 v41, v38, v9
    v_and_b32 v42, v38, v10
    v_and_b32 v43, v38, v11
    s_waitcnt vmcnt(6)
    s_cbranch_vccnz L_w_375
    s_waitcnt vmcnt(4)
L_w_375:
    buffer_load_dwordx4 v[148:151], v1, s[32:35], s41 offen offset:1024 nt
    v_mfma_f32_32x32x16_bf16 v[16:31], v[40:43], v[120:123], v[16:31]
    v_and_b32 v44, v39, v8
    v_and_b32 v45, v39, v9
    v_and_b32 v46, v39, v10
    v_and_b32 v47, v39, v11
    s_waitcnt vmcnt(6)
    s_cbranch_vccnz L_w_376
    s_waitcnt vmcnt(4)
L_w_376:
    buffer_load_dwordx4 v[152:155], v1, s[32:35], s41 offen offset:2048 nt
    v_mfma_f32_32x32x16_bf16 v[16:31], v[44:47], v[124:127], v[16:31]
    s_waitcnt lgkmcnt(0)
    v_cmp_lt_u32 vcc, v250, v249
    ds_read_b32 v249, v15 offset:28
    ds_read_b128 v[36:39], v13 offset:464
    v_and_b32 v40, v32, v8
    v_and_b32 v41, v32, v9
    v_and_b32 v42, v32, v10
    v_and_b32 v43, v32, v11
    s_waitcnt vmcnt(6)
    s_cbranch_vccnz L_w_377
    s_waitcnt vmcnt(4)
L_w_377:
    buffer_load_dwordx4 v[156:159], v1, s[32:35], s41 offen offset:3072 nt
    v_mov_b32 v250, 376
    ds_write_b32 v248, v250 offset:96
    v_mfma_f32_32x32x16_bf16 v[16:31], v[40:43], v[128:131], v[16:31]
    v_and_b32 v44, v33, v8
    v_and_b32 v45, v33, v9
    v_and_b32 v46, v33, v10
    v_and_b32 v47, v33, v11
    s_waitcnt vmcnt(6)
    s_cbranch_vccnz L_w_378
    s_waitcnt vmcnt(4)
L_w_378:
    s_add_u32 s41, s41, s42
    buffer_load_dwordx4 v[160:163], v1, s[32:35], s41 offen offset:0 nt
    v_mfma_f32_32x32x16_bf16 v[16:31], v[44:47], v[132:135], v[16:31]
    v_and_b32 v40, v34, v8
    v_and_b32 v41, v34, v9
    v_and_b32 v42, v34, v10
    v_and_b32 v43, v34, v11
    s_waitcnt vmcnt(6)
    s_cbranch_vccnz L_w_379
    s_waitcnt vmcnt(4)
L_w_379:
    buffer_load_dwordx4 v[164:167], v1, s[32:35], s41 offen offset:1024 nt
    v_mfma_f32_32x32x16_bf16 v[16:31], v[40:43], v[136:139], v[16:31]
    v_and_b32 v44, v35, v8
    v_and_b32 v45, v35, v9
    v_and_b32 v46, v35, v10
    v_and_b32 v47, v35, v11
    s_waitcnt vmcnt(6)
    s_cbranch_vccnz L_w_380
    s_waitcnt vmcnt(4)
L_w_380:
    buffer_load_dwordx4 v[168:171], v1, s[32:35], s41 offen offset:2048 nt
    v_mfma_f32_32x32x16_bf16 v[16:31], v[44:47], v[140:143], v[16:31]
    s_waitcnt lgkmcnt(0)
    v_cmp_lt_u32 vcc, v250, v249
    ds_read_b32 v249, v15 offset:28
    ds_read_b128 v[32:35], v13 offset:480
    v_and_b32 v40, v36, v8
    v_and_b32 v41, v36, v9
    v_and_b32 v42, v36, v10
    v_and_b32 v43, v36, v11
    s_waitcnt vmcnt(6)
    s_cbranch_vccnz L_w_381
    s_waitcnt vmcnt(4)
L_w_381:
    buffer_load_dwordx4 v[172:175], v1, s[32:35], s41 offen offset:3072 nt
    v_mov_b32 v250, 380
    ds_write_b32 v248, v250 offset:96
    v_mfma_f32_32x32x16_bf16 v[16:31], v[40:43], v[144:147], v[16:31]
    v_and_b32 v44, v37, v8
    v_and_b32 v45, v37, v9
    v_and_b32 v46, v37, v10
    v_and_b32 v47, v37, v11
    s_waitcnt vmcnt(6)
    s_cbranch_vccnz L_w_382
    s_waitcnt vmcnt(4)
L_w_382:
    s_add_u32 s41, s41, s42
    buffer_load_dwordx4 v[176:179], v1, s[32:35], s41 offen offset:0 nt
    v_mfma_f32_32x32x16_bf16 v[16:31], v[44:47], v[148:151], v[16:31]
    v_and_b32 v40, v38, v8
    v_and_b32 v41, v38, v9
    v_and_b32 v42, v38, v10
    v_and_b32 v43, v38, v11
    s_waitcnt vmcnt(6)
    s_cbranch_vccnz L_w_383
    s_waitcnt vmcnt(4)
L_w_383:
    buffer_load_dwordx4 v[180:183], v1, s[32:35], s41 offen offset:1024 nt
    v_mfma_f32_32x32x16_bf16 v[16:31], v[40:43], v[152:155], v[16:31]
    v_and_b32 v44, v39, v8
    v_and_b32 v45, v39, v9
    v_and_b32 v46, v39, v10
    v_and_b32 v47, v39, v11
    s_waitcnt vmcnt(6)
    s_cbranch_vccnz L_w_384
    s_waitcnt vmcnt(4)
L_w_384:
    buffer_load_dwordx4 v[184:187], v1, s[32:35], s41 offen offset:2048 nt
    v_mfma_f32_32x32x16_bf16 v[16:31], v[44:47], v[156:159], v[16:31]
    s_waitcnt lgkmcnt(0)
    v_cmp_lt_u32 vcc, v250, v249
    ds_read_b32 v249, v15 offset:28
    ds_read_b128 v[36:39], v13 offset:496
    v_and_b32 v40, v32, v8
    v_and_b32 v41, v32, v9
    v_and_b32 v42, v32, v10
    v_and_b32 v43, v32, v11
    s_waitcnt vmcnt(6)
    s_cbranch_vccnz L_w_385
    s_waitcnt vmcnt(4)
L_w_385:
    buffer_load_dwordx4 v[188:191], v1, s[32:35], s41 offen offset:3072 nt
    v_mov_b32 v250, 384
    ds_write_b32 v248, v250 offset:96
    v_mfma_f32_32x32x16_bf16 v[16:31], v[40:43], v[160:163], v[16:31]
    v_and_b32 v44, v33, v8
    v_and_b32 v45, v33, v9
    v_and_b32 v46, v33, v10
    v_and_b32 v47, v33, v11
    s_waitcnt vmcnt(6)
    s_cbranch_vccnz L_w_386
    s_waitcnt vmcnt(4)
L_w_386:
    s_add_u32 s41, s41, s42
    buffer_load_dwordx4 v[192:195], v1, s[32:35], s41 offen offset:0 nt
    v_mfma_f32_32x32x16_bf16 v[16:31], v[44:47], v[164:167], v[16:31]
    v_and_b32 v40, v34, v8
    v_and_b32 v41, v34, v9
    v_and_b32 v42, v34, v10
    v_and_b32 v43, v34, v11
    s_waitcnt vmcnt(6)
    s_cbranch_vccnz L_w_387
    s_waitcnt vmcnt(4)
L_w_387:
    buffer_load_dwordx4 v[196:199], v1, s[32:35], s41 offen offset:1024 nt
    v_mfma_f32_32x32x16_bf16 v[16:31], v[40:43], v[168:171], v[16:31]
    v_and_b32 v44, v35, v8
    v_and_b32 v45, v35, v9
    v_and_b32 v46, v35, v10
    v_and_b32 v47, v35, v11
    s_waitcnt vmcnt(6)
    s_cbranch_vccnz L_w_388
    s_waitcnt vmcnt(4)
L_w_388:
    buffer_load_dwordx4 v[200:203], v1, s[32:35], s41 offen offset:2048 nt
    v_mfma_f32_32x32x16_bf16 v[16:31], v[44:47], v[172:175], v[16:31]
    s_waitcnt lgkmcnt(0)
    v_cmp_lt_u32 vcc, v250, v249
    ds_read_b32 v249, v15 offset:28
    ds_read_b128 v[32:35], v13 offset:512
    v_and_b32 v40, v36, v8
    v_and_b32 v41, v36, v9
    v_and_b32 v42, v36, v10
    v_and_b32 v43, v36, v11
    s_waitcnt vmcnt(6)
    s_cbranch_vccnz L_w_389
    s_waitcnt vmcnt(4)
L_w_389:
    buffer_load_dwordx4 v[204:207], v1, s[32:35], s41 offen offset:3072 nt
    v_mov_b32 v250, 388
    ds_write_b32 v248, v250 offset:96
    v_mfma_f32_32x32x16_bf16 v[16:31], v[40:43], v[176:179], v[16:31]
    v_and_b32 v44, v37, v8
    v_and_b32 v45, v37, v9
    v_and_b32 v46, v37, v10
    v_and_b32 v47, v37, v11
    s_waitcnt vmcnt(6)
    s_cbranch_vccnz L_w_390
    s_waitcnt vmcnt(4)
L_w_390:
    s_add_u32 s41, s41, s42
    buffer_load_dwordx4 v[208:211], v1, s[32:35], s41 offen offset:0 nt
    v_mfma_f32_32x32x16_bf16 v[16:31], v[44:47], v[180:183], v[16:31]
    v_and_b32 v40, v38, v8
    v_and_b32 v41, v38, v9
    v_and_b32 v42, v38, v10
    v_and_b32 v43, v38, v11
    s_waitcnt vmcnt(6)
    s_cbranch_vccnz L_w_391
    s_waitcnt vmcnt(4)
L_w_391:
    buffer_load_dwordx4 v[212:215], v1, s[32:35], s41 offen offset:1024 nt
    v_mfma_f32_32x32x16_bf16 v[16:31], v[40:43], v[184:187], v[16:31]
    v_and_b32 v44, v39, v8
    v_and_b32 v45, v39, v9
    v_and_b32 v46, v39, v10
    v_and_b32 v47, v39, v11
    s_waitcnt vmcnt(6)
    s_cbranch_vccnz L_w_392
    s_waitcnt vmcnt(4)
L_w_392:
    buffer_load_dwordx4 v[216:219], v1, s[32:35], s41 offen offset:2048 nt
    v_mfma_f32_32x32x16_bf16 v[16:31], v[44:47], v[188:191], v[16:31]
    s_waitcnt lgkmcnt(0)
    v_cmp_lt_u32 vcc, v250, v249
    ds_read_b32 v249, v15 offset:28
    ds_read_b128 v[36:39], v13 offset:528
    v_and_b32 v40, v32, v8
    v_and_b32 v41, v32, v9
    v_and_b32 v42, v32, v10
    v_and_b32 v43, v32, v11
    s_waitcnt vmcnt(6)
    s_cbranch_vccnz L_w_393
    s_waitcnt vmcnt(4)
L_w_393:
    buffer_load_dwordx4 v[220:223], v1, s[32:35], s41 offen offset:3072 nt
    v_mov_b32 v250, 392
    ds_write_b32 v248, v250 offset:96
    v_mfma_f32_32x32x16_bf16 v[16:31], v[40:43], v[192:195], v[16:31]
    v_and_b32 v44, v33, v8
    v_and_b32 v45, v33, v9
    v_and_b32 v46, v33, v10
    v_and_b32 v47, v33, v11
    s_waitcnt vmcnt(6)
    s_cbranch_vccnz L_w_394
    s_waitcnt vmcnt(4)
L_w_394:
    s_add_u32 s41, s41, s42
    buffer_load_dwordx4 v[224:227], v1, s[32:35], s41 offen offset:0 nt
    v_mfma_f32_32x32x16_bf16 v[16:31], v[44:47], v[196:199], v[16:31]
    v_and_b32 v40, v34, v8
    v_and_b32 v41, v34, v9
    v_and_b32 v42, v34, v10
    v_and_b32 v43, v34, v11
    s_waitcnt vmcnt(6)
    s_cbranch_vccnz L_w_395
    s_waitcnt vmcnt(4)
L_w_395:
    buffer_load_dwordx4 v[228:231], v1, s[32:35], s41 offen offset:1024 nt
    v_mfma_f32_32x32x16_bf16 v[16:31], v[40:43], v[200:203], v[16:31]
    v_and_b32 v44, v35, v8
    v_and_b32 v45, v35, v9
    v_and_b32 v46, v35, v10
    v_and_b32 v47, v35, v11
    s_waitcnt vmcnt(6)
    s_cbranch_vccnz L_w_396
    s_waitcnt vmcnt(4)
L_w_396:
    buffer_load_dwordx4 v[232:235], v1, s[32:35], s41 offen offset:2048 nt
    v_mfma_f32_32x32x16_bf16 v[16:31], v[44:47], v[204:207], v[16:31]
    s_waitcnt lgkmcnt(0)
    v_cmp_lt_u32 vcc, v250, v249
    ds_read_b32 v249, v15 offset:28
    ds_read_b128 v[32:35], v13 offset:544
    v_and_b32 v40, v36, v8
    v_and_b32 v41, v36, v9
    v_and_b32 v42, v36, v10
    v_and_b32 v43, v36, v11
    s_waitcnt vmcnt(6)
    s_cbranch_vccnz L_w_397
    s_waitcnt vmcnt(4)
L_w_397:
    buffer_load_dwordx4 v[236:239], v1, s[32:35], s41 offen offset:3072 nt
    v_mov_b32 v250, 396
    ds_write_b32 v248, v250 offset:96
    v_mfma_f32_32x32x16_bf16 v[16:31], v[40:43], v[208:211], v[16:31]
    v_and_b32 v44, v37, v8
    v_and_b32 v45, v37, v9
    v_and_b32 v46, v37, v10
    v_and_b32 v47, v37, v11
    s_waitcnt vmcnt(6)
    s_cbranch_vccnz L_w_398
    s_waitcnt vmcnt(4)
L_w_398:
    s_add_u32 s41, s41, s42
    buffer_load_dwordx4 v[48:51], v1, s[32:35], s41 offen offset:0 nt
    v_mfma_f32_32x32x16_bf16 v[16:31], v[44:47], v[212:215], v[16:31]
    v_and_b32 v40, v38, v8
    v_and_b32 v41, v38, v9
    v_and_b32 v42, v38, v10
    v_and_b32 v43, v38, v11
    s_waitcnt vmcnt(6)
    s_cbranch_vccnz L_w_399
    s_waitcnt vmcnt(4)
L_w_399:
    buffer_load_dwordx4 v[52:55], v1, s[32:35], s41 offen offset:1024 nt
    v_mfma_f32_32x32x16_bf16 v[16:31], v[40:43], v[216:219], v[16:31]
    v_and_b32 v44, v39, v8
    v_and_b32 v45, v39, v9
    v_and_b32 v46, v39, v10
    v_and_b32 v47, v39, v11
    s_waitcnt vmcnt(6)
    s_cbranch_vccnz L_w_400
    s_waitcnt vmcnt(4)
L_w_400:
    buffer_load_dwordx4 v[56:59], v1, s[32:35], s41 offen offset:2048 nt
    v_mfma_f32_32x32x16_bf16 v[16:31], v[44:47], v[220:223], v[16:31]
    s_waitcnt lgkmcnt(0)
    v_cmp_lt_u32 vcc, v250, v249
    ds_read_b32 v249, v15 offset:28
    ds_read_b128 v[36:39], v13 offset:560
    v_and_b32 v40, v32, v8
    v_and_b32 v41, v32, v9
    v_and_b32 v42, v32, v10
    v_and_b32 v43, v32, v11
    s_waitcnt vmcnt(6)
    s_cbranch_vccnz L_w_401
    s_waitcnt vmcnt(4)
L_w_401:
    buffer_load_dwordx4 v[60:63], v1, s[32:35], s41 offen offset:3072 nt
    v_mov_b32 v250, 400
    ds_write_b32 v248, v250 offset:96
    v_mfma_f32_32x32x16_bf16 v[16:31], v[40:43], v[224:227], v[16:31]
    v_and_b32 v44, v33, v8
    v_and_b32 v45, v33, v9
    v_and_b32 v46, v33, v10
    v_and_b32 v47, v33, v11
    s_waitcnt vmcnt(6)
    s_cbranch_vccnz L_w_402
    s_waitcnt vmcnt(4)
L_w_402:
    s_add_u32 s41, s41, s42
    buffer_load_dwordx4 v[64:67], v1, s[32:35], s41 offen offset:0 nt
    v_mfma_f32_32x32x16_bf16 v[16:31], v[44:47], v[228:231], v[16:31]
    v_and_b32 v40, v34, v8
    v_and_b32 v41, v34, v9
    v_and_b32 v42, v34, v10
    v_and_b32 v43, v34, v11
    s_waitcnt vmcnt(6)
    s_cbranch_vccnz L_w_403
    s_waitcnt vmcnt(4)
L_w_403:
    buffer_load_dwordx4 v[68:71], v1, s[32:35], s41 offen offset:1024 nt
    v_mfma_f32_32x32x16_bf16 v[16:31], v[40:43], v[232:235], v[16:31]
    v_and_b32 v44, v35, v8
    v_and_b32 v45, v35, v9
    v_and_b32 v46, v35, v10
    v_and_b32 v47, v35, v11
    s_waitcnt vmcnt(6)
    s_cbranch_vccnz L_w_404
    s_waitcnt vmcnt(4)
L_w_404:
    buffer_load_dwordx4 v[72:75], v1, s[32:35], s41 offen offset:2048 nt
    v_mfma_f32_32x32x16_bf16 v[16:31], v[44:47], v[236:239], v[16:31]
    s_waitcnt lgkmcnt(0)
    v_cmp_lt_u32 vcc, v250, v249
    ds_read_b32 v249, v15 offset:28
    ds_read_b128 v[32:35], v13 offset:576
    v_and_b32 v40, v36, v8
    v_and_b32 v41, v36, v9
    v_and_b32 v42, v36, v10
    v_and_b32 v43, v36, v11
    s_waitcnt vmcnt(6)
    s_cbranch_vccnz L_w_405
    s_waitcnt vmcnt(4)
L_w_405:
    buffer_load_dwordx4 v[76:79], v1, s[32:35], s41 offen offset:3072 nt
    v_mov_b32 v250, 404
    ds_write_b32 v248, v250 offset:96
    v_mfma_f32_32x32x16_bf16 v[16:31], v[40:43], v[48:51], v[16:31]
    v_and_b32 v44, v37, v8
    v_and_b32 v45, v37, v9
    v_and_b32 v46, v37, v10
    v_and_b32 v47, v37, v11
    s_waitcnt vmcnt(6)
    s_cbranch_vccnz L_w_406
    s_waitcnt vmcnt(4)
L_w_406:
    s_add_u32 s41, s41, s42
    buffer_load_dwordx4 v[80:83], v1, s[32:35], s41 offen offset:0 nt
    v_mfma_f32_32x32x16_bf16 v[16:31], v[44:47], v[52:55], v[16:31]
    v_and_b32 v40, v38, v8
    v_and_b32 v41, v38, v9
    v_and_b32 v42, v38, v10
    v_and_b32 v43, v38, v11
    s_waitcnt vmcnt(6)
    s_cbranch_vccnz L_w_407
    s_waitcnt vmcnt(4)
L_w_407:
    buffer_load_dwordx4 v[84:87], v1, s[32:35], s41 offen offset:1024 nt
    v_mfma_f32_32x32x16_bf16 v[16:31], v[40:43], v[56:59], v[16:31]
    v_and_b32 v44, v39, v8
    v_and_b32 v45, v39, v9
    v_and_b32 v46, v39, v10
    v_and_b32 v47, v39, v11
    s_waitcnt vmcnt(6)
    s_cbranch_vccnz L_w_408
    s_waitcnt vmcnt(4)
L_w_408:
    buffer_load_dwordx4 v[88:91], v1, s[32:35], s41 offen offset:2048 nt
    v_mfma_f32_32x32x16_bf16 v[16:31], v[44:47], v[60:63], v[16:31]
    s_waitcnt lgkmcnt(0)
    v_cmp_lt_u32 vcc, v250, v249
    ds_read_b32 v249, v15 offset:28
    ds_read_b128 v[36:39], v13 offset:592
    v_and_b32 v40, v32, v8
    v_and_b32 v41, v32, v9
    v_and_b32 v42, v32, v10
    v_and_b32 v43, v32, v11
    s_waitcnt vmcnt(6)
    s_cbranch_vccnz L_w_409
    s_waitcnt vmcnt(4)
L_w_409:
    buffer_load_dwordx4 v[92:95], v1, s[32:35], s41 offen offset:3072 nt
    v_mov_b32 v250, 408
    ds_write_b32 v248, v250 offset:96
    v_mfma_f32_32x32x16_bf16 v[16:31], v[40:43], v[64:67], v[16:31]
    v_and_b32 v44, v33, v8
    v_and_b32 v45, v33, v9
    v_and_b32 v46, v33, v10
    v_and_b32 v47, v33, v11
    s_waitcnt vmcnt(6)
    s_cbranch_vccnz L_w_410
    s_waitcnt vmcnt(4)
L_w_410:
    s_add_u32 s41, s41, s42
    buffer_load_dwordx4 v[96:99], v1, s[32:35], s41 offen offset:0 nt
    v_mfma_f32_32x32x16_bf16 v[16:31], v[44:47], v[68:71], v[16:31]
    v_and_b32 v40, v34, v8
    v_and_b32 v41, v34, v9
    v_and_b32 v42, v34, v10
    v_and_b32 v43, v34, v11
    s_waitcnt vmcnt(6)
    s_cbranch_vccnz L_w_411
    s_waitcnt vmcnt(4)
L_w_411:
    buffer_load_dwordx4 v[100:103], v1, s[32:35], s41 offen offset:1024 nt
    v_mfma_f32_32x32x16_bf16 v[16:31], v[40:43], v[72:75], v[16:31]
    v_and_b32 v44, v35, v8
    v_and_b32 v45, v35, v9
    v_and_b32 v46, v35, v10
    v_and_b32 v47, v35, v11
    s_waitcnt vmcnt(6)
    s_cbranch_vccnz L_w_412
    s_waitcnt vmcnt(4)
L_w_412:
    buffer_load_dwordx4 v[104:107], v1, s[32:35], s41 offen offset:2048 nt
    v_mfma_f32_32x32x16_bf16 v[16:31], v[44:47], v[76:79], v[16:31]
    s_waitcnt lgkmcnt(0)
    v_cmp_lt_u32 vcc, v250, v249
    ds_read_b32 v249, v15 offset:28
    ds_read_b128 v[32:35], v13 offset:608
    v_and_b32 v40, v36, v8
    v_and_b32 v41, v36, v9
    v_and_b32 v42, v36, v10
    v_and_b32 v43, v36, v11
    s_waitcnt vmcnt(6)
    s_cbranch_vccnz L_w_413
    s_waitcnt vmcnt(4)
L_w_413:
    buffer_load_dwordx4 v[108:111], v1, s[32:35], s41 offen offset:3072 nt
    v_mov_b32 v250, 412
    ds_write_b32 v248, v250 offset:96
    v_mfma_f32_32x32x16_bf16 v[16:31], v[40:43], v[80:83], v[16:31]
    v_and_b32 v44, v37, v8
    v_and_b32 v45, v37, v9
    v_and_b32 v46, v37, v10
    v_and_b32 v47, v37, v11
    s_waitcnt vmcnt(6)
    s_cbranch_vccnz L_w_414
    s_waitcnt vmcnt(4)
L_w_414:
    s_add_u32 s41, s41, s42
    buffer_load_dwordx4 v[112:115], v1, s[32:35], s41 offen offset:0 nt
    v_mfma_f32_32x32x16_bf16 v[16:31], v[44:47], v[84:87], v[16:31]
    v_and_b32 v40, v38, v8
    v_and_b32 v41, v38, v9
    v_and_b32 v42, v38, v10
    v_and_b32 v43, v38, v11
    s_waitcnt vmcnt(6)
    s_cbranch_vccnz L_w_415
    s_waitcnt vmcnt(4)
L_w_415:
    buffer_load_dwordx4 v[116:119], v1, s[32:35], s41 offen offset:1024 nt
    v_mfma_f32_32x32x16_bf16 v[16:31], v[40:43], v[88:91], v[16:31]
    v_and_b32 v44, v39, v8
    v_and_b32 v45, v39, v9
    v_and_b32 v46, v39, v10
    v_and_b32 v47, v39, v11
    s_waitcnt vmcnt(6)
    s_cbranch_vccnz L_w_416
    s_waitcnt vmcnt(4)
L_w_416:
    buffer_load_dwordx4 v[120:123], v1, s[32:35], s41 offen offset:2048 nt
    v_mfma_f32_32x32x16_bf16 v[16:31], v[44:47], v[92:95], v[16:31]
    s_waitcnt lgkmcnt(0)
    v_cmp_lt_u32 vcc, v250, v249
    ds_read_b32 v249, v15 offset:28
    ds_read_b128 v[36:39], v13 offset:624
    v_and_b32 v40, v32, v8
    v_and_b32 v41, v32, v9
    v_and_b32 v42, v32, v10
    v_and_b32 v43, v32, v11
    s_waitcnt vmcnt(6)
    s_cbranch_vccnz L_w_417
    s_waitcnt vmcnt(4)
L_w_417:
    buffer_load_dwordx4 v[124:127], v1, s[32:35], s41 offen offset:3072 nt
    v_mov_b32 v250, 416
    ds_write_b32 v248, v250 offset:96
    v_mfma_f32_32x32x16_bf16 v[16:31], v[40:43], v[96:99], v[16:31]
    v_and_b32 v44, v33, v8
    v_and_b32 v45, v33, v9
    v_and_b32 v46, v33, v10
    v_and_b32 v47, v33, v11
    s_waitcnt vmcnt(6)
    s_cbranch_vccnz L_w_418
    s_waitcnt vmcnt(4)
L_w_418:
    s_add_u32 s41, s41, s42
    buffer_load_dwordx4 v[128:131], v1, s[32:35], s41 offen offset:0 nt
    v_mfma_f32_32x32x16_bf16 v[16:31], v[44:47], v[100:103], v[16:31]
    v_and_b32 v40, v34, v8
    v_and_b32 v41, v34, v9
    v_and_b32 v42, v34, v10
    v_and_b32 v43, v34, v11
    s_waitcnt vmcnt(6)
    s_cbranch_vccnz L_w_419
    s_waitcnt vmcnt(4)
L_w_419:
    buffer_load_dwordx4 v[132:135], v1, s[32:35], s41 offen offset:1024 nt
    v_mfma_f32_32x32x16_bf16 v[16:31], v[40:43], v[104:107], v[16:31]
    v_and_b32 v44, v35, v8
    v_and_b32 v45, v35, v9
    v_and_b32 v46, v35, v10
    v_and_b32 v47, v35, v11
    s_waitcnt vmcnt(6)
    s_cbranch_vccnz L_w_420
    s_waitcnt vmcnt(4)
L_w_420:
    buffer_load_dwordx4 v[136:139], v1, s[32:35], s41 offen offset:2048 nt
    v_mfma_f32_32x32x16_bf16 v[16:31], v[44:47], v[108:111], v[16:31]
    s_waitcnt lgkmcnt(0)
    v_cmp_lt_u32 vcc, v250, v249
    ds_read_b32 v249, v15 offset:28
    ds_read_b128 v[32:35], v13 offset:640
    v_and_b32 v40, v36, v8
    v_and_b32 v41, v36, v9
    v_and_b32 v42, v36, v10
    v_and_b32 v43, v36, v11
    s_waitcnt vmcnt(6)
    s_cbranch_vccnz L_w_421
    s_waitcnt vmcnt(4)
L_w_421:
    buffer_load_dwordx4 v[140:143], v1, s[32:35], s41 offen offset:3072 nt
    v_mov_b32 v250, 420
    ds_write_b32 v248, v250 offset:96
    v_mfma_f32_32x32x16_bf16 v[16:31], v[40:43], v[112:115], v[16:31]
    v_and_b32 v44, v37, v8
    v_and_b32 v45, v37, v9
    v_and_b32 v46, v37, v10
    v_and_b32 v47, v37, v11
    s_waitcnt vmcnt(6)
    s_cbranch_vccnz L_w_422
    s_waitcnt vmcnt(4)
L_w_422:
    s_add_u32 s41, s41, s42
    buffer_load_dwordx4 v[144:147], v1, s[32:35], s41 offen offset:0 nt
    v_mfma_f32_32x32x16_bf16 v[16:31], v[44:47], v[116:119], v[16:31]
    v_and_b32 v40, v38, v8
    v_and_b32 v41, v38, v9
    v_and_b32 v42, v38, v10
    v_and_b32 v43, v38, v11
    s_waitcnt vmcnt(6)
    s_cbranch_vccnz L_w_423
    s_waitcnt vmcnt(4)
L_w_423:
    buffer_load_dwordx4 v[148:151], v1, s[32:35], s41 offen offset:1024 nt
    v_mfma_f32_32x32x16_bf16 v[16:31], v[40:43], v[120:123], v[16:31]
    v_and_b32 v44, v39, v8
    v_and_b32 v45, v39, v9
    v_and_b32 v46, v39, v10
    v_and_b32 v47, v39, v11
    s_waitcnt vmcnt(6)
    s_cbranch_vccnz L_w_424
    s_waitcnt vmcnt(4)
L_w_424:
    buffer_load_dwordx4 v[152:155], v1, s[32:35], s41 offen offset:2048 nt
    v_mfma_f32_32x32x16_bf16 v[16:31], v[44:47], v[124:127], v[16:31]
    s_waitcnt lgkmcnt(0)
    v_cmp_lt_u32 vcc, v250, v249
    ds_read_b32 v249, v15 offset:28
    ds_read_b128 v[36:39], v13 offset:656
    v_and_b32 v40, v32, v8
    v_and_b32 v41, v32, v9
    v_and_b32 v42, v32, v10
    v_and_b32 v43, v32, v11
    s_waitcnt vmcnt(6)
    s_cbranch_vccnz L_w_425
    s_waitcnt vmcnt(4)
L_w_425:
    buffer_load_dwordx4 v[156:159], v1, s[32:35], s41 offen offset:3072 nt
    v_mov_b32 v250, 424
    ds_write_b32 v248, v250 offset:96
    v_mfma_f32_32x32x16_bf16 v[16:31], v[40:43], v[128:131], v[16:31]
    v_and_b32 v44, v33, v8
    v_and_b32 v45, v33, v9
    v_and_b32 v46, v33, v10
    v_and_b32 v47, v33, v11
    s_waitcnt vmcnt(6)
    s_cbranch_vccnz L_w_426
    s_waitcnt vmcnt(4)
L_w_426:
    s_add_u32 s41, s41, s42
    buffer_load_dwordx4 v[160:163], v1, s[32:35], s41 offen offset:0 nt
    v_mfma_f32_32x32x16_bf16 v[16:31], v[44:47], v[132:135], v[16:31]
    v_and_b32 v40, v34, v8
    v_and_b32 v41, v34, v9
    v_and_b32 v42, v34, v10
    v_and_b32 v43, v34, v11
    s_waitcnt vmcnt(6)
    s_cbranch_vccnz L_w_427
    s_waitcnt vmcnt(4)
L_w_427:
    buffer_load_dwordx4 v[164:167], v1, s[32:35], s41 offen offset:1024 nt
    v_mfma_f32_32x32x16_bf16 v[16:31], v[40:43], v[136:139], v[16:31]
    v_and_b32 v44, v35, v8
    v_and_b32 v45, v35, v9
    v_and_b32 v46, v35, v10
    v_and_b32 v47, v35, v11
    s_waitcnt vmcnt(6)
    s_cbranch_vccnz L_w_428
    s_waitcnt vmcnt(4)
L_w_428:
    buffer_load_dwordx4 v[168:171], v1, s[32:35], s41 offen offset:2048 nt
    v_mfma_f32_32x32x16_bf16 v[16:31], v[44:47], v[140:143], v[16:31]
    s_waitcnt lgkmcnt(0)
    v_cmp_lt_u32 vcc, v250, v249
    ds_read_b32 v249, v15 offset:28
    ds_read_b128 v[32:35], v13 offset:672
    v_and_b32 v40, v36, v8
    v_and_b32 v41, v36, v9
    v_and_b32 v42, v36, v10
    v_and_b32 v43, v36, v11
    s_waitcnt vmcnt(6)
    s_cbranch_vccnz L_w_429
    s_waitcnt vmcnt(4)
L_w_429:
    buffer_load_dwordx4 v[172:175], v1, s[32:35], s41 offen offset:3072 nt
    v_mov_b32 v250, 428
    ds_write_b32 v248, v250 offset:96
    v_mfma_f32_32x32x16_bf16 v[16:31], v[40:43], v[144:147], v[16:31]
    v_and_b32 v44, v37, v8
    v_and_b32 v45, v37, v9
    v_and_b32 v46, v37, v10
    v_and_b32 v47, v37, v11
    s_waitcnt vmcnt(6)
    s_cbranch_vccnz L_w_430
    s_waitcnt vmcnt(4)
L_w_430:
    s_add_u32 s41, s41, s42
    buffer_load_dwordx4 v[176:179], v1, s[32:35], s41 offen offset:0 nt
    v_mfma_f32_32x32x16_bf16 v[16:31], v[44:47], v[148:151], v[16:31]
    v_and_b32 v40, v38, v8
    v_and_b32 v41, v38, v9
    v_and_b32 v42, v38, v10
    v_and_b32 v43, v38, v11
    s_waitcnt vmcnt(6)
    s_cbranch_vccnz L_w_431
    s_waitcnt vmcnt(4)
L_w_431:
    buffer_load_dwordx4 v[180:183], v1, s[32:35], s41 offen offset:1024 nt
    v_mfma_f32_32x32x16_bf16 v[16:31], v[40:43], v[152:155], v[16:31]
    v_and_b32 v44, v39, v8
    v_and_b32 v45, v39, v9
    v_and_b32 v46, v39, v10
    v_and_b32 v47, v39, v11
    s_waitcnt vmcnt(6)
    s_cbranch_vccnz L_w_432
    s_waitcnt vmcnt(4)
L_w_432:
    buffer_load_dwordx4 v[184:187], v1, s[32:35], s41 offen offset:2048 nt
    v_mfma_f32_32x32x16_bf16 v[16:31], v[44:47], v[156:159], v[16:31]
    s_waitcnt lgkmcnt(0)
    v_cmp_lt_u32 vcc, v250, v249
    ds_read_b32 v249, v15 offset:28
    ds_read_b128 v[36:39], v13 offset:688
    v_and_b32 v40, v32, v8
    v_and_b32 v41, v32, v9
    v_and_b32 v42, v32, v10
    v_and_b32 v43, v32, v11
    s_waitcnt vmcnt(6)
    s_cbranch_vccnz L_w_433
    s_waitcnt vmcnt(4)
L_w_433:
    buffer_load_dwordx4 v[188:191], v1, s[32:35], s41 offen offset:3072 nt
    v_mov_b32 v250, 432
    ds_write_b32 v248, v250 offset:96
    v_mfma_f32_32x32x16_bf16 v[16:31], v[40:43], v[160:163], v[16:31]
    v_and_b32 v44, v33, v8
    v_and_b32 v45, v33, v9
    v_and_b32 v46, v33, v10
    v_and_b32 v47, v33, v11
    s_waitcnt vmcnt(6)
    s_cbranch_vccnz L_w_434
    s_waitcnt vmcnt(4)
L_w_434:
    s_add_u32 s41, s41, s42
    buffer_load_dwordx4 v[192:195], v1, s[32:35], s41 offen offset:0 nt
    v_mfma_f32_32x32x16_bf16 v[16:31], v[44:47], v[164:167], v[16:31]
    v_and_b32 v40, v34, v8
    v_and_b32 v41, v34, v9
    v_and_b32 v42, v34, v10
    v_and_b32 v43, v34, v11
    s_waitcnt vmcnt(6)
    s_cbranch_vccnz L_w_435
    s_waitcnt vmcnt(4)
L_w_435:
    buffer_load_dwordx4 v[196:199], v1, s[32:35], s41 offen offset:1024 nt
    v_mfma_f32_32x32x16_bf16 v[16:31], v[40:43], v[168:171], v[16:31]
    v_and_b32 v44, v35, v8
    v_and_b32 v45, v35, v9
    v_and_b32 v46, v35, v10
    v_and_b32 v47, v35, v11
    s_waitcnt vmcnt(6)
    s_cbranch_vccnz L_w_436
    s_waitcnt vmcnt(4)
L_w_436:
    buffer_load_dwordx4 v[200:203], v1, s[32:35], s41 offen offset:2048 nt
    v_mfma_f32_32x32x16_bf16 v[16:31], v[44:47], v[172:175], v[16:31]
    s_waitcnt lgkmcnt(0)
    v_cmp_lt_u32 vcc, v250, v249
    ds_read_b32 v249, v15 offset:28
    ds_read_b128 v[32:35], v13 offset:704
    v_and_b32 v40, v36, v8
    v_and_b32 v41, v36, v9
    v_and_b32 v42, v36, v10
    v_and_b32 v43, v36, v11
    s_waitcnt vmcnt(6)
    s_cbranch_vccnz L_w_437
    s_waitcnt vmcnt(4)
L_w_437:
    buffer_load_dwordx4 v[204:207], v1, s[32:35], s41 offen offset:3072 nt
    v_mov_b32 v250, 436
    ds_write_b32 v248, v250 offset:96
    v_mfma_f32_32x32x16_bf16 v[16:31], v[40:43], v[176:179], v[16:31]
    v_and_b32 v44, v37, v8
    v_and_b32 v45, v37, v9
    v_and_b32 v46, v37, v10
    v_and_b32 v47, v37, v11
    s_waitcnt vmcnt(6)
    s_cbranch_vccnz L_w_438
    s_waitcnt vmcnt(4)
L_w_438:
    s_add_u32 s41, s41, s42
    buffer_load_dwordx4 v[208:211], v1, s[32:35], s41 offen offset:0 nt
    v_mfma_f32_32x32x16_bf16 v[16:31], v[44:47], v[180:183], v[16:31]
    v_and_b32 v40, v38, v8
    v_and_b32 v41, v38, v9
    v_and_b32 v42, v38, v10
    v_and_b32 v43, v38, v11
    s_waitcnt vmcnt(6)
    s_cbranch_vccnz L_w_439
    s_waitcnt vmcnt(4)
L_w_439:
    buffer_load_dwordx4 v[212:215], v1, s[32:35], s41 offen offset:1024 nt
    v_mfma_f32_32x32x16_bf16 v[16:31], v[40:43], v[184:187], v[16:31]
    v_and_b32 v44, v39, v8
    v_and_b32 v45, v39, v9
    v_and_b32 v46, v39, v10
    v_and_b32 v47, v39, v11
    s_waitcnt vmcnt(6)
    s_cbranch_vccnz L_w_440
    s_waitcnt vmcnt(4)
L_w_440:
    buffer_load_dwordx4 v[216:219], v1, s[32:35], s41 offen offset:2048 nt
    v_mfma_f32_32x32x16_bf16 v[16:31], v[44:47], v[188:191], v[16:31]
    s_waitcnt lgkmcnt(0)
    v_cmp_lt_u32 vcc, v250, v249
    ds_read_b32 v249, v15 offset:28
    ds_read_b128 v[36:39], v13 offset:720
    v_and_b32 v40, v32, v8
    v_and_b32 v41, v32, v9
    v_and_b32 v42, v32, v10
    v_and_b32 v43, v32, v11
    s_waitcnt vmcnt(6)
    s_cbranch_vccnz L_w_441
    s_waitcnt vmcnt(4)
L_w_441:
    buffer_load_dwordx4 v[220:223], v1, s[32:35], s41 offen offset:3072 nt
    v_mov_b32 v250, 440
    ds_write_b32 v248, v250 offset:96
    v_mfma_f32_32x32x16_bf16 v[16:31], v[40:43], v[192:195], v[16:31]
    v_and_b32 v44, v33, v8
    v_and_b32 v45, v33, v9
    v_and_b32 v46, v33, v10
    v_and_b32 v47, v33, v11
    s_waitcnt vmcnt(6)
    s_cbranch_vccnz L_w_442
    s_waitcnt vmcnt(4)
L_w_442:
    s_add_u32 s41, s41, s42
    buffer_load_dwordx4 v[224:227], v1, s[32:35], s41 offen offset:0 nt
    v_mfma_f32_32x32x16_bf16 v[16:31], v[44:47], v[196:199], v[16:31]
    v_and_b32 v40, v34, v8
    v_and_b32 v41, v34, v9
    v_and_b32 v42, v34, v10
    v_and_b32 v43, v34, v11
    s_waitcnt vmcnt(6)
    s_cbranch_vccnz L_w_443
    s_waitcnt vmcnt(4)
L_w_443:
    buffer_load_dwordx4 v[228:231], v1, s[32:35], s41 offen offset:1024 nt
    v_mfma_f32_32x32x16_bf16 v[16:31], v[40:43], v[200:203], v[16:31]
    v_and_b32 v44, v35, v8
    v_and_b32 v45, v35, v9
    v_and_b32 v46, v35, v10
    v_and_b32 v47, v35, v11
    s_waitcnt vmcnt(6)
    s_cbranch_vccnz L_w_444
    s_waitcnt vmcnt(4)
L_w_444:
    buffer_load_dwordx4 v[232:235], v1, s[32:35], s41 offen offset:2048 nt
    v_mfma_f32_32x32x16_bf16 v[16:31], v[44:47], v[204:207], v[16:31]
    s_waitcnt lgkmcnt(0)
    v_cmp_lt_u32 vcc, v250, v249
    ds_read_b32 v249, v15 offset:28
    ds_read_b128 v[32:35], v13 offset:736
    v_and_b32 v40, v36, v8
    v_and_b32 v41, v36, v9
    v_and_b32 v42, v36, v10
    v_and_b32 v43, v36, v11
    s_waitcnt vmcnt(6)
    s_cbranch_vccnz L_w_445
    s_waitcnt vmcnt(4)
L_w_445:
    buffer_load_dwordx4 v[236:239], v1, s[32:35], s41 offen offset:3072 nt
    v_mov_b32 v250, 444
    ds_write_b32 v248, v250 offset:96
    v_mfma_f32_32x32x16_bf16 v[16:31], v[40:43], v[208:211], v[16:31]
    v_and_b32 v44, v37, v8
    v_and_b32 v45, v37, v9
    v_and_b32 v46, v37, v10
    v_and_b32 v47, v37, v11
    s_waitcnt vmcnt(6)
    s_cbranch_vccnz L_w_446
    s_waitcnt vmcnt(4)
L_w_446:
    s_add_u32 s41, s41, s42
    buffer_load_dwordx4 v[48:51], v1, s[32:35], s41 offen offset:0 nt
    v_mfma_f32_32x32x16_bf16 v[16:31], v[44:47], v[212:215], v[16:31]
    v_and_b32 v40, v38, v8
    v_and_b32 v41, v38, v9
    v_and_b32 v42, v38, v10
    v_and_b32 v43, v38, v11
    s_waitcnt vmcnt(6)
    s_cbranch_vccnz L_w_447
    s_waitcnt vmcnt(4)
L_w_447:
    buffer_load_dwordx4 v[52:55], v1, s[32:35], s41 offen offset:1024 nt
    v_mfma_f32_32x32x16_bf16 v[16:31], v[40:43], v[216:219], v[16:31]
    v_and_b32 v44, v39, v8
    v_and_b32 v45, v39, v9
    v_and_b32 v46, v39, v10
    v_and_b32 v47, v39, v11
    s_waitcnt vmcnt(6)
    s_cbranch_vccnz L_w_448
    s_waitcnt vmcnt(4)
L_w_448:
    buffer_load_dwordx4 v[56:59], v1, s[32:35], s41 offen offset:2048 nt
    v_mfma_f32_32x32x16_bf16 v[16:31], v[44:47], v[220:223], v[16:31]
    s_waitcnt lgkmcnt(0)
    v_cmp_lt_u32 vcc, v250, v249
    ds_read_b32 v249, v15 offset:28
    ds_read_b128 v[36:39], v13 offset:752
    v_and_b32 v40, v32, v8
    v_and_b32 v41, v32, v9
    v_and_b32 v42, v32, v10
    v_and_b32 v43, v32, v11
    s_waitcnt vmcnt(6)
    s_cbranch_vccnz L_w_449
    s_waitcnt vmcnt(4)
L_w_449:
    buffer_load_dwordx4 v[60:63], v1, s[32:35], s41 offen offset:3072 nt
    v_mov_b32 v250, 448
    ds_write_b32 v248, v250 offset:96
    v_mfma_f32_32x32x16_bf16 v[16:31], v[40:43], v[224:227], v[16:31]
    v_and_b32 v44, v33, v8
    v_and_b32 v45, v33, v9
    v_and_b32 v46, v33, v10
    v_and_b32 v47, v33, v11
    s_waitcnt vmcnt(6)
    s_cbranch_vccnz L_w_450
    s_waitcnt vmcnt(4)
L_w_450:
    s_add_u32 s41, s41, s42
    buffer_load_dwordx4 v[64:67], v1, s[32:35], s41 offen offset:0 nt
    v_mfma_f32_32x32x16_bf16 v[16:31], v[44:47], v[228:231], v[16:31]
    v_and_b32 v40, v34, v8
    v_and_b32 v41, v34, v9
    v_and_b32 v42, v34, v10
    v_and_b32 v43, v34, v11
    s_waitcnt vmcnt(6)
    s_cbranch_vccnz L_w_451
    s_waitcnt vmcnt(4)
L_w_451:
    buffer_load_dwordx4 v[68:71], v1, s[32:35], s41 offen offset:1024 nt
    v_mfma_f32_32x32x16_bf16 v[16:31], v[40:43], v[232:235], v[16:31]
    v_and_b32 v44, v35, v8
    v_and_b32 v45, v35, v9
    v_and_b32 v46, v35, v10
    v_and_b32 v47, v35, v11
    s_waitcnt vmcnt(6)
    s_cbranch_vccnz L_w_452
    s_waitcnt vmcnt(4)
L_w_452:
    buffer_load_dwordx4 v[72:75], v1, s[32:35], s41 offen offset:2048 nt
    v_mfma_f32_32x32x16_bf16 v[16:31], v[44:47], v[236:239], v[16:31]
    s_waitcnt lgkmcnt(0)
    v_cmp_lt_u32 vcc, v250, v249
    ds_read_b32 v249, v15 offset:28
    ds_read_b128 v[32:35], v13 offset:768
    v_and_b32 v40, v36, v8
    v_and_b32 v41, v36, v9
    v_and_b32 v42, v36, v10
    v_and_b32 v43, v36, v11
    s_waitcnt vmcnt(6)
    s_cbranch_vccnz L_w_453
    s_waitcnt vmcnt(4)
L_w_453:
    buffer_load_dwordx4 v[76:79], v1, s[32:35], s41 offen offset:3072 nt
    v_mov_b32 v250, 452
    ds_write_b32 v248, v250 offset:96
    v_mfma_f32_32x32x16_bf16 v[16:31], v[40:43], v[48:51], v[16:31]
    v_and_b32 v44, v37, v8
    v_and_b32 v45, v37, v9
    v_and_b32 v46, v37, v10
    v_and_b32 v47, v37, v11
    s_waitcnt vmcnt(6)
    s_cbranch_vccnz L_w_454
    s_waitcnt vmcnt(4)
L_w_454:
    s_add_u32 s41, s41, s42
    buffer_load_dwordx4 v[80:83], v1, s[32:35], s41 offen offset:0 nt
    v_mfma_f32_32x32x16_bf16 v[16:31], v[44:47], v[52:55], v[16:31]
    v_and_b32 v40, v38, v8
    v_and_b32 v41, v38, v9
    v_and_b32 v42, v38, v10
    v_and_b32 v43, v38, v11
    s_waitcnt vmcnt(6)
    s_cbranch_vccnz L_w_455
    s_waitcnt vmcnt(4)
L_w_455:
    buffer_load_dwordx4 v[84:87], v1, s[32:35], s41 offen offset:1024 nt
    v_mfma_f32_32x32x16_bf16 v[16:31], v[40:43], v[56:59], v[16:31]
    v_and_b32 v44, v39, v8
    v_and_b32 v45, v39, v9
    v_and_b32 v46, v39, v10
    v_and_b32 v47, v39, v11
    s_waitcnt vmcnt(6)
    s_cbranch_vccnz L_w_456
    s_waitcnt vmcnt(4)
L_w_456:
    buffer_load_dwordx4 v[88:91], v1, s[32:35], s41 offen offset:2048 nt
    v_mfma_f32_32x32x16_bf16 v[16:31], v[44:47], v[60:63], v[16:31]
    s_waitcnt lgkmcnt(0)
    v_cmp_lt_u32 vcc, v250, v249
    ds_read_b32 v249, v15 offset:28
    ds_read_b128 v[36:39], v13 offset:784
    v_and_b32 v40, v32, v8
    v_and_b32 v41, v32, v9
    v_and_b32 v42, v32, v10
    v_and_b32 v43, v32, v11
    s_waitcnt vmcnt(6)
    s_cbranch_vccnz L_w_457
    s_waitcnt vmcnt(4)
L_w_457:
    buffer_load_dwordx4 v[92:95], v1, s[32:35], s41 offen offset:3072 nt
    v_mov_b32 v250, 456
    ds_write_b32 v248, v250 offset:96
    v_mfma_f32_32x32x16_bf16 v[16:31], v[40:43], v[64:67], v[16:31]
    v_and_b32 v44, v33, v8
    v_and_b32 v45, v33, v9
    v_and_b32 v46, v33, v10
    v_and_b32 v47, v33, v11
    s_waitcnt vmcnt(6)
    s_cbranch_vccnz L_w_458
    s_waitcnt vmcnt(4)
L_w_458:
    s_add_u32 s41, s41, s42
    buffer_load_dwordx4 v[96:99], v1, s[32:35], s41 offen offset:0 nt
    v_mfma_f32_32x32x16_bf16 v[16:31], v[44:47], v[68:71], v[16:31]
    ds_write_b32 v15, v243 offset:48
    v_and_b32 v40, v34, v8
    v_and_b32 v41, v34, v9
    v_and_b32 v42, v34, v10
    v_and_b32 v43, v34, v11
    s_waitcnt vmcnt(6)
    s_cbranch_vccnz L_w_459
    s_waitcnt vmcnt(4)
L_w_459:
    buffer_load_dwordx4 v[100:103], v1, s[32:35], s41 offen offset:1024 nt
    v_mfma_f32_32x32x16_bf16 v[16:31], v[40:43], v[72:75], v[16:31]
    v_and_b32 v44, v35, v8
    v_and_b32 v45, v35, v9
    v_and_b32 v46, v35, v10
    v_and_b32 v47, v35, v11
    s_waitcnt vmcnt(6)
    s_cbranch_vccnz L_w_460
    s_waitcnt vmcnt(4)
L_w_460:
    buffer_load_dwordx4 v[104:107], v1, s[32:35], s41 offen offset:2048 nt
    v_mfma_f32_32x32x16_bf16 v[16:31], v[44:47], v[76:79], v[16:31]
    s_waitcnt lgkmcnt(0)
    v_cmp_lt_u32 vcc, v250, v249
    ds_read_b32 v249, v15 offset:28
    ds_read_b128 v[32:35], v13 offset:800
    v_and_b32 v40, v36, v8
    v_and_b32 v41, v36, v9
    v_and_b32 v42, v36, v10
    v_and_b32 v43, v36, v11
    s_waitcnt vmcnt(6)
    s_cbranch_vccnz L_w_461
    s_waitcnt vmcnt(4)
L_w_461:
    buffer_load_dwordx4 v[108:111], v1, s[32:35], s41 offen offset:3072 nt
    v_mov_b32 v250, 460
    ds_write_b32 v248, v250 offset:96
    v_mfma_f32_32x32x16_bf16 v[16:31], v[40:43], v[80:83], v[16:31]
    v_and_b32 v44, v37, v8
    v_and_b32 v45, v37, v9
    v_and_b32 v46, v37, v10
    v_and_b32 v47, v37, v11
    s_waitcnt vmcnt(6)
    s_cbranch_vccnz L_w_462
    s_waitcnt vmcnt(4)
L_w_462:
    s_add_u32 s41, s41, s42
    buffer_load_dwordx4 v[112:115], v1, s[32:35], s41 offen offset:0 nt
    v_mfma_f32_32x32x16_bf16 v[16:31], v[44:47], v[84:87], v[16:31]
    v_and_b32 v40, v38, v8
    v_and_b32 v41, v38, v9
    v_and_b32 v42, v38, v10
    v_and_b32 v43, v38, v11
    s_waitcnt vmcnt(6)
    s_cbranch_vccnz L_w_463
    s_waitcnt vmcnt(4)
L_w_463:
    buffer_load_dwordx4 v[116:119], v1, s[32:35], s41 offen offset:1024 nt
    v_mfma_f32_32x32x16_bf16 v[16:31], v[40:43], v[88:91], v[16:31]
    v_and_b32 v44, v39, v8
    v_and_b32 v45, v39, v9
    v_and_b32 v46, v39, v10
    v_and_b32 v47, v39, v11
    s_waitcnt vmcnt(6)
    s_cbranch_vccnz L_w_464
    s_waitcnt vmcnt(4)
L_w_464:
    buffer_load_dwordx4 v[120:123], v1, s[32:35], s41 offen offset:2048 nt
    v_mfma_f32_32x32x16_bf16 v[16:31], v[44:47], v[92:95], v[16:31]
    s_waitcnt lgkmcnt(0)
    v_cmp_lt_u32 vcc, v250, v249
    ds_read_b32 v249, v15 offset:28
    ds_read_b128 v[36:39], v13 offset:816
    v_and_b32 v40, v32, v8
    v_and_b32 v41, v32, v9
    v_and_b32 v42, v32, v10
    v_and_b32 v43, v32, v11
    s_waitcnt vmcnt(6)
    s_cbranch_vccnz L_w_465
    s_waitcnt vmcnt(4)
L_w_465:
    buffer_load_dwordx4 v[124:127], v1, s[32:35], s41 offen offset:3072 nt
    v_mov_b32 v250, 464
    ds_write_b32 v248, v250 offset:96
    v_mfma_f32_32x32x16_bf16 v[16:31], v[40:43], v[96:99], v[16:31]
    v_and_b32 v44, v33, v8
    v_and_b32 v45, v33, v9
    v_and_b32 v46, v33, v10
    v_and_b32 v47, v33, v11
    s_waitcnt vmcnt(6)
    s_cbranch_vccnz L_w_466
    s_waitcnt vmcnt(4)
L_w_466:
    s_add_u32 s41, s41, s42
    buffer_load_dwordx4 v[128:131], v1, s[32:35], s41 offen offset:0 nt
    v_mfma_f32_32x32x16_bf16 v[16:31], v[44:47], v[100:103], v[16:31]
    v_and_b32 v40, v34, v8
    v_and_b32 v41, v34, v9
    v_and_b32 v42, v34, v10
    v_and_b32 v43, v34, v11
    s_waitcnt vmcnt(6)
    s_cbranch_vccnz L_w_467
    s_waitcnt vmcnt(4)
L_w_467:
    buffer_load_dwordx4 v[132:135], v1, s[32:35], s41 offen offset:1024 nt
    v_mfma_f32_32x32x16_bf16 v[16:31], v[40:43], v[104:107], v[16:31]
    v_and_b32 v44, v35, v8
    v_and_b32 v45, v35, v9
    v_and_b32 v46, v35, v10
    v_and_b32 v47, v35, v11
    s_waitcnt vmcnt(6)
    s_cbranch_vccnz L_w_468
    s_waitcnt vmcnt(4)
L_w_468:
    buffer_load_dwordx4 v[136:139], v1, s[32:35], s41 offen offset:2048 nt
    v_mfma_f32_32x32x16_bf16 v[16:31], v[44:47], v[108:111], v[16:31]
    s_waitcnt lgkmcnt(0)
    v_cmp_lt_u32 vcc, v250, v249
    ds_read_b32 v249, v15 offset:28
    ds_read_b128 v[32:35], v13 offset:832
    v_and_b32 v40, v36, v8
    v_and_b32 v41, v36, v9
    v_and_b32 v42, v36, v10
    v_and_b32 v43, v36, v11
    s_waitcnt vmcnt(6)
    s_cbranch_vccnz L_w_469
    s_waitcnt vmcnt(4)
L_w_469:
    buffer_load_dwordx4 v[140:143], v1, s[32:35], s41 offen offset:3072 nt
    v_mov_b32 v250, 468
    ds_write_b32 v248, v250 offset:96
    v_mfma_f32_32x32x16_bf16 v[16:31], v[40:43], v[112:115], v[16:31]
    v_and_b32 v44, v37, v8
    v_and_b32 v45, v37, v9
    v_and_b32 v46, v37, v10
    v_and_b32 v47, v37, v11
    s_waitcnt vmcnt(6)
    s_cbranch_vccnz L_w_470
    s_waitcnt vmcnt(4)
L_w_470:
    s_add_u32 s41, s41, s42
    buffer_load_dwordx4 v[144:147], v1, s[32:35], s41 offen offset:0 nt
    v_mfma_f32_32x32x16_bf16 v[16:31], v[44:47], v[116:119], v[16:31]
    v_and_b32 v40, v38, v8
    v_and_b32 v41, v38, v9
    v_and_b32 v42, v38, v10
    v_and_b32 v43, v38, v11
    s_waitcnt vmcnt(6)
    s_cbranch_vccnz L_w_471
    s_waitcnt vmcnt(4)
L_w_471:
    buffer_load_dwordx4 v[148:151], v1, s[32:35], s41 offen offset:1024 nt
    v_mfma_f32_32x32x16_bf16 v[16:31], v[40:43], v[120:123], v[16:31]
    v_and_b32 v44, v39, v8
    v_and_b32 v45, v39, v9
    v_and_b32 v46, v39, v10
    v_and_b32 v47, v39, v11
    s_waitcnt vmcnt(6)
    s_cbranch_vccnz L_w_472
    s_waitcnt vmcnt(4)
L_w_472:
    buffer_load_dwordx4 v[152:155], v1, s[32:35], s41 offen offset:2048 nt
    v_mfma_f32_32x32x16_bf16 v[16:31], v[44:47], v[124:127], v[16:31]
    s_waitcnt lgkmcnt(0)
    v_cmp_lt_u32 vcc, v250, v249
    ds_read_b32 v249, v15 offset:28
    ds_read_b128 v[36:39], v13 offset:848
    v_and_b32 v40, v32, v8
    v_and_b32 v41, v32, v9
    v_and_b32 v42, v32, v10
    v_and_b32 v43, v32, v11
    s_waitcnt vmcnt(6)
    s_cbranch_vccnz L_w_473
    s_waitcnt vmcnt(4)
L_w_473:
    buffer_load_dwordx4 v[156:159], v1, s[32:35], s41 offen offset:3072 nt
    v_mov_b32 v250, 472
    ds_write_b32 v248, v250 offset:96
    v_mfma_f32_32x32x16_bf16 v[16:31], v[40:43], v[128:131], v[16:31]
    v_and_b32 v44, v33, v8
    v_and_b32 v45, v33, v9
    v_and_b32 v46, v33, v10
    v_and_b32 v47, v33, v11
    s_waitcnt vmcnt(6)
    s_cbranch_vccnz L_w_474
    s_waitcnt vmcnt(4)
L_w_474:
    s_add_u32 s41, s41, s42
    buffer_load_dwordx4 v[160:163], v1, s[32:35], s41 offen offset:0 nt
    v_mfma_f32_32x32x16_bf16 v[16:31], v[44:47], v[132:135], v[16:31]
    v_and_b32 v40, v34, v8
    v_and_b32 v41, v34, v9
    v_and_b32 v42, v34, v10
    v_and_b32 v43, v34, v11
    s_waitcnt vmcnt(6)
    s_cbranch_vccnz L_w_475
    s_waitcnt vmcnt(4)
L_w_475:
    buffer_load_dwordx4 v[164:167], v1, s[32:35], s41 offen offset:1024 nt
    v_mfma_f32_32x32x16_bf16 v[16:31], v[40:43], v[136:139], v[16:31]
    v_and_b32 v44, v35, v8
    v_and_b32 v45, v35, v9
    v_and_b32 v46, v35, v10
    v_and_b32 v47, v35, v11
    s_waitcnt vmcnt(6)
    s_cbranch_vccnz L_w_476
    s_waitcnt vmcnt(4)
L_w_476:
    buffer_load_dwordx4 v[168:171], v1, s[32:35], s41 offen offset:2048 nt
    v_mfma_f32_32x32x16_bf16 v[16:31], v[44:47], v[140:143], v[16:31]
    s_waitcnt lgkmcnt(0)
    v_cmp_lt_u32 vcc, v250, v249
    ds_read_b32 v249, v15 offset:28
    ds_read_b128 v[32:35], v13 offset:864
    v_and_b32 v40, v36, v8
    v_and_b32 v41, v36, v9
    v_and_b32 v42, v36, v10
    v_and_b32 v43, v36, v11
    s_waitcnt vmcnt(6)
    s_cbranch_vccnz L_w_477
    s_waitcnt vmcnt(4)
L_w_477:
    buffer_load_dwordx4 v[172:175], v1, s[32:35], s41 offen offset:3072 nt
    v_mov_b32 v250, 476
    ds_write_b32 v248, v250 offset:96
    v_mfma_f32_32x32x16_bf16 v[16:31], v[40:43], v[144:147], v[16:31]
    v_and_b32 v44, v37, v8
    v_and_b32 v45, v37, v9
    v_and_b32 v46, v37, v10
    v_and_b32 v47, v37, v11
    s_waitcnt vmcnt(6)
    s_cbranch_vccnz L_w_478
    s_waitcnt vmcnt(4)
L_w_478:
    s_add_u32 s41, s41, s42
    buffer_load_dwordx4 v[176:179], v1, s[32:35], s41 offen offset:0 nt
    v_mfma_f32_32x32x16_bf16 v[16:31], v[44:47], v[148:151], v[16:31]
    v_and_b32 v40, v38, v8
    v_and_b32 v41, v38, v9
    v_and_b32 v42, v38, v10
    v_and_b32 v43, v38, v11
    s_waitcnt vmcnt(6)
    s_cbranch_vccnz L_w_479
    s_waitcnt vmcnt(4)
L_w_479:
    buffer_load_dwordx4 v[180:183], v1, s[32:35], s41 offen offset:1024 nt
    v_mfma_f32_32x32x16_bf16 v[16:31], v[40:43], v[152:155], v[16:31]
    v_and_b32 v44, v39, v8
    v_and_b32 v45, v39, v9
    v_and_b32 v46, v39, v10
    v_and_b32 v47, v39, v11
    s_waitcnt vmcnt(6)
    s_cbranch_vccnz L_w_480
    s_waitcnt vmcnt(4)
L_w_480:
    buffer_load_dwordx4 v[184:187], v1, s[32:35], s41 offen offset:2048 nt
    v_mfma_f32_32x32x16_bf16 v[16:31], v[44:47], v[156:159], v[16:31]
    s_waitcnt lgkmcnt(0)
    v_cmp_lt_u32 vcc, v250, v249
    ds_read_b32 v249, v15 offset:28
    ds_read_b128 v[36:39], v13 offset:880
    v_and_b32 v40, v32, v8
    v_and_b32 v41, v32, v9
    v_and_b32 v42, v32, v10
    v_and_b32 v43, v32, v11
    s_waitcnt vmcnt(6)
    s_cbranch_vccnz L_w_481
    s_waitcnt vmcnt(4)
L_w_481:
    buffer_load_dwordx4 v[188:191], v1, s[32:35], s41 offen offset:3072 nt
    v_mov_b32 v250, 480
    ds_write_b32 v248, v250 offset:96
    v_mfma_f32_32x32x16_bf16 v[16:31], v[40:43], v[160:163], v[16:31]
    v_and_b32 v44, v33, v8
    v_and_b32 v45, v33, v9
    v_and_b32 v46, v33, v10
    v_and_b32 v47, v33, v11
    s_waitcnt vmcnt(6)
    s_cbranch_vccnz L_w_482
    s_waitcnt vmcnt(4)
L_w_482:
    s_add_u32 s41, s41, s42
    buffer_load_dwordx4 v[192:195], v1, s[32:35], s41 offen offset:0 nt
    v_mfma_f32_32x32x16_bf16 v[16:31], v[44:47], v[164:167], v[16:31]
    v_and_b32 v40, v34, v8
    v_and_b32 v41, v34, v9
    v_and_b32 v42, v34, v10
    v_and_b32 v43, v34, v11
    s_waitcnt vmcnt(6)
    s_cbranch_vccnz L_w_483
    s_waitcnt vmcnt(4)
L_w_483:
    buffer_load_dwordx4 v[196:199], v1, s[32:35], s41 offen offset:1024 nt
    v_mfma_f32_32x32x16_bf16 v[16:31], v[40:43], v[168:171], v[16:31]
    v_and_b32 v44, v35, v8
    v_and_b32 v45, v35, v9
    v_and_b32 v46, v35, v10
    v_and_b32 v47, v35, v11
    s_waitcnt vmcnt(6)
    s_cbranch_vccnz L_w_484
    s_waitcnt vmcnt(4)
L_w_484:
    buffer_load_dwordx4 v[200:203], v1, s[32:35], s41 offen offset:2048 nt
    v_mfma_f32_32x32x16_bf16 v[16:31], v[44:47], v[172:175], v[16:31]
    s_waitcnt lgkmcnt(0)
    v_cmp_lt_u32 vcc, v250, v249
    ds_read_b32 v249, v15 offset:28
    ds_read_b128 v[32:35], v13 offset:896
    v_and_b32 v40, v36, v8
    v_and_b32 v41, v36, v9
    v_and_b32 v42, v36, v10
    v_and_b32 v43, v36, v11
    s_waitcnt vmcnt(6)
    s_cbranch_vccnz L_w_485
    s_waitcnt vmcnt(4)
L_w_485:
    buffer_load_dwordx4 v[204:207], v1, s[32:35], s41 offen offset:3072 nt
    v_mov_b32 v250, 484
    ds_write_b32 v248, v250 offset:96
    v_mfma_f32_32x32x16_bf16 v[16:31], v[40:43], v[176:179], v[16:31]
    v_and_b32 v44, v37, v8
    v_and_b32 v45, v37, v9
    v_and_b32 v46, v37, v10
    v_and_b32 v47, v37, v11
    s_waitcnt vmcnt(6)
    s_cbranch_vccnz L_w_486
    s_waitcnt vmcnt(4)
L_w_486:
    s_add_u32 s41, s41, s42
    buffer_load_dwordx4 v[208:211], v1, s[32:35], s41 offen offset:0 nt
    v_mfma_f32_32x32x16_bf16 v[16:31], v[44:47], v[180:183], v[16:31]
    v_and_b32 v40, v38, v8
    v_and_b32 v41, v38, v9
    v_and_b32 v42, v38, v10
    v_and_b32 v43, v38, v11
    s_waitcnt vmcnt(6)
    s_cbranch_vccnz L_w_487
    s_waitcnt vmcnt(4)
L_w_487:
    buffer_load_dwordx4 v[212:215], v1, s[32:35], s41 offen offset:1024 nt
    v_mfma_f32_32x32x16_bf16 v[16:31], v[40:43], v[184:187], v[16:31]
    v_and_b32 v44, v39, v8
    v_and_b32 v45, v39, v9
    v_and_b32 v46, v39, v10
    v_and_b32 v47, v39, v11
    s_waitcnt vmcnt(6)
    s_cbranch_vccnz L_w_488
    s_waitcnt vmcnt(4)
L_w_488:
    buffer_load_dwordx4 v[216:219], v1, s[32:35], s41 offen offset:2048 nt
    v_mfma_f32_32x32x16_bf16 v[16:31], v[44:47], v[188:191], v[16:31]
    s_waitcnt lgkmcnt(0)
    v_cmp_lt_u32 vcc, v250, v249
    ds_read_b32 v249, v15 offset:28
    ds_read_b128 v[36:39], v13 offset:912
    v_and_b32 v40, v32, v8
    v_and_b32 v41, v32, v9
    v_and_b32 v42, v32, v10
    v_and_b32 v43, v32, v11
    s_waitcnt vmcnt(6)
    s_cbranch_vccnz L_w_489
    s_waitcnt vmcnt(4)
L_w_489:
    buffer_load_dwordx4 v[220:223], v1, s[32:35], s41 offen offset:3072 nt
    v_mov_b32 v250, 488
    ds_write_b32 v248, v250 offset:96
    v_mfma_f32_32x32x16_bf16 v[16:31], v[40:43], v[192:195], v[16:31]
    v_and_b32 v44, v33, v8
    v_and_b32 v45, v33, v9
    v_and_b32 v46, v33, v10
    v_and_b32 v47, v33, v11
    s_waitcnt vmcnt(6)
    s_cbranch_vccnz L_w_490
    s_waitcnt vmcnt(4)
L_w_490:
    s_add_u32 s41, s41, s42
    buffer_load_dwordx4 v[224:227], v1, s[32:35], s41 offen offset:0 nt
    v_mfma_f32_32x32x16_bf16 v[16:31], v[44:47], v[196:199], v[16:31]
    v_and_b32 v40, v34, v8
    v_and_b32 v41, v34, v9
    v_and_b32 v42, v34, v10
    v_and_b32 v43, v34, v11
    s_waitcnt vmcnt(6)
    s_cbranch_vccnz L_w_491
    s_waitcnt vmcnt(4)
L_w_491:
    buffer_load_dwordx4 v[228:231], v1, s[32:35], s41 offen offset:1024 nt
    v_mfma_f32_32x32x16_bf16 v[16:31], v[40:43], v[200:203], v[16:31]
    v_and_b32 v44, v35, v8
    v_and_b32 v45, v35, v9
    v_and_b32 v46, v35, v10
    v_and_b32 v47, v35, v11
    s_waitcnt vmcnt(6)
    s_cbranch_vccnz L_w_492
    s_waitcnt vmcnt(4)
L_w_492:
    buffer_load_dwordx4 v[232:235], v1, s[32:35], s41 offen offset:2048 nt
    v_mfma_f32_32x32x16_bf16 v[16:31], v[44:47], v[204:207], v[16:31]
    s_waitcnt lgkmcnt(0)
    v_cmp_lt_u32 vcc, v250, v249
    ds_read_b32 v249, v15 offset:28
    ds_read_b128 v[32:35], v13 offset:928
    v_and_b32 v40, v36, v8
    v_and_b32 v41, v36, v9
    v_and_b32 v42, v36, v10
    v_and_b32 v43, v36, v11
    s_waitcnt vmcnt(6)
    s_cbranch_vccnz L_w_493
    s_waitcnt vmcnt(4)
L_w_493:
    buffer_load_dwordx4 v[236:239], v1, s[32:35], s41 offen offset:3072 nt
    v_mov_b32 v250, 492
    ds_write_b32 v248, v250 offset:96
    v_mfma_f32_32x32x16_bf16 v[16:31], v[40:43], v[208:211], v[16:31]
    v_and_b32 v44, v37, v8
    v_and_b32 v45, v37, v9
    v_and_b32 v46, v37, v10
    v_and_b32 v47, v37, v11
    s_waitcnt vmcnt(6)
    s_cbranch_vccnz L_w_494
    s_waitcnt vmcnt(4)
L_w_494:
    s_add_u32 s41, s41, s42
    buffer_load_dwordx4 v[48:51], v1, s[32:35], s41 offen offset:0 nt
    v_mfma_f32_32x32x16_bf16 v[16:31], v[44:47], v[212:215], v[16:31]
    v_and_b32 v40, v38, v8
    v_and_b32 v41, v38, v9
    v_and_b32 v42, v38, v10
    v_and_b32 v43, v38, v11
    s_waitcnt vmcnt(6)
    s_cbranch_vccnz L_w_495
    s_waitcnt vmcnt(4)
L_w_495:
    buffer_load_dwordx4 v[52:55], v1, s[32:35], s41 offen offset:1024 nt
    v_mfma_f32_32x32x16_bf16 v[16:31], v[40:43], v[216:219], v[16:31]
    v_and_b32 v44, v39, v8
    v_and_b32 v45, v39, v9
    v_and_b32 v46, v39, v10
    v_and_b32 v47, v39, v11
    s_waitcnt vmcnt(6)
    s_cbranch_vccnz L_w_496
    s_waitcnt vmcnt(4)
L_w_496:
    buffer_load_dwordx4 v[56:59], v1, s[32:35], s41 offen offset:2048 nt
    v_mfma_f32_32x32x16_bf16 v[16:31], v[44:47], v[220:223], v[16:31]
    s_waitcnt lgkmcnt(0)
    v_cmp_lt_u32 vcc, v250, v249
    ds_read_b32 v249, v15 offset:28
    ds_read_b128 v[36:39], v13 offset:944
    v_and_b32 v40, v32, v8
    v_and_b32 v41, v32, v9
    v_and_b32 v42, v32, v10
    v_and_b32 v43, v32, v11
    s_waitcnt vmcnt(6)
    s_cbranch_vccnz L_w_497
    s_waitcnt vmcnt(4)
L_w_497:
    buffer_load_dwordx4 v[60:63], v1, s[32:35], s41 offen offset:3072 nt
    v_mov_b32 v250, 496
    ds_write_b32 v248, v250 offset:96
    v_mfma_f32_32x32x16_bf16 v[16:31], v[40:43], v[224:227], v[16:31]
    v_and_b32 v44, v33, v8
    v_and_b32 v45, v33, v9
    v_and_b32 v46, v33, v10
    v_and_b32 v47, v33, v11
    s_waitcnt vmcnt(6)
    s_cbranch_vccnz L_w_498
    s_waitcnt vmcnt(4)
L_w_498:
    s_add_u32 s41, s41, s42
    buffer_load_dwordx4 v[64:67], v1, s[32:35], s41 offen offset:0 nt
    v_mfma_f32_32x32x16_bf16 v[16:31], v[44:47], v[228:231], v[16:31]
    v_and_b32 v40, v34, v8
    v_and_b32 v41, v34, v9
    v_and_b32 v42, v34, v10
    v_and_b32 v43, v34, v11
    s_waitcnt vmcnt(6)
    s_cbranch_vccnz L_w_499
    s_waitcnt vmcnt(4)
L_w_499:
    buffer_load_dwordx4 v[68:71], v1, s[32:35], s41 offen offset:1024 nt
    v_mfma_f32_32x32x16_bf16 v[16:31], v[40:43], v[232:235], v[16:31]
    v_and_b32 v44, v35, v8
    v_and_b32 v45, v35, v9
    v_and_b32 v46, v35, v10
    v_and_b32 v47, v35, v11
    s_waitcnt vmcnt(6)
    s_cbranch_vccnz L_w_500
    s_waitcnt vmcnt(4)
L_w_500:
    buffer_load_dwordx4 v[72:75], v1, s[32:35], s41 offen offset:2048 nt
    v_mfma_f32_32x32x16_bf16 v[16:31], v[44:47], v[236:239], v[16:31]
    s_waitcnt lgkmcnt(0)
    v_cmp_lt_u32 vcc, v250, v249
    ds_read_b32 v249, v15 offset:28
    ds_read_b128 v[32:35], v13 offset:960
    v_and_b32 v40, v36, v8
    v_and_b32 v41, v36, v9
    v_and_b32 v42, v36, v10
    v_and_b32 v43, v36, v11
    s_waitcnt vmcnt(6)
    s_cbranch_vccnz L_w_501
    s_waitcnt vmcnt(4)
L_w_501:
    buffer_load_dwordx4 v[76:79], v1, s[32:35], s41 offen offset:3072 nt
    v_mov_b32 v250, 500
    ds_write_b32 v248, v250 offset:96
    v_mfma_f32_32x32x16_bf16 v[16:31], v[40:43], v[48:51], v[16:31]
    v_and_b32 v44, v37, v8
    v_and_b32 v45, v37, v9
    v_and_b32 v46, v37, v10
    v_and_b32 v47, v37, v11
    s_waitcnt vmcnt(6)
    s_cbranch_vccnz L_w_502
    s_waitcnt vmcnt(4)
L_w_502:
    s_add_u32 s41, s41, s42
    buffer_load_dwordx4 v[80:83], v1, s[32:35], s41 offen offset:0 nt
    v_mfma_f32_32x32x16_bf16 v[16:31], v[44:47], v[52:55], v[16:31]
    v_and_b32 v40, v38, v8
    v_and_b32 v41, v38, v9
    v_and_b32 v42, v38, v10
    v_and_b32 v43, v38, v11
    s_waitcnt vmcnt(6)
    s_cbranch_vccnz L_w_503
    s_waitcnt vmcnt(4)
L_w_503:
    buffer_load_dwordx4 v[84:87], v1, s[32:35], s41 offen offset:1024 nt
    v_mfma_f32_32x32x16_bf16 v[16:31], v[40:43], v[56:59], v[16:31]
    v_and_b32 v44, v39, v8
    v_and_b32 v45, v39, v9
    v_and_b32 v46, v39, v10
    v_and_b32 v47, v39, v11
    s_waitcnt vmcnt(6)
    s_cbranch_vccnz L_w_504
    s_waitcnt vmcnt(4)
L_w_504:
    buffer_load_dwordx4 v[88:91], v1, s[32:35], s41 offen offset:2048 nt
    v_mfma_f32_32x32x16_bf16 v[16:31], v[44:47], v[60:63], v[16:31]
    s_waitcnt lgkmcnt(0)
    v_cmp_lt_u32 vcc, v250, v249
    ds_read_b32 v249, v15 offset:28
    ds_read_b128 v[36:39], v13 offset:976
    v_and_b32 v40, v32, v8
    v_and_b32 v41, v32, v9
    v_and_b32 v42, v32, v10
    v_and_b32 v43, v32, v11
    s_waitcnt vmcnt(6)
    s_cbranch_vccnz L_w_505
    s_waitcnt vmcnt(4)
L_w_505:
    buffer_load_dwordx4 v[92:95], v1, s[32:35], s41 offen offset:3072 nt
    v_mov_b32 v250, 504
    ds_write_b32 v248, v250 offset:96
    v_mfma_f32_32x32x16_bf16 v[16:31], v[40:43], v[64:67], v[16:31]
    v_and_b32 v44, v33, v8
    v_and_b32 v45, v33, v9
    v_and_b32 v46, v33, v10
    v_and_b32 v47, v33, v11
    s_waitcnt vmcnt(6)
    s_cbranch_vccnz L_w_506
    s_waitcnt vmcnt(4)
L_w_506:
    s_add_u32 s41, s41, s42
    buffer_load_dwordx4 v[96:99], v1, s[32:35], s41 offen offset:0 nt
    v_mfma_f32_32x32x16_bf16 v[16:31], v[44:47], v[68:71], v[16:31]
    v_and_b32 v40, v34, v8
    v_and_b32 v41, v34, v9
    v_and_b32 v42, v34, v10
    v_and_b32 v43, v34, v11
    s_waitcnt vmcnt(6)
    s_cbranch_vccnz L_w_507
    s_waitcnt vmcnt(4)
L_w_507:
    buffer_load_dwordx4 v[100:103], v1, s[32:35], s41 offen offset:1024 nt
    v_mfma_f32_32x32x16_bf16 v[16:31], v[40:43], v[72:75], v[16:31]
    v_and_b32 v44, v35, v8
    v_and_b32 v45, v35, v9
    v_and_b32 v46, v35, v10
    v_and_b32 v47, v35, v11
    s_waitcnt vmcnt(6)
    s_cbranch_vccnz L_w_508
    s_waitcnt vmcnt(4)
L_w_508:
    buffer_load_dwordx4 v[104:107], v1, s[32:35], s41 offen offset:2048 nt
    v_mfma_f32_32x32x16_bf16 v[16:31], v[44:47], v[76:79], v[16:31]
    s_waitcnt lgkmcnt(0)
    v_cmp_lt_u32 vcc, v250, v249
    ds_read_b32 v249, v15 offset:28
    ds_read_b128 v[32:35], v13 offset:992
    v_and_b32 v40, v36, v8
    v_and_b32 v41, v36, v9
    v_and_b32 v42, v36, v10
    v_and_b32 v43, v36, v11
    s_waitcnt vmcnt(6)
    s_cbranch_vccnz L_w_509
    s_waitcnt vmcnt(4)
L_w_509:
    buffer_load_dwordx4 v[108:111], v1, s[32:35], s41 offen offset:3072 nt
    v_mov_b32 v250, 508
    ds_write_b32 v248, v250 offset:96
    v_mfma_f32_32x32x16_bf16 v[16:31], v[40:43], v[80:83], v[16:31]
    v_and_b32 v44, v37, v8
    v_and_b32 v45, v37, v9
    v_and_b32 v46, v37, v10
    v_and_b32 v47, v37, v11
    s_waitcnt vmcnt(6)
    s_cbranch_vccnz L_w_510
    s_waitcnt vmcnt(4)
L_w_510:
    s_add_u32 s41, s41, s42
    buffer_load_dwordx4 v[112:115], v1, s[32:35], s41 offen offset:0 nt
    v_mfma_f32_32x32x16_bf16 v[16:31], v[44:47], v[84:87], v[16:31]
    v_and_b32 v40, v38, v8
    v_and_b32 v41, v38, v9
    v_and_b32 v42, v38, v10
    v_and_b32 v43, v38, v11
    s_waitcnt vmcnt(6)
    s_cbranch_vccnz L_w_511
    s_waitcnt vmcnt(4)
L_w_511:
    buffer_load_dwordx4 v[116:119], v1, s[32:35], s41 offen offset:1024 nt
    v_mfma_f32_32x32x16_bf16 v[16:31], v[40:43], v[88:91], v[16:31]
    v_and_b32 v44, v39, v8
    v_and_b32 v45, v39, v9
    v_and_b32 v46, v39, v10
    v_and_b32 v47, v39, v11
    s_waitcnt vmcnt(6)
    s_cbranch_vccnz L_w_512
    s_waitcnt vmcnt(4)
L_w_512:
    buffer_load_dwordx4 v[120:123], v1, s[32:35], s41 offen offset:2048 nt
    v_mfma_f32_32x32x16_bf16 v[16:31], v[44:47], v[92:95], v[16:31]
    s_waitcnt lgkmcnt(0)
    v_cmp_lt_u32 vcc, v250, v249
    ds_read_b32 v249, v15 offset:28
    ds_read_b128 v[36:39], v13 offset:1008
    v_and_b32 v40, v32, v8
    v_and_b32 v41, v32, v9
    v_and_b32 v42, v32, v10
    v_and_b32 v43, v32, v11
    s_waitcnt vmcnt(6)
    s_cbranch_vccnz L_w_513
    s_waitcnt vmcnt(4)
L_w_513:
    buffer_load_dwordx4 v[124:127], v1, s[32:35], s41 offen offset:3072 nt
    v_mov_b32 v250, 512
    ds_write_b32 v248, v250 offset:96
    v_mfma_f32_32x32x16_bf16 v[16:31], v[40:43], v[96:99], v[16:31]
    v_and_b32 v44, v33, v8
    v_and_b32 v45, v33, v9
    v_and_b32 v46, v33, v10
    v_and_b32 v47, v33, v11
    s_waitcnt vmcnt(6)
    s_nop 0
    v_mfma_f32_32x32x16_bf16 v[16:31], v[44:47], v[100:103], v[16:31]
    ds_read_b32 v240, v248 offset:32
    ds_read_b32 v244, v15 offset:112
    v_and_b32 v40, v34, v8
    v_and_b32 v41, v34, v9
    v_and_b32 v42, v34, v10
    v_and_b32 v43, v34, v11
    s_waitcnt vmcnt(5)
    s_nop 0
    v_mfma_f32_32x32x16_bf16 v[16:31], v[40:43], v[104:107], v[16:31]
    v_and_b32 v44, v35, v8
    v_and_b32 v45, v35, v9
    v_and_b32 v46, v35, v10
    v_and_b32 v47, v35, v11
    s_waitcnt vmcnt(4)
    s_nop 0
    v_mfma_f32_32x32x16_bf16 v[16:31], v[44:47], v[108:111], v[16:31]
    s_waitcnt lgkmcnt(0)
    v_cmp_lt_u32 vcc, v250, v249
    ds_read_b32 v249, v15 offset:28
    v_and_b32 v40, v36, v8
    v_and_b32 v41, v36, v9
    v_and_b32 v42, v36, v10
    v_and_b32 v43, v36, v11
    s_waitcnt vmcnt(3)
    s_nop 0
    v_mfma_f32_32x32x16_bf16 v[16:31], v[40:43], v[112:115], v[16:31]
    v_and_b32 v44, v37, v8
    v_and_b32 v45, v37, v9
    v_and_b32 v46, v37, v10
    v_and_b32 v47, v37, v11
    s_waitcnt vmcnt(2)
    s_nop 0
    v_mfma_f32_32x32x16_bf16 v[16:31], v[44:47], v[116:119], v[16:31]
    v_and_b32 v40, v38, v8
    v_and_b32 v41, v38, v9
    v_and_b32 v42, v38, v10
    v_and_b32 v43, v38, v11
    s_waitcnt vmcnt(1)
    s_nop 0
    v_mfma_f32_32x32x16_bf16 v[16:31], v[40:43], v[120:123], v[16:31]
    v_and_b32 v44, v39, v8
    v_and_b32 v45, v39, v9
    v_and_b32 v46, v39, v10
    v_and_b32 v47, v39, v11
    s_waitcnt vmcnt(0)
    s_nop 0
    v_mfma_f32_32x32x16_bf16 v[16:31], v[44:47], v[124:127], v[16:31]
    s_waitcnt lgkmcnt(0)
    v_readfirstlane_b32 s58, v240
    s_cmp_lg_u32 s58, -1
    s_cbranch_scc1 L_have_f
L_spin_514:
    ds_read_b32 v240, v248 offset:32
    s_waitcnt lgkmcnt(0)
    v_readfirstlane_b32 s58, v240
    s_cmp_lg_u32 s58, -1
    s_cbranch_scc1 L_spun_515
    s_sleep 1
    s_branch L_spin_514
L_spun_515:
    ds_read_b32 v244, v15 offset:112
    s_waitcnt lgkmcnt(0)
L_have_f:
    v_readfirstlane_b32 s60, v244
    v_and_b32 v14, 31, v2
    v_lshlrev_b32 v14, 5, v14
    v_lshl_add_u32 v14, v3, 4, v14
    s_lshl_b32 s45, s3, 10
    v_add_u32 v14, s45, v14
    s_nop 1
    v_pk_mul_f32 v[16:17], v[16:17], v[240:241] op_sel_hi:[1,0]
    v_pk_mul_f32 v[18:19], v[18:19], v[240:241] op_sel_hi:[1,0]
    ds_write_b128 v14, v[16:19] offset:9216
    s_mov_b64 exec, 1
    ds_add_rtn_u32 v242, v15, v243 offset:4
    s_mov_b64 exec, -1
    s_bfe_u32 s45, s2, 0x40002
    s_lshl_b32 s45, s45, 14
    s_and_b32 s46, s2, 3
    s_lshl_b32 s46, s46, 8
    s_lshr_b32 s47, s2, 6
    s_lshl_b32 s47, s47, 6
    s_add_u32 s45, s45, s46
    s_add_u32 s45, s45, s47
    s_add_u32 s45, s45, 262144
    s_add_u32 s45, s45, s60
    v_lshlrev_b32 v14, 4, v2
    s_waitcnt lgkmcnt(0)
    v_readfirstlane_b32 s58, v242
    s_cmp_lg_u32 s58, 3
    s_cbranch_scc1 L_stream_end
    ds_read_b128 v[16:19], v14 offset:9216
    ds_read_b128 v[20:23], v14 offset:10240
    ds_read_b128 v[24:27], v14 offset:11264
    ds_read_b128 v[28:31], v14 offset:12288
    v_lshrrev_b32 v14, 3, v2
    v_and_b32 v245, 7, v2
    v_lshlrev_b32 v245, 3, v245
    v_lshl_add_u32 v14, v14, 10, v245
    s_waitcnt lgkmcnt(2)
    v_pk_add_f32 v[16:17], v[16:17], v[20:21]
    v_pk_add_f32 v[18:19], v[18:19], v[22:23]
    s_waitcnt lgkmcnt(0)
    v_pk_add_f32 v[24:25], v[24:25], v[28:29]
    v_pk_add_f32 v[26:27], v[26:27], v[30:31]
    v_pk_add_f32 v[16:17], v[16:17], v[24:25]
    v_pk_add_f32 v[18:19], v[18:19], v[26:27]
    v_cvt_pk_bf16_f32 v16, v16, v17
    v_cvt_pk_bf16_f32 v17, v18, v19
    v_min_u32 v16, 0xfffffffe, v16
    v_min_u32 v17, 0xfffffffe, v17
    buffer_store_dwordx2 v[16:17], v14, s[36:39], s45 offen sc1
    ds_write_b32 v15, v243 offset:116
L_stream_end:
    s_endpgm
.section .rodata,"a"
.p2align 6
.amdhsa_kernel sequential_preLN__mha_block_cached__glu_gated_bilinear__decode_kernel
  .amdhsa_next_free_vgpr 256
  .amdhsa_next_free_sgpr 100
  .amdhsa_accum_offset 256
  .amdhsa_group_segment_fixed_size 0
  .amdhsa_kernarg_size 96
  .amdhsa_user_sgpr_count 2
  .amdhsa_user_sgpr_kernarg_segment_ptr 1
  .amdhsa_system_sgpr_workgroup_id_x 1
.end_amdhsa_kernel
```
